```python
import torch

def _softmax(x, axis=-1):
    return torch.softmax(x, dim=axis)
def _gelu(x):
    return torch.nn.functional.gelu(x, approximate="tanh")
def _silu(x):
    return torch.nn.functional.silu(x)
def _sigmoid(x):
    return torch.sigmoid(x)
def _layernorm(x, axis=-1, eps=1e-5):
    m = x.mean(dim=axis, keepdim=True)
    v = x.var(dim=axis, keepdim=True, unbiased=False)
    return (x - m) / torch.sqrt(v + eps)
def _scatter_add(tgt, idx, src, axis=0):
    return tgt.clone().index_add_(axis, idx, src)
def _segment_sum(src, seg, n):
    out = torch.zeros((n,) + src.shape[1:], dtype=src.dtype)
    return out.index_add_(0, seg, src)
def _pad(x, pw):
    flat = tuple(v for pair in reversed(pw) for v in pair)
    return torch.nn.functional.pad(x, flat)

kernel_name = 'concat_heads__ssm_conv_h3__linear_attn_block__prompt'

def setup_inputs():

    _w = (lambda a: (lambda t: t.to(torch.bfloat16) if t.is_floating_point() else t)(torch.as_tensor(a)))
    def _A_setup():
        B, S, D = 1, 2048, 640
        ks = 4
        return {
            "q": _w((lambda *s: torch.randn(*s, dtype=torch.bfloat16) * 0.05)(B, S, D)),
            "k": _w((lambda *s: torch.randn(*s, dtype=torch.bfloat16) * 0.4)(B, S, D)),
            "v": _w((lambda *s: torch.randn(*s, dtype=torch.bfloat16) * 0.4)(B, S, D)),
            "shift_k": _w((lambda *s: torch.randn(*s, dtype=torch.bfloat16) * 0.4)(D, ks) * 0.5),
            "ssm_k": _w((lambda *s: torch.randn(*s, dtype=torch.bfloat16) * 0.4)(D, S) * (1.0 / S ** 0.5)),
            "ssm_D": _w((lambda *s: torch.randn(*s, dtype=torch.bfloat16) * 0.4)(D)),
        }
    _A_in = _A_setup()

    def _B_setup():
        B, S, D = 1, 2048, 640
        return {
            "x": _w((lambda *s: torch.randn(*s, dtype=torch.bfloat16) * 0.05)(B, S, D)),
            "wqkv": _w((lambda *s: torch.randn(*s, dtype=torch.bfloat16) * 0.8)(D, 3 * D)),
            "wo": _w((lambda *s: torch.randn(*s, dtype=torch.bfloat16) * 0.05)(D, D)),
        }
    _B_in = _B_setup()

    return {
        "A_q": _A_in["q"],
        "A_k": _A_in["k"],
        "A_v": _A_in["v"],
        "A_shift_k": _A_in["shift_k"],
        "A_ssm_k": _A_in["ssm_k"],
        "A_ssm_D": _A_in["ssm_D"],
        "B_x": _B_in["x"],
        "B_wqkv": _B_in["wqkv"],
        "B_wo": _B_in["wo"],
    }

def reference(A_q, A_k, A_v, A_shift_k, A_ssm_k, A_ssm_D, B_x, B_wqkv, B_wo):
    def _A_ref(q, k, v, shift_k, ssm_k, ssm_D):
        B, S, D = q.shape
        ks = shift_k.shape[-1]
        k_pad = _pad(k, ((0, 0), (ks - 1, 0), (0, 0)))
        k_shift = torch.zeros_like(k)
        for t in range(ks):
            k_shift = k_shift + k_pad[:, t:t + S, :] * shift_k[:, ks - 1 - t][None, None, :]
        kv = k_shift * v
        L = 2 * S
        kv_pad = _pad(kv, ((0, 0), (0, S), (0, 0)))
        kf_pad = _pad(ssm_k, ((0, 0), (0, S)))
        kv_f = (lambda x, axes=(-2,-1): torch.fft.rfft2(x.float(), dim=axes))(kv_pad[:, None, :, :], axes=(1, 2))
        kf_f = (lambda x, axes=(-2,-1): torch.fft.rfft2(x.float(), dim=axes))(kf_pad[:, None, :], axes=(1, 2))
        kf_f = (lambda x, *d: x.permute(*d))(kf_f, 1, 2, 0)
        y_f = kv_f * kf_f[None, :, :, :]
        y = (lambda x, s, axes=(-2,-1): torch.fft.irfft2(x, s=s, dim=axes).to(torch.bfloat16))(y_f, (1, L), axes=(1, 2))[:, 0, :S, :]
        y = y + kv * ssm_D[None, None, :]
        return q * y

    def _B_ref(x, wqkv, wo):
        B, S, D = x.shape
        H = 32; Dh = D // H
        qkv = (lambda x, *d: x.permute(*d))((x @ wqkv).reshape(B, S, 3, H, Dh), 2, 0, 3, 1, 4)
        q, k, v = qkv[0], qkv[1], qkv[2]
        phi = lambda t: torch.where(t > 0, t + 1, torch.exp(t)) + 1e-6
        pq, pk = phi(q), phi(k)
        kv = torch.einsum("bhsd,bhse->bhde", pk, v)
        z = torch.einsum("bhsd->bhd", pk)
        num = torch.einsum("bhqd,bhde->bhqe", pq, kv)
        den = torch.einsum("bhqd,bhd->bhq", pq, z)[..., None] + 1e-6
        o = num / den
        return (lambda x, *d: x.permute(*d))(o, 0, 2, 1, 3).reshape(B, S, D) @ wo

    a = _A_ref(A_q, A_k, A_v, A_shift_k, A_ssm_k, A_ssm_D)
    b = _B_ref(B_x, B_wqkv, B_wo)
    return torch.concatenate([a, b], axis=-1)
```

```asm
; @launch grid=(256,1,1) block=(512,1,1) lds=163840
.amdgcn_target "amdgcn-amd-amdhsa--gfx950"
.text
.p2align 8
L_CODE_BEGIN:
.globl concat_heads__ssm_conv_h3__linear_attn_block__prompt_kernel
.p2align 8
.type concat_heads__ssm_conv_h3__linear_attn_block__prompt_kernel,@function
concat_heads__ssm_conv_h3__linear_attn_block__prompt_kernel:
    s_load_dwordx16 s[4:19], s[0:1], 0
    s_load_dwordx8 s[20:27], s[0:1], 64
    s_cmp_ge_u32 s2, 256
    s_cbranch_scc1 L_END
    v_and_b32 v1, 63, v0
    v_lshrrev_b32 v2, 6, v0
    s_mov_b32 s76, 0
    v_readfirstlane_b32 s77, v2
    v_mov_b32 v12, 0
    s_mov_b32 s72, 0
    s_and_b32 s3, s77, 3
    s_lshr_b32 s74, s77, 2
    s_mul_i32 s75, s74, 81920
    s_cmp_ge_u32 s2, 192
    s_cbranch_scc1 L_P
    s_and_b32 s52, s2, 7
    s_lshr_b32 s53, s2, 3
    s_and_b32 s57, s52, 3
    s_lshl_b32 s57, s57, 2
    s_and_b32 s54, s53, 3
    s_add_u32 s57, s57, s54
    s_lshr_b32 s52, s52, 2
    s_lshr_b32 s54, s53, 2
    s_lshl_b32 s58, s52, 2
    s_add_u32 s58, s58, s54
    s_lshl_b32 s52, s52, 1
    s_add_u32 s52, s52, s54
    s_add_u32 s52, s52, 4
    s_cmp_ge_u32 s54, 4
    s_cselect_b32 s58, s52, s58
    s_lshl_b32 s66, s3, 12
    s_add_u32 s66, s66, 20480
    s_cmp_eq_u32 s74, 0
    s_cbranch_scc1 L_CONS
    s_setprio 3
    s_mul_i32 s62, s57, 3
    s_lshl_b32 s59, s58, 1
    s_add_u32 s62, s62, s59
    s_mul_i32 s59, s62, 205
    s_lshr_b32 s59, s59, 11
    s_mul_i32 s59, s59, 10
    s_sub_u32 s62, s62, s59
    s_lshl_b32 s64, s62, 7
    s_mul_i32 s63, s62, 245760
    v_lshrrev_b32 v240, 3, v1
    s_lshl_b32 s59, s57, 7
    s_lshl_b32 s54, s3, 5
    s_add_u32 s59, s59, s54
    v_add_u32 v240, s59, v240
    v_mul_u32_u24 v240, 1280, v240
    v_lshrrev_b32 v241, 4, v1
    v_and_b32 v242, 7, v1
    v_xor_b32 v242, v242, v241
    v_lshl_add_u32 v7, v242, 4, v240
    v_xor_b32 v242, 4, v242
    v_lshl_add_u32 v8, v242, 4, v240
    v_add_u32 v8, 9216, v8
    v_add_u32 v9, 18432, v7
    v_add_u32 v10, 18432, v8
    s_waitcnt lgkmcnt(0)
    s_mov_b32 s28, s16
    s_and_b32 s29, s17, 0xffff
    s_mov_b32 s30, 2621440
    s_mov_b32 s31, 0x20000
    s_add_u32 m0, s66, 36864
    s_nop 0
    buffer_load_dwordx4 v7, s[28:31], s64 offen offset:0 lds
    buffer_load_dwordx4 v8, s[28:31], s64 offen offset:1024 lds
    buffer_load_dwordx4 v9, s[28:31], s64 offen offset:2048 lds
    buffer_load_dwordx4 v10, s[28:31], s64 offen offset:3072 lds
    s_add_u32 s64, s64, 128
    s_cmp_eq_u32 s64, 1280
    s_cselect_b32 s64, 0, s64
    s_mov_b32 s32, s18
    s_and_b32 s33, s19, 0xffff
    s_mov_b32 s34, 2457600
    s_mov_b32 s35, 0x20000
    s_mul_i32 s59, s58, 160
    s_add_u32 s60, s59, 1280
    s_add_u32 s61, s59, 2400
    s_sub_u32 s59, s58, 8
    s_mul_i32 s59, s59, 320
    s_cmp_ge_u32 s58, 8
    s_cselect_b32 s60, s59, s60
    s_cselect_b32 s61, s59, s61
    s_mul_i32 s59, s3, 61440
    s_add_u32 s60, s60, s59
    s_add_u32 s61, s61, s59
    s_mul_i32 s65, s3, 5120
    v_mov_b32 v244, s60
    v_mov_b32 v245, s61
    v_add_u32 v240, 0, v1
    v_mul_u32_u24 v241, 3277, v240
    v_lshrrev_b32 v241, 16, v241
    v_mul_u32_u24 v242, 20, v241
    v_sub_u32 v240, v240, v242
    v_cmp_gt_u32 vcc, 10, v240
    v_mul_u32_u24 v241, 3840, v241
    v_lshl_add_u32 v240, v240, 4, v241
    v_cndmask_b32 v242, v245, v244, vcc
    v_add_u32 v2, v240, v242
    s_add_u32 m0, s65, 36864
    s_nop 0
    buffer_load_dwordx4 v2, s[32:35], s63 offen offset:0 lds
    v_add_u32 v240, 64, v1
    v_mul_u32_u24 v241, 3277, v240
    v_lshrrev_b32 v241, 16, v241
    v_mul_u32_u24 v242, 20, v241
    v_sub_u32 v240, v240, v242
    v_cmp_gt_u32 vcc, 10, v240
    v_mul_u32_u24 v241, 3840, v241
    v_lshl_add_u32 v240, v240, 4, v241
    v_cndmask_b32 v242, v245, v244, vcc
    v_add_u32 v240, v240, v242
    v_subrev_u32 v3, 1024, v240
    buffer_load_dwordx4 v3, s[32:35], s63 offen offset:1024 lds
    v_add_u32 v240, 128, v1
    v_mul_u32_u24 v241, 3277, v240
    v_lshrrev_b32 v241, 16, v241
    v_mul_u32_u24 v242, 20, v241
    v_sub_u32 v240, v240, v242
    v_lshrrev_b32 v242, 4, v1
    v_and_b32 v242, 2, v242
    v_xor_b32 v240, v240, v242
    v_cmp_gt_u32 vcc, 10, v240
    v_mul_u32_u24 v241, 3840, v241
    v_lshl_add_u32 v240, v240, 4, v241
    v_cndmask_b32 v242, v245, v244, vcc
    v_add_u32 v240, v240, v242
    v_subrev_u32 v4, 2048, v240
    buffer_load_dwordx4 v4, s[32:35], s63 offen offset:2048 lds
    v_add_u32 v240, 192, v1
    v_mul_u32_u24 v241, 3277, v240
    v_lshrrev_b32 v241, 16, v241
    v_mul_u32_u24 v242, 20, v241
    v_sub_u32 v240, v240, v242
    v_xor_b32 v240, 2, v240
    v_cmp_gt_u32 vcc, 10, v240
    v_mul_u32_u24 v241, 3840, v241
    v_lshl_add_u32 v240, v240, 4, v241
    v_cndmask_b32 v242, v245, v244, vcc
    v_add_u32 v240, v240, v242
    v_subrev_u32 v5, 3072, v240
    buffer_load_dwordx4 v5, s[32:35], s63 offen offset:3072 lds
    v_add_u32 v240, 256, v1
    v_mul_u32_u24 v241, 3277, v240
    v_lshrrev_b32 v241, 16, v241
    v_mul_u32_u24 v242, 20, v241
    v_sub_u32 v240, v240, v242
    v_xor_b32 v240, 2, v240
    v_cmp_gt_u32 vcc, 10, v240
    v_mul_u32_u24 v241, 3840, v241
    v_lshl_add_u32 v240, v240, 4, v241
    v_cndmask_b32 v242, v245, v244, vcc
    v_add_u32 v6, v240, v242
    s_add_u32 m0, s65, 40960
    s_nop 0
    buffer_load_dwordx4 v6, s[32:35], s63 offen lds
    s_add_u32 s63, s63, 245760
    s_cmp_eq_u32 s63, 2457600
    s_cselect_b32 s63, 0, s63
    s_add_u32 m0, s66, 0
    s_nop 0
    buffer_load_dwordx4 v7, s[28:31], s64 offen offset:0 lds
    buffer_load_dwordx4 v8, s[28:31], s64 offen offset:1024 lds
    buffer_load_dwordx4 v9, s[28:31], s64 offen offset:2048 lds
    buffer_load_dwordx4 v10, s[28:31], s64 offen offset:3072 lds
    s_add_u32 s64, s64, 128
    s_cmp_eq_u32 s64, 1280
    s_cselect_b32 s64, 0, s64
    s_add_u32 m0, s65, 0
    s_nop 0
    buffer_load_dwordx4 v2, s[32:35], s63 offen offset:0 lds
    buffer_load_dwordx4 v3, s[32:35], s63 offen offset:1024 lds
    buffer_load_dwordx4 v4, s[32:35], s63 offen offset:2048 lds
    buffer_load_dwordx4 v5, s[32:35], s63 offen offset:3072 lds
    s_add_u32 m0, s65, 4096
    s_nop 0
    buffer_load_dwordx4 v6, s[32:35], s63 offen lds
    s_add_u32 s63, s63, 245760
    s_cmp_eq_u32 s63, 2457600
    s_cselect_b32 s63, 0, s63
    s_waitcnt lgkmcnt(0)
    s_mov_b32 s48, s26
    s_and_b32 s49, s27, 0xffff
    s_mov_b32 s50, 10485760
    s_mov_b32 s51, 0x20000
    s_mov_b32 s44, s24
    s_and_b32 s45, s25, 0xffff
    s_mov_b32 s46, 256
    s_mov_b32 s47, 0x20000
    s_waitcnt vmcnt(9)
    s_barrier
    s_add_u32 m0, s66, 118784
    s_nop 0
    buffer_load_dwordx4 v7, s[28:31], s64 offen offset:0 lds
    buffer_load_dwordx4 v8, s[28:31], s64 offen offset:1024 lds
    buffer_load_dwordx4 v9, s[28:31], s64 offen offset:2048 lds
    buffer_load_dwordx4 v10, s[28:31], s64 offen offset:3072 lds
    s_add_u32 s64, s64, 128
    s_cmp_eq_u32 s64, 1280
    s_cselect_b32 s64, 0, s64
    s_add_u32 m0, s65, 118784
    s_nop 0
    buffer_load_dwordx4 v2, s[32:35], s63 offen offset:0 lds
    buffer_load_dwordx4 v3, s[32:35], s63 offen offset:1024 lds
    buffer_load_dwordx4 v4, s[32:35], s63 offen offset:2048 lds
    buffer_load_dwordx4 v5, s[32:35], s63 offen offset:3072 lds
    s_add_u32 m0, s65, 122880
    s_nop 0
    buffer_load_dwordx4 v6, s[32:35], s63 offen lds
    s_add_u32 s63, s63, 245760
    s_cmp_eq_u32 s63, 2457600
    s_cselect_b32 s63, 0, s63
    s_waitcnt vmcnt(9)
    s_barrier
    s_add_u32 m0, s66, 81920
    s_nop 0
    buffer_load_dwordx4 v7, s[28:31], s64 offen offset:0 lds
    buffer_load_dwordx4 v8, s[28:31], s64 offen offset:1024 lds
    buffer_load_dwordx4 v9, s[28:31], s64 offen offset:2048 lds
    buffer_load_dwordx4 v10, s[28:31], s64 offen offset:3072 lds
    s_add_u32 s64, s64, 128
    s_cmp_eq_u32 s64, 1280
    s_cselect_b32 s64, 0, s64
    s_add_u32 m0, s65, 81920
    s_nop 0
    buffer_load_dwordx4 v2, s[32:35], s63 offen offset:0 lds
    buffer_load_dwordx4 v3, s[32:35], s63 offen offset:1024 lds
    buffer_load_dwordx4 v4, s[32:35], s63 offen offset:2048 lds
    buffer_load_dwordx4 v5, s[32:35], s63 offen offset:3072 lds
    s_add_u32 m0, s65, 86016
    s_nop 0
    buffer_load_dwordx4 v6, s[32:35], s63 offen lds
    s_add_u32 s63, s63, 245760
    s_cmp_eq_u32 s63, 2457600
    s_cselect_b32 s63, 0, s63
    s_waitcnt vmcnt(9)
    s_barrier
    s_add_u32 m0, s66, 36864
    s_nop 0
    buffer_load_dwordx4 v7, s[28:31], s64 offen offset:0 lds
    buffer_load_dwordx4 v8, s[28:31], s64 offen offset:1024 lds
    buffer_load_dwordx4 v9, s[28:31], s64 offen offset:2048 lds
    buffer_load_dwordx4 v10, s[28:31], s64 offen offset:3072 lds
    s_add_u32 s64, s64, 128
    s_cmp_eq_u32 s64, 1280
    s_cselect_b32 s64, 0, s64
    s_add_u32 m0, s65, 36864
    s_nop 0
    buffer_load_dwordx4 v2, s[32:35], s63 offen offset:0 lds
    buffer_load_dwordx4 v3, s[32:35], s63 offen offset:1024 lds
    buffer_load_dwordx4 v4, s[32:35], s63 offen offset:2048 lds
    buffer_load_dwordx4 v5, s[32:35], s63 offen offset:3072 lds
    s_add_u32 m0, s65, 40960
    s_nop 0
    buffer_load_dwordx4 v6, s[32:35], s63 offen lds
    s_add_u32 s63, s63, 245760
    s_cmp_eq_u32 s63, 2457600
    s_cselect_b32 s63, 0, s63
    s_waitcnt vmcnt(9)
    s_barrier
    s_add_u32 m0, s66, 0
    s_nop 0
    buffer_load_dwordx4 v7, s[28:31], s64 offen offset:0 lds
    buffer_load_dwordx4 v8, s[28:31], s64 offen offset:1024 lds
    buffer_load_dwordx4 v9, s[28:31], s64 offen offset:2048 lds
    buffer_load_dwordx4 v10, s[28:31], s64 offen offset:3072 lds
    s_add_u32 s64, s64, 128
    s_cmp_eq_u32 s64, 1280
    s_cselect_b32 s64, 0, s64
    s_add_u32 m0, s65, 0
    s_nop 0
    buffer_load_dwordx4 v2, s[32:35], s63 offen offset:0 lds
    buffer_load_dwordx4 v3, s[32:35], s63 offen offset:1024 lds
    buffer_load_dwordx4 v4, s[32:35], s63 offen offset:2048 lds
    buffer_load_dwordx4 v5, s[32:35], s63 offen offset:3072 lds
    s_add_u32 m0, s65, 4096
    s_nop 0
    buffer_load_dwordx4 v6, s[32:35], s63 offen lds
    s_add_u32 s63, s63, 245760
    s_cmp_eq_u32 s63, 2457600
    s_cselect_b32 s63, 0, s63
    s_waitcnt vmcnt(9)
    s_barrier
    s_add_u32 m0, s66, 118784
    s_nop 0
    buffer_load_dwordx4 v7, s[28:31], s64 offen offset:0 lds
    buffer_load_dwordx4 v8, s[28:31], s64 offen offset:1024 lds
    buffer_load_dwordx4 v9, s[28:31], s64 offen offset:2048 lds
    buffer_load_dwordx4 v10, s[28:31], s64 offen offset:3072 lds
    s_add_u32 s64, s64, 128
    s_cmp_eq_u32 s64, 1280
    s_cselect_b32 s64, 0, s64
    s_add_u32 m0, s65, 118784
    s_nop 0
    buffer_load_dwordx4 v2, s[32:35], s63 offen offset:0 lds
    buffer_load_dwordx4 v3, s[32:35], s63 offen offset:1024 lds
    buffer_load_dwordx4 v4, s[32:35], s63 offen offset:2048 lds
    buffer_load_dwordx4 v5, s[32:35], s63 offen offset:3072 lds
    s_add_u32 m0, s65, 122880
    s_nop 0
    buffer_load_dwordx4 v6, s[32:35], s63 offen lds
    s_add_u32 s63, s63, 245760
    s_cmp_eq_u32 s63, 2457600
    s_cselect_b32 s63, 0, s63
    s_waitcnt vmcnt(9)
    s_barrier
    s_add_u32 m0, s66, 81920
    s_nop 0
    buffer_load_dwordx4 v7, s[28:31], s64 offen offset:0 lds
    buffer_load_dwordx4 v8, s[28:31], s64 offen offset:1024 lds
    buffer_load_dwordx4 v9, s[28:31], s64 offen offset:2048 lds
    buffer_load_dwordx4 v10, s[28:31], s64 offen offset:3072 lds
    s_add_u32 s64, s64, 128
    s_cmp_eq_u32 s64, 1280
    s_cselect_b32 s64, 0, s64
    s_add_u32 m0, s65, 81920
    s_nop 0
    buffer_load_dwordx4 v2, s[32:35], s63 offen offset:0 lds
    buffer_load_dwordx4 v3, s[32:35], s63 offen offset:1024 lds
    buffer_load_dwordx4 v4, s[32:35], s63 offen offset:2048 lds
    buffer_load_dwordx4 v5, s[32:35], s63 offen offset:3072 lds
    s_add_u32 m0, s65, 86016
    s_nop 0
    buffer_load_dwordx4 v6, s[32:35], s63 offen lds
    s_add_u32 s63, s63, 245760
    s_cmp_eq_u32 s63, 2457600
    s_cselect_b32 s63, 0, s63
    s_waitcnt vmcnt(9)
    s_barrier
    v_mov_b32 v13, 128
    buffer_load_dword v14, v13, s[44:47], 0 offen sc1
    s_add_u32 m0, s66, 36864
    s_nop 0
    buffer_load_dwordx4 v7, s[28:31], s64 offen offset:0 lds
    buffer_load_dwordx4 v8, s[28:31], s64 offen offset:1024 lds
    buffer_load_dwordx4 v9, s[28:31], s64 offen offset:2048 lds
    buffer_load_dwordx4 v10, s[28:31], s64 offen offset:3072 lds
    s_add_u32 s64, s64, 128
    s_cmp_eq_u32 s64, 1280
    s_cselect_b32 s64, 0, s64
    s_add_u32 m0, s65, 36864
    s_nop 0
    buffer_load_dwordx4 v2, s[32:35], s63 offen offset:0 lds
    buffer_load_dwordx4 v3, s[32:35], s63 offen offset:1024 lds
    buffer_load_dwordx4 v4, s[32:35], s63 offen offset:2048 lds
    buffer_load_dwordx4 v5, s[32:35], s63 offen offset:3072 lds
    s_add_u32 m0, s65, 40960
    s_nop 0
    buffer_load_dwordx4 v6, s[32:35], s63 offen lds
    s_add_u32 s63, s63, 245760
    s_cmp_eq_u32 s63, 2457600
    s_cselect_b32 s63, 0, s63
    s_waitcnt vmcnt(10)
    s_barrier
    s_add_u32 m0, s66, 0
    s_nop 0
    buffer_load_dwordx4 v7, s[28:31], s64 offen offset:0 lds
    buffer_load_dwordx4 v8, s[28:31], s64 offen offset:1024 lds
    buffer_load_dwordx4 v9, s[28:31], s64 offen offset:2048 lds
    buffer_load_dwordx4 v10, s[28:31], s64 offen offset:3072 lds
    s_add_u32 s64, s64, 128
    s_cmp_eq_u32 s64, 1280
    s_cselect_b32 s64, 0, s64
    s_add_u32 m0, s65, 0
    s_nop 0
    buffer_load_dwordx4 v2, s[32:35], s63 offen offset:0 lds
    buffer_load_dwordx4 v3, s[32:35], s63 offen offset:1024 lds
    buffer_load_dwordx4 v4, s[32:35], s63 offen offset:2048 lds
    buffer_load_dwordx4 v5, s[32:35], s63 offen offset:3072 lds
    s_add_u32 m0, s65, 4096
    s_nop 0
    buffer_load_dwordx4 v6, s[32:35], s63 offen lds
    s_add_u32 s63, s63, 245760
    s_cmp_eq_u32 s63, 2457600
    s_cselect_b32 s63, 0, s63
    s_waitcnt vmcnt(9)
    s_barrier
    v_cmp_gt_u32 vcc, 1, v14
    s_mov_b32 s78, 0
    s_nop 0
    s_cbranch_vccz L_OK_zld
L_POLL_zld:
    s_sleep 2
    buffer_load_dword v14, v13, s[44:47], 0 offen sc1
    s_add_u32 s78, s78, 1
    s_waitcnt vmcnt(0)
    v_cmp_gt_u32 vcc, 1, v14
    s_cmp_ge_u32 s78, 0x20000
    s_cbranch_scc1 L_OK_zld
    s_cbranch_vccnz L_POLL_zld
L_OK_zld:
    s_lshl_b32 s53, s58, 7
    s_add_u32 s6, s26, s53
    s_addc_u32 s7, s27, 0
    s_mov_b32 s72, 1
    s_cmp_ge_u32 s2, 128
    s_cbranch_scc1 L_CONV
    s_branch L_B2
L_CONS:
    s_cmp_lg_u32 s3, 3
    s_cbranch_scc1 L_CONS1
    s_getpc_b64 s[52:53]
L_PCg:
    s_lshr_b32 s54, s2, 3
    s_and_b32 s54, s54, 7
    s_lshl_b32 s54, s54, 13
    v_lshlrev_b32 v3, 7, v1
    v_add_u32 v3, s54, v3
    s_sub_u32 s52, s52, L_PCg-L_CODE_BEGIN
    s_subb_u32 s53, s53, 0
    v_min_u32 v3, L_CODE_END-L_CODE_BEGIN-4, v3
    global_load_dword v15, v3, s[52:53]
    v_and_b32 v4, 15, v1
    v_lshlrev_b32 v4, 2, v4
    v_bfe_u32 v5, v1, 4, 1
    v_mul_u32_u24 v5, 81920, v5
    v_add_u32 v4, v4, v5
    v_add_u32 v4, 81856, v4
    v_mov_b32 v5, 0
    ds_write_b32 v4, v5
L_CONS1:
    s_setprio 2
    s_waitcnt lgkmcnt(0)
    s_mov_b32 s48, s26
    s_and_b32 s49, s27, 0xffff
    s_mov_b32 s50, 10485760
    s_mov_b32 s51, 0x20000
    s_mov_b32 s44, s24
    s_and_b32 s45, s25, 0xffff
    s_mov_b32 s46, 256
    s_mov_b32 s47, 0x20000
    v_lshrrev_b32 v241, 4, v1
    v_bfe_u32 v242, v1, 2, 2
    v_lshl_add_u32 v242, v241, 3, v242
    v_mul_u32_u24 v242, 320, v242
    v_and_b32 v243, 3, v1
    v_lshl_add_u32 v242, v243, 3, v242
    v_and_b32 v243, 1, v241
    v_lshlrev_b32 v243, 5, v243
    v_add_u32 v9, v242, v243
    v_sub_u32 v10, v242, v243
    v_and_b32 v240, 15, v1
    v_lshrrev_b32 v242, 1, v240
    v_xor_b32 v242, v242, v241
    v_lshlrev_b32 v240, 7, v240
    v_add_u32 v240, s66, v240
    v_lshl_add_u32 v11, v242, 4, v240
    v_xor_b32 v242, 4, v242
    v_lshl_add_u32 v12, v242, 4, v240
    s_mov_b32 s70, 1069066811
    s_mov_b32 s71, 897988541
    v_add_u32 v2, 81920, v9
    v_add_u32 v3, 81920, v10
    v_add_u32 v4, 81920, v11
    v_add_u32 v5, 81920, v12
    s_cmp_ge_u32 s58, 8
    s_cbranch_scc1 L_Q
    v_lshlrev_b32 v240, 4, v1
    s_mul_i32 s52, s3, 10240
    s_add_u32 s52, s52, 36864
    v_add_u32 v214, s52, v240
    s_lshl_b32 s52, s3, 10
    s_add_u32 s52, s52, 36864
    v_add_u32 v215, s52, v240
    v_and_b32 v246, 15, v1
    v_lshrrev_b32 v247, 4, v1
    v_lshlrev_b32 v247, 2, v247
    s_lshl_b32 s52, s3, 2
    v_subrev_u32 v246, s52, v246
    v_subrev_u32 v247, s52, v247
    s_lshl_b32 s53, s3, 11
    v_mov_b32 v245, 8192
    v_lshlrev_b32 v216, 2, v1
    v_add_u32 v217, s53, v216
    v_mov_b32 v220, 0x3f803f80
    v_mov_b32 v221, 0x3f803f80
    v_mov_b32 v222, 0x3f803f80
    v_mov_b32 v223, 0x3f803f80
    v_add_u32 v240, 0, v247
    v_add_u32 v241, 0, v246
    v_max_u32 v242, v240, v241
    v_cmp_gt_u32 vcc, 20, v242
    v_mul_u32_u24 v241, 80, v241
    v_lshl_add_u32 v241, v240, 2, v241
    v_add_u32 v241, s53, v241
    v_cndmask_b32 v208, v245, v241, vcc
    v_add_u32 v240, 0, v247
    v_add_u32 v241, 16, v246
    v_max_u32 v242, v240, v241
    v_cmp_gt_u32 vcc, 20, v242
    v_mul_u32_u24 v241, 80, v241
    v_lshl_add_u32 v241, v240, 2, v241
    v_add_u32 v241, s53, v241
    v_cndmask_b32 v209, v245, v241, vcc
    v_add_u32 v240, 0, v247
    v_and_b32 v241, 15, v1
    v_mul_u32_u24 v241, 20, v241
    v_max_u32 v242, v240, v241
    v_cmp_gt_u32 vcc, 20, v242
    v_lshlrev_b32 v240, 2, v240
    v_add_u32 v240, s53, v240
    v_add_u32 v240, 1600, v240
    v_cndmask_b32 v212, v245, v240, vcc
    v_add_u32 v240, 16, v247
    v_add_u32 v241, 0, v246
    v_max_u32 v242, v240, v241
    v_cmp_gt_u32 vcc, 20, v242
    v_mul_u32_u24 v241, 80, v241
    v_lshl_add_u32 v241, v240, 2, v241
    v_add_u32 v241, s53, v241
    v_cndmask_b32 v210, v245, v241, vcc
    v_add_u32 v240, 16, v247
    v_add_u32 v241, 16, v246
    v_max_u32 v242, v240, v241
    v_cmp_gt_u32 vcc, 20, v242
    v_mul_u32_u24 v241, 80, v241
    v_lshl_add_u32 v241, v240, 2, v241
    v_add_u32 v241, s53, v241
    v_cndmask_b32 v211, v245, v241, vcc
    v_add_u32 v240, 16, v247
    v_and_b32 v241, 15, v1
    v_mul_u32_u24 v241, 20, v241
    v_max_u32 v242, v240, v241
    v_cmp_gt_u32 vcc, 20, v242
    v_lshlrev_b32 v240, 2, v240
    v_add_u32 v240, s53, v240
    v_add_u32 v240, 1600, v240
    v_cndmask_b32 v213, v245, v240, vcc
    s_lshl_b32 s52, s58, 2
    s_add_u32 s52, s52, s3
    s_mul_i32 s52, s52, 1680
    s_add_u32 s52, s52, 53248
    s_lshl_b32 s53, s58, 7
    s_add_u32 s6, s26, s53
    s_addc_u32 s7, s27, 0
    s_mov_b32 s28, s12
    s_and_b32 s29, s13, 0xffff
    s_mov_b32 s30, 2621440
    s_mov_b32 s31, 0x20000
    s_add_u32 s59, s2, 512
    s_lshl_b32 s60, s59, 12
    s_add_u32 s62, s12, s60
    s_addc_u32 s63, s13, 0
    s_load_dword s64, s[62:63], 0
    s_lshr_b32 s54, s59, 1
    s_lshl_b32 s54, s54, 2
    s_load_dword s65, s[14:15], s54
    s_lshl_b32 s54, s3, 10
    v_lshl_add_u32 v6, v1, 4, s54
    buffer_load_dwordx4 v[224:227], v6, s[28:31], s60 offen
    buffer_load_dwordx4 v[228:231], v6, s[28:31], s60 offen offset:4
    v_mov_b32 v8, 0
    v_mov_b32 v7, 0
    s_mov_b32 s61, 19456
    s_mul_i32 s55, s59, 4224
    s_waitcnt lgkmcnt(0)
    s_add_u32 s62, s55, 1048576
    s_add_u32 s55, s55, 4194304
    s_lshr_b32 s63, s59, 6
    s_lshl_b32 s63, s63, 10
    s_add_u32 s63, s63, 8192
    s_lshl_b32 s53, s65, 16
    s_and_b32 s54, s65, 0xffff0000
    s_bitcmp1_b32 s59, 0
    s_cselect_b32 s53, s54, s53
    s_lshl_b32 s54, s64, 16
    v_mov_b32 v240, s54
    v_add_f32 v240, s53, v240
    s_and_b32 s54, s64, 0xffff0000
    v_mov_b32 v241, s54
    v_cvt_pk_bf16_f32 v236, v240, v241
    v_and_b32 v240, 15, v1
    v_lshrrev_b32 v241, 4, v1
    v_add_u32 v242, 1, v240
    v_bfe_u32 v243, v242, 1, 1
    v_mul_u32_u24 v243, 4224, v243
    v_lshrrev_b32 v244, 2, v242
    v_lshl_add_u32 v244, v241, 3, v244
    v_lshl_add_u32 v243, v244, 3, v243
    s_lshr_b32 s53, s3, 1
    s_and_b32 s54, s3, 1
    s_lshl_b32 s53, s53, 7
    s_lshl_b32 s54, s54, 4
    s_add_u32 s53, s53, s54
    s_lshl_b32 s54, s53, 1
    s_add_u32 s54, s54, 8448
    v_add_u32 v237, s54, v243
    v_and_b32 v242, 1, v242
    v_lshlrev_b32 v238, 4, v242
    v_lshlrev_b32 v242, 1, v241
    v_sub_u32 v242, v242, v240
    v_add_u32 v242, 15, v242
    s_add_u32 s53, s53, 16896
    v_lshl_add_u32 v239, v242, 4, s53
    v_lshrrev_b32 v242, 1, v1
    v_and_b32 v243, 1, v1
    v_mul_u32_u24 v243, 144, v243
    v_add_u32 v242, v242, v243
    s_lshl_b32 s53, s3, 9
    s_add_u32 s53, s53, 16896
    v_lshl_add_u32 v248, v242, 4, s53
    v_and_b32 v242, 1, v241
    v_mul_u32_u24 v242, 144, v242
    v_add_u32 v242, v242, v240
    v_lshlrev_b32 v249, 4, v242
    v_and_b32 v242, 1, v1
    v_lshlrev_b32 v242, 4, v242
    v_bfe_u32 v243, v1, 1, 1
    v_mul_u32_u24 v243, 4224, v243
    v_add_u32 v250, v242, v243
    s_lshl_b32 s53, s3, 13
    s_add_u32 s53, s53, 13312
    s_cmp_eq_u32 s3, 0
    s_cselect_b32 s53, 0, s53
    v_lshl_add_u32 v251, v1, 4, s53
    v_bfe_u32 v240, v1, 1, 4
    v_and_b32 v241, 1, v1
    v_lshlrev_b32 v240, 4, v240
    v_lshl_add_u32 v240, v241, 9, v240
    v_lshrrev_b32 v241, 5, v1
    v_lshl_add_u32 v240, v241, 10, v240
    s_lshl_b32 s53, s3, 11
    v_add_u32 v252, s53, v240
    s_waitcnt lgkmcnt(0)
    s_barrier
    ds_read_b128 v[176:179], v11 offset:36864
    ds_read_b128 v[180:183], v11 offset:38912
    ds_read_b128 v[184:187], v12 offset:36864
    ds_read_b128 v[188:191], v12 offset:38912
    ds_read_b64_tr_b16 v[96:97], v9 offset:36864
    ds_read_b64_tr_b16 v[98:99], v9 offset:38144
    ds_read_b64_tr_b16 v[100:101], v10 offset:36896
    ds_read_b64_tr_b16 v[102:103], v10 offset:38176
    ds_read_b64_tr_b16 v[104:105], v9 offset:36928
    ds_read_b64_tr_b16 v[106:107], v9 offset:38208
    ds_read_b64_tr_b16 v[108:109], v10 offset:36960
    ds_read_b64_tr_b16 v[110:111], v10 offset:38240
    ds_read_b64_tr_b16 v[112:113], v9 offset:36992
    ds_read_b64_tr_b16 v[114:115], v9 offset:38272
    ds_read_b64_tr_b16 v[116:117], v10 offset:37024
    ds_read_b64_tr_b16 v[118:119], v10 offset:38304
    ds_read_b64_tr_b16 v[120:121], v9 offset:37056
    ds_read_b64_tr_b16 v[122:123], v9 offset:38336
    ds_read_b64_tr_b16 v[124:125], v10 offset:37088
    ds_read_b64_tr_b16 v[126:127], v10 offset:38368
    ds_read_b64_tr_b16 v[128:129], v9 offset:37120
    ds_read_b64_tr_b16 v[130:131], v9 offset:38400
    ds_read_b64_tr_b16 v[132:133], v10 offset:37152
    ds_read_b64_tr_b16 v[134:135], v10 offset:38432
    s_waitcnt lgkmcnt(15)
    v_mfma_f32_16x16x32_bf16 v[16:19], v[176:179], v[96:99], 0
    ds_read_b64_tr_b16 v[136:137], v9 offset:47104
    v_mfma_f32_16x16x32_bf16 v[56:59], v[180:183], v[96:99], 0
    ds_read_b64_tr_b16 v[138:139], v9 offset:48384
    v_mfma_f32_16x16x32_bf16 v[20:23], v[176:179], v[100:103], 0
    ds_read_b64_tr_b16 v[140:141], v10 offset:47136
    v_mfma_f32_16x16x32_bf16 v[60:63], v[180:183], v[100:103], 0
    ds_read_b64_tr_b16 v[142:143], v10 offset:48416
    s_waitcnt lgkmcnt(15)
    v_mfma_f32_16x16x32_bf16 v[24:27], v[176:179], v[104:107], 0
    ds_read_b64_tr_b16 v[144:145], v9 offset:47168
    v_mfma_f32_16x16x32_bf16 v[64:67], v[180:183], v[104:107], 0
    ds_read_b64_tr_b16 v[146:147], v9 offset:48448
    v_mfma_f32_16x16x32_bf16 v[28:31], v[176:179], v[108:111], 0
    ds_read_b64_tr_b16 v[148:149], v10 offset:47200
    v_mfma_f32_16x16x32_bf16 v[68:71], v[180:183], v[108:111], 0
    ds_read_b64_tr_b16 v[150:151], v10 offset:48480
    s_waitcnt lgkmcnt(11)
    v_mfma_f32_16x16x32_bf16 v[32:35], v[176:179], v[112:115], 0
    ds_read_b64_tr_b16 v[152:153], v9 offset:47232
    v_mfma_f32_16x16x32_bf16 v[72:75], v[180:183], v[112:115], 0
    ds_read_b64_tr_b16 v[154:155], v9 offset:48512
    v_mfma_f32_16x16x32_bf16 v[36:39], v[176:179], v[116:119], 0
    ds_read_b64_tr_b16 v[156:157], v10 offset:47264
    v_mfma_f32_16x16x32_bf16 v[76:79], v[180:183], v[116:119], 0
    ds_read_b64_tr_b16 v[158:159], v10 offset:48544
    v_mfma_f32_16x16x32_bf16 v[40:43], v[176:179], v[120:123], 0
    ds_read_b64_tr_b16 v[160:161], v9 offset:47296
    v_mfma_f32_16x16x32_bf16 v[80:83], v[180:183], v[120:123], 0
    ds_read_b64_tr_b16 v[162:163], v9 offset:48576
    v_mfma_f32_16x16x32_bf16 v[44:47], v[176:179], v[124:127], 0
    ds_read_b64_tr_b16 v[164:165], v10 offset:47328
    v_mfma_f32_16x16x32_bf16 v[84:87], v[180:183], v[124:127], 0
    ds_read_b64_tr_b16 v[166:167], v10 offset:48608
    s_waitcnt lgkmcnt(10)
    v_mfma_f32_16x16x32_bf16 v[48:51], v[176:179], v[128:131], 0
    ds_read_b64_tr_b16 v[168:169], v9 offset:47360
    v_mfma_f32_16x16x32_bf16 v[88:91], v[180:183], v[128:131], 0
    ds_read_b64_tr_b16 v[170:171], v9 offset:48640
    v_mfma_f32_16x16x32_bf16 v[52:55], v[176:179], v[132:135], 0
    ds_read_b64_tr_b16 v[172:173], v10 offset:47392
    v_mfma_f32_16x16x32_bf16 v[92:95], v[180:183], v[132:135], 0
    ds_read_b64_tr_b16 v[174:175], v10 offset:48672
    v_mfma_f32_16x16x32_bf16 v[16:19], v[184:187], v[136:139], v[16:19]
    v_mfma_f32_16x16x32_bf16 v[56:59], v[188:191], v[136:139], v[56:59]
    v_mfma_f32_16x16x32_bf16 v[20:23], v[184:187], v[140:143], v[20:23]
    s_waitcnt lgkmcnt(0)
    s_barrier
    v_mfma_f32_16x16x32_bf16 v[60:63], v[188:191], v[140:143], v[60:63]
    ds_read_b128 v[192:195], v11 offset:0
    ds_read_b128 v[196:199], v11 offset:2048
    v_mfma_f32_16x16x32_bf16 v[24:27], v[184:187], v[144:147], v[24:27]
    ds_read_b128 v[200:203], v12 offset:0
    v_mfma_f32_16x16x32_bf16 v[64:67], v[188:191], v[144:147], v[64:67]
    ds_read_b128 v[204:207], v12 offset:2048
    ds_read_b64_tr_b16 v[96:97], v9 offset:0
    v_mfma_f32_16x16x32_bf16 v[28:31], v[184:187], v[148:151], v[28:31]
    ds_read_b64_tr_b16 v[98:99], v9 offset:1280
    v_mfma_f32_16x16x32_bf16 v[68:71], v[188:191], v[148:151], v[68:71]
    ds_read_b64_tr_b16 v[100:101], v10 offset:32
    ds_read_b64_tr_b16 v[102:103], v10 offset:1312
    v_mfma_f32_16x16x32_bf16 v[32:35], v[184:187], v[152:155], v[32:35]
    ds_read_b64_tr_b16 v[104:105], v9 offset:64
    v_mfma_f32_16x16x32_bf16 v[72:75], v[188:191], v[152:155], v[72:75]
    ds_read_b64_tr_b16 v[106:107], v9 offset:1344
    v_mfma_f32_16x16x32_bf16 v[36:39], v[184:187], v[156:159], v[36:39]
    ds_read_b64_tr_b16 v[108:109], v10 offset:96
    ds_read_b64_tr_b16 v[110:111], v10 offset:1376
    v_mfma_f32_16x16x32_bf16 v[76:79], v[188:191], v[156:159], v[76:79]
    ds_read_b64_tr_b16 v[112:113], v9 offset:128
    v_mfma_f32_16x16x32_bf16 v[40:43], v[184:187], v[160:163], v[40:43]
    ds_read_b64_tr_b16 v[114:115], v9 offset:1408
    ds_read_b64_tr_b16 v[116:117], v10 offset:160
    v_mfma_f32_16x16x32_bf16 v[80:83], v[188:191], v[160:163], v[80:83]
    ds_read_b64_tr_b16 v[118:119], v10 offset:1440
    v_mfma_f32_16x16x32_bf16 v[44:47], v[184:187], v[164:167], v[44:47]
    ds_read_b64_tr_b16 v[120:121], v9 offset:192
    v_mfma_f32_16x16x32_bf16 v[84:87], v[188:191], v[164:167], v[84:87]
    ds_read_b64_tr_b16 v[122:123], v9 offset:1472
    ds_read_b64_tr_b16 v[124:125], v10 offset:224
    v_mfma_f32_16x16x32_bf16 v[48:51], v[184:187], v[168:171], v[48:51]
    ds_read_b64_tr_b16 v[126:127], v10 offset:1504
    v_mfma_f32_16x16x32_bf16 v[88:91], v[188:191], v[168:171], v[88:91]
    ds_read_b64_tr_b16 v[128:129], v9 offset:256
    ds_read_b64_tr_b16 v[130:131], v9 offset:1536
    v_mfma_f32_16x16x32_bf16 v[52:55], v[184:187], v[172:175], v[52:55]
    ds_read_b64_tr_b16 v[132:133], v10 offset:288
    v_mfma_f32_16x16x32_bf16 v[92:95], v[188:191], v[172:175], v[92:95]
    ds_read_b64_tr_b16 v[134:135], v10 offset:1568
    s_waitcnt lgkmcnt(11)
    v_mfma_f32_16x16x32_bf16 v[16:19], v[192:195], v[96:99], v[16:19]
    ds_read_b64_tr_b16 v[136:137], v9 offset:10240
    v_mfma_f32_16x16x32_bf16 v[56:59], v[196:199], v[96:99], v[56:59]
    ds_read_b64_tr_b16 v[138:139], v9 offset:11520
    v_mfma_f32_16x16x32_bf16 v[20:23], v[192:195], v[100:103], v[20:23]
    ds_read_b64_tr_b16 v[140:141], v10 offset:10272
    v_mfma_f32_16x16x32_bf16 v[60:63], v[196:199], v[100:103], v[60:63]
    ds_read_b64_tr_b16 v[142:143], v10 offset:11552
    v_mfma_f32_16x16x32_bf16 v[24:27], v[192:195], v[104:107], v[24:27]
    ds_read_b64_tr_b16 v[144:145], v9 offset:10304
    v_mfma_f32_16x16x32_bf16 v[64:67], v[196:199], v[104:107], v[64:67]
    ds_read_b64_tr_b16 v[146:147], v9 offset:11584
    v_mfma_f32_16x16x32_bf16 v[28:31], v[192:195], v[108:111], v[28:31]
    ds_read_b64_tr_b16 v[148:149], v10 offset:10336
    v_mfma_f32_16x16x32_bf16 v[68:71], v[196:199], v[108:111], v[68:71]
    ds_read_b64_tr_b16 v[150:151], v10 offset:11616
    s_waitcnt lgkmcnt(10)
    v_mfma_f32_16x16x32_bf16 v[32:35], v[192:195], v[112:115], v[32:35]
    ds_read_b64_tr_b16 v[152:153], v9 offset:10368
    v_mfma_f32_16x16x32_bf16 v[72:75], v[196:199], v[112:115], v[72:75]
    ds_read_b64_tr_b16 v[154:155], v9 offset:11648
    v_mfma_f32_16x16x32_bf16 v[36:39], v[192:195], v[116:119], v[36:39]
    ds_read_b64_tr_b16 v[156:157], v10 offset:10400
    v_mfma_f32_16x16x32_bf16 v[76:79], v[196:199], v[116:119], v[76:79]
    ds_read_b64_tr_b16 v[158:159], v10 offset:11680
    v_mfma_f32_16x16x32_bf16 v[40:43], v[192:195], v[120:123], v[40:43]
    ds_read_b64_tr_b16 v[160:161], v9 offset:10432
    v_mfma_f32_16x16x32_bf16 v[80:83], v[196:199], v[120:123], v[80:83]
    ds_read_b64_tr_b16 v[162:163], v9 offset:11712
    v_mfma_f32_16x16x32_bf16 v[44:47], v[192:195], v[124:127], v[44:47]
    ds_read_b64_tr_b16 v[164:165], v10 offset:10464
    v_mfma_f32_16x16x32_bf16 v[84:87], v[196:199], v[124:127], v[84:87]
    ds_read_b64_tr_b16 v[166:167], v10 offset:11744
    v_mfma_f32_16x16x32_bf16 v[48:51], v[192:195], v[128:131], v[48:51]
    ds_read_b64_tr_b16 v[168:169], v9 offset:10496
    v_mfma_f32_16x16x32_bf16 v[88:91], v[196:199], v[128:131], v[88:91]
    ds_read_b64_tr_b16 v[170:171], v9 offset:11776
    s_waitcnt lgkmcnt(10)
    v_mfma_f32_16x16x32_bf16 v[52:55], v[192:195], v[132:135], v[52:55]
    ds_read_b64_tr_b16 v[172:173], v10 offset:10528
    v_mfma_f32_16x16x32_bf16 v[92:95], v[196:199], v[132:135], v[92:95]
    ds_read_b64_tr_b16 v[174:175], v10 offset:11808
    v_mfma_f32_16x16x32_bf16 v[16:19], v[200:203], v[136:139], v[16:19]
    v_mfma_f32_16x16x32_bf16 v[56:59], v[204:207], v[136:139], v[56:59]
    v_mfma_f32_16x16x32_bf16 v[20:23], v[200:203], v[140:143], v[20:23]
    s_waitcnt lgkmcnt(0)
    s_barrier
    v_mfma_f32_16x16x32_bf16 v[60:63], v[204:207], v[140:143], v[60:63]
    ds_read_b128 v[176:179], v4 offset:36864
    ds_read_b128 v[180:183], v4 offset:38912
    v_mfma_f32_16x16x32_bf16 v[24:27], v[200:203], v[144:147], v[24:27]
    ds_read_b128 v[184:187], v5 offset:36864
    v_mfma_f32_16x16x32_bf16 v[64:67], v[204:207], v[144:147], v[64:67]
    ds_read_b128 v[188:191], v5 offset:38912
    ds_read_b64_tr_b16 v[96:97], v2 offset:36864
    v_mfma_f32_16x16x32_bf16 v[28:31], v[200:203], v[148:151], v[28:31]
    ds_read_b64_tr_b16 v[98:99], v2 offset:38144
    v_mfma_f32_16x16x32_bf16 v[68:71], v[204:207], v[148:151], v[68:71]
    ds_read_b64_tr_b16 v[100:101], v3 offset:36896
    ds_read_b64_tr_b16 v[102:103], v3 offset:38176
    v_mfma_f32_16x16x32_bf16 v[32:35], v[200:203], v[152:155], v[32:35]
    ds_read_b64_tr_b16 v[104:105], v2 offset:36928
    v_mfma_f32_16x16x32_bf16 v[72:75], v[204:207], v[152:155], v[72:75]
    ds_read_b64_tr_b16 v[106:107], v2 offset:38208
    v_mfma_f32_16x16x32_bf16 v[36:39], v[200:203], v[156:159], v[36:39]
    ds_read_b64_tr_b16 v[108:109], v3 offset:36960
    ds_read_b64_tr_b16 v[110:111], v3 offset:38240
    v_mfma_f32_16x16x32_bf16 v[76:79], v[204:207], v[156:159], v[76:79]
    ds_read_b64_tr_b16 v[112:113], v2 offset:36992
    v_mfma_f32_16x16x32_bf16 v[40:43], v[200:203], v[160:163], v[40:43]
    ds_read_b64_tr_b16 v[114:115], v2 offset:38272
    ds_read_b64_tr_b16 v[116:117], v3 offset:37024
    v_mfma_f32_16x16x32_bf16 v[80:83], v[204:207], v[160:163], v[80:83]
    ds_read_b64_tr_b16 v[118:119], v3 offset:38304
    v_mfma_f32_16x16x32_bf16 v[44:47], v[200:203], v[164:167], v[44:47]
    ds_read_b64_tr_b16 v[120:121], v2 offset:37056
    v_mfma_f32_16x16x32_bf16 v[84:87], v[204:207], v[164:167], v[84:87]
    ds_read_b64_tr_b16 v[122:123], v2 offset:38336
    ds_read_b64_tr_b16 v[124:125], v3 offset:37088
    v_mfma_f32_16x16x32_bf16 v[48:51], v[200:203], v[168:171], v[48:51]
    ds_read_b64_tr_b16 v[126:127], v3 offset:38368
    v_mfma_f32_16x16x32_bf16 v[88:91], v[204:207], v[168:171], v[88:91]
    ds_read_b64_tr_b16 v[128:129], v2 offset:37120
    ds_read_b64_tr_b16 v[130:131], v2 offset:38400
    v_mfma_f32_16x16x32_bf16 v[52:55], v[200:203], v[172:175], v[52:55]
    ds_read_b64_tr_b16 v[132:133], v3 offset:37152
    v_mfma_f32_16x16x32_bf16 v[92:95], v[204:207], v[172:175], v[92:95]
    ds_read_b64_tr_b16 v[134:135], v3 offset:38432
    s_waitcnt lgkmcnt(11)
    v_mfma_f32_16x16x32_bf16 v[16:19], v[176:179], v[96:99], v[16:19]
    ds_read_b64_tr_b16 v[136:137], v2 offset:47104
    v_mfma_f32_16x16x32_bf16 v[56:59], v[180:183], v[96:99], v[56:59]
    ds_read_b64_tr_b16 v[138:139], v2 offset:48384
    v_mfma_f32_16x16x32_bf16 v[20:23], v[176:179], v[100:103], v[20:23]
    ds_read_b64_tr_b16 v[140:141], v3 offset:47136
    v_mfma_f32_16x16x32_bf16 v[60:63], v[180:183], v[100:103], v[60:63]
    ds_read_b64_tr_b16 v[142:143], v3 offset:48416
    v_mfma_f32_16x16x32_bf16 v[24:27], v[176:179], v[104:107], v[24:27]
    ds_read_b64_tr_b16 v[144:145], v2 offset:47168
    v_mfma_f32_16x16x32_bf16 v[64:67], v[180:183], v[104:107], v[64:67]
    ds_read_b64_tr_b16 v[146:147], v2 offset:48448
    v_mfma_f32_16x16x32_bf16 v[28:31], v[176:179], v[108:111], v[28:31]
    ds_read_b64_tr_b16 v[148:149], v3 offset:47200
    v_mfma_f32_16x16x32_bf16 v[68:71], v[180:183], v[108:111], v[68:71]
    ds_read_b64_tr_b16 v[150:151], v3 offset:48480
    s_waitcnt lgkmcnt(10)
    v_mfma_f32_16x16x32_bf16 v[32:35], v[176:179], v[112:115], v[32:35]
    ds_read_b64_tr_b16 v[152:153], v2 offset:47232
    v_mfma_f32_16x16x32_bf16 v[72:75], v[180:183], v[112:115], v[72:75]
    ds_read_b64_tr_b16 v[154:155], v2 offset:48512
    v_mfma_f32_16x16x32_bf16 v[36:39], v[176:179], v[116:119], v[36:39]
    ds_read_b64_tr_b16 v[156:157], v3 offset:47264
    v_mfma_f32_16x16x32_bf16 v[76:79], v[180:183], v[116:119], v[76:79]
    ds_read_b64_tr_b16 v[158:159], v3 offset:48544
    v_mfma_f32_16x16x32_bf16 v[40:43], v[176:179], v[120:123], v[40:43]
    ds_read_b64_tr_b16 v[160:161], v2 offset:47296
    v_mfma_f32_16x16x32_bf16 v[80:83], v[180:183], v[120:123], v[80:83]
    ds_read_b64_tr_b16 v[162:163], v2 offset:48576
    v_mfma_f32_16x16x32_bf16 v[44:47], v[176:179], v[124:127], v[44:47]
    ds_read_b64_tr_b16 v[164:165], v3 offset:47328
    v_mfma_f32_16x16x32_bf16 v[84:87], v[180:183], v[124:127], v[84:87]
    ds_read_b64_tr_b16 v[166:167], v3 offset:48608
    v_mfma_f32_16x16x32_bf16 v[48:51], v[176:179], v[128:131], v[48:51]
    ds_read_b64_tr_b16 v[168:169], v2 offset:47360
    v_mfma_f32_16x16x32_bf16 v[88:91], v[180:183], v[128:131], v[88:91]
    ds_read_b64_tr_b16 v[170:171], v2 offset:48640
    s_waitcnt lgkmcnt(10)
    v_mfma_f32_16x16x32_bf16 v[52:55], v[176:179], v[132:135], v[52:55]
    ds_read_b64_tr_b16 v[172:173], v3 offset:47392
    v_mfma_f32_16x16x32_bf16 v[92:95], v[180:183], v[132:135], v[92:95]
    ds_read_b64_tr_b16 v[174:175], v3 offset:48672
    v_mfma_f32_16x16x32_bf16 v[16:19], v[184:187], v[136:139], v[16:19]
    v_mfma_f32_16x16x32_bf16 v[56:59], v[188:191], v[136:139], v[56:59]
    v_mfma_f32_16x16x32_bf16 v[20:23], v[184:187], v[140:143], v[20:23]
    s_waitcnt lgkmcnt(0)
    s_barrier
    v_mfma_f32_16x16x32_bf16 v[60:63], v[188:191], v[140:143], v[60:63]
    ds_read_b128 v[192:195], v4 offset:0
    ds_read_b128 v[196:199], v4 offset:2048
    v_mfma_f32_16x16x32_bf16 v[24:27], v[184:187], v[144:147], v[24:27]
    ds_read_b128 v[200:203], v5 offset:0
    v_mfma_f32_16x16x32_bf16 v[64:67], v[188:191], v[144:147], v[64:67]
    ds_read_b128 v[204:207], v5 offset:2048
    ds_read_b64_tr_b16 v[96:97], v2 offset:0
    v_mfma_f32_16x16x32_bf16 v[28:31], v[184:187], v[148:151], v[28:31]
    ds_read_b64_tr_b16 v[98:99], v2 offset:1280
    v_mfma_f32_16x16x32_bf16 v[68:71], v[188:191], v[148:151], v[68:71]
    ds_read_b64_tr_b16 v[100:101], v3 offset:32
    ds_read_b64_tr_b16 v[102:103], v3 offset:1312
    v_mfma_f32_16x16x32_bf16 v[32:35], v[184:187], v[152:155], v[32:35]
    ds_read_b64_tr_b16 v[104:105], v2 offset:64
    v_mfma_f32_16x16x32_bf16 v[72:75], v[188:191], v[152:155], v[72:75]
    ds_read_b64_tr_b16 v[106:107], v2 offset:1344
    v_mfma_f32_16x16x32_bf16 v[36:39], v[184:187], v[156:159], v[36:39]
    ds_read_b64_tr_b16 v[108:109], v3 offset:96
    ds_read_b64_tr_b16 v[110:111], v3 offset:1376
    v_mfma_f32_16x16x32_bf16 v[76:79], v[188:191], v[156:159], v[76:79]
    ds_read_b64_tr_b16 v[112:113], v2 offset:128
    v_mfma_f32_16x16x32_bf16 v[40:43], v[184:187], v[160:163], v[40:43]
    ds_read_b64_tr_b16 v[114:115], v2 offset:1408
    ds_read_b64_tr_b16 v[116:117], v3 offset:160
    v_mfma_f32_16x16x32_bf16 v[80:83], v[188:191], v[160:163], v[80:83]
    ds_read_b64_tr_b16 v[118:119], v3 offset:1440
    v_mfma_f32_16x16x32_bf16 v[44:47], v[184:187], v[164:167], v[44:47]
    ds_read_b64_tr_b16 v[120:121], v2 offset:192
    v_mfma_f32_16x16x32_bf16 v[84:87], v[188:191], v[164:167], v[84:87]
    ds_read_b64_tr_b16 v[122:123], v2 offset:1472
    ds_read_b64_tr_b16 v[124:125], v3 offset:224
    v_mfma_f32_16x16x32_bf16 v[48:51], v[184:187], v[168:171], v[48:51]
    ds_read_b64_tr_b16 v[126:127], v3 offset:1504
    v_mfma_f32_16x16x32_bf16 v[88:91], v[188:191], v[168:171], v[88:91]
    ds_read_b64_tr_b16 v[128:129], v2 offset:256
    ds_read_b64_tr_b16 v[130:131], v2 offset:1536
    v_mfma_f32_16x16x32_bf16 v[52:55], v[184:187], v[172:175], v[52:55]
    ds_read_b64_tr_b16 v[132:133], v3 offset:288
    v_mfma_f32_16x16x32_bf16 v[92:95], v[188:191], v[172:175], v[92:95]
    ds_read_b64_tr_b16 v[134:135], v3 offset:1568
    s_waitcnt lgkmcnt(11)
    v_mfma_f32_16x16x32_bf16 v[16:19], v[192:195], v[96:99], v[16:19]
    ds_read_b64_tr_b16 v[136:137], v2 offset:10240
    v_mfma_f32_16x16x32_bf16 v[56:59], v[196:199], v[96:99], v[56:59]
    ds_read_b64_tr_b16 v[138:139], v2 offset:11520
    v_mfma_f32_16x16x32_bf16 v[20:23], v[192:195], v[100:103], v[20:23]
    ds_read_b64_tr_b16 v[140:141], v3 offset:10272
    v_mfma_f32_16x16x32_bf16 v[60:63], v[196:199], v[100:103], v[60:63]
    ds_read_b64_tr_b16 v[142:143], v3 offset:11552
    v_mfma_f32_16x16x32_bf16 v[24:27], v[192:195], v[104:107], v[24:27]
    ds_read_b64_tr_b16 v[144:145], v2 offset:10304
    v_mfma_f32_16x16x32_bf16 v[64:67], v[196:199], v[104:107], v[64:67]
    ds_read_b64_tr_b16 v[146:147], v2 offset:11584
    v_mfma_f32_16x16x32_bf16 v[28:31], v[192:195], v[108:111], v[28:31]
    ds_read_b64_tr_b16 v[148:149], v3 offset:10336
    v_mfma_f32_16x16x32_bf16 v[68:71], v[196:199], v[108:111], v[68:71]
    ds_read_b64_tr_b16 v[150:151], v3 offset:11616
    s_waitcnt lgkmcnt(10)
    v_mfma_f32_16x16x32_bf16 v[32:35], v[192:195], v[112:115], v[32:35]
    ds_read_b64_tr_b16 v[152:153], v2 offset:10368
    v_mfma_f32_16x16x32_bf16 v[72:75], v[196:199], v[112:115], v[72:75]
    ds_read_b64_tr_b16 v[154:155], v2 offset:11648
    v_mfma_f32_16x16x32_bf16 v[36:39], v[192:195], v[116:119], v[36:39]
    ds_read_b64_tr_b16 v[156:157], v3 offset:10400
    v_mfma_f32_16x16x32_bf16 v[76:79], v[196:199], v[116:119], v[76:79]
    ds_read_b64_tr_b16 v[158:159], v3 offset:11680
    v_mfma_f32_16x16x32_bf16 v[40:43], v[192:195], v[120:123], v[40:43]
    ds_read_b64_tr_b16 v[160:161], v2 offset:10432
    v_mfma_f32_16x16x32_bf16 v[80:83], v[196:199], v[120:123], v[80:83]
    ds_read_b64_tr_b16 v[162:163], v2 offset:11712
    v_mfma_f32_16x16x32_bf16 v[44:47], v[192:195], v[124:127], v[44:47]
    ds_read_b64_tr_b16 v[164:165], v3 offset:10464
    v_mfma_f32_16x16x32_bf16 v[84:87], v[196:199], v[124:127], v[84:87]
    ds_read_b64_tr_b16 v[166:167], v3 offset:11744
    v_mfma_f32_16x16x32_bf16 v[48:51], v[192:195], v[128:131], v[48:51]
    ds_read_b64_tr_b16 v[168:169], v2 offset:10496
    v_mfma_f32_16x16x32_bf16 v[88:91], v[196:199], v[128:131], v[88:91]
    ds_read_b64_tr_b16 v[170:171], v2 offset:11776
    s_waitcnt lgkmcnt(10)
    v_mfma_f32_16x16x32_bf16 v[52:55], v[192:195], v[132:135], v[52:55]
    ds_read_b64_tr_b16 v[172:173], v3 offset:10528
    v_mfma_f32_16x16x32_bf16 v[92:95], v[196:199], v[132:135], v[92:95]
    ds_read_b64_tr_b16 v[174:175], v3 offset:11808
    v_mfma_f32_16x16x32_bf16 v[16:19], v[200:203], v[136:139], v[16:19]
    v_mfma_f32_16x16x32_bf16 v[56:59], v[204:207], v[136:139], v[56:59]
    v_mfma_f32_16x16x32_bf16 v[20:23], v[200:203], v[140:143], v[20:23]
    s_waitcnt lgkmcnt(0)
    s_barrier
    v_mfma_f32_16x16x32_bf16 v[60:63], v[204:207], v[140:143], v[60:63]
    ds_read_b128 v[176:179], v11 offset:36864
    ds_read_b128 v[180:183], v11 offset:38912
    v_mfma_f32_16x16x32_bf16 v[24:27], v[200:203], v[144:147], v[24:27]
    ds_read_b128 v[184:187], v12 offset:36864
    v_mfma_f32_16x16x32_bf16 v[64:67], v[204:207], v[144:147], v[64:67]
    ds_read_b128 v[188:191], v12 offset:38912
    ds_read_b64_tr_b16 v[96:97], v9 offset:36864
    v_mfma_f32_16x16x32_bf16 v[28:31], v[200:203], v[148:151], v[28:31]
    ds_read_b64_tr_b16 v[98:99], v9 offset:38144
    v_mfma_f32_16x16x32_bf16 v[68:71], v[204:207], v[148:151], v[68:71]
    ds_read_b64_tr_b16 v[100:101], v10 offset:36896
    ds_read_b64_tr_b16 v[102:103], v10 offset:38176
    v_mfma_f32_16x16x32_bf16 v[32:35], v[200:203], v[152:155], v[32:35]
    ds_read_b64_tr_b16 v[104:105], v9 offset:36928
    v_mfma_f32_16x16x32_bf16 v[72:75], v[204:207], v[152:155], v[72:75]
    ds_read_b64_tr_b16 v[106:107], v9 offset:38208
    v_mfma_f32_16x16x32_bf16 v[36:39], v[200:203], v[156:159], v[36:39]
    ds_read_b64_tr_b16 v[108:109], v10 offset:36960
    ds_read_b64_tr_b16 v[110:111], v10 offset:38240
    v_mfma_f32_16x16x32_bf16 v[76:79], v[204:207], v[156:159], v[76:79]
    ds_read_b64_tr_b16 v[112:113], v9 offset:36992
    v_mfma_f32_16x16x32_bf16 v[40:43], v[200:203], v[160:163], v[40:43]
    ds_read_b64_tr_b16 v[114:115], v9 offset:38272
    ds_read_b64_tr_b16 v[116:117], v10 offset:37024
    v_mfma_f32_16x16x32_bf16 v[80:83], v[204:207], v[160:163], v[80:83]
    ds_read_b64_tr_b16 v[118:119], v10 offset:38304
    v_mfma_f32_16x16x32_bf16 v[44:47], v[200:203], v[164:167], v[44:47]
    ds_read_b64_tr_b16 v[120:121], v9 offset:37056
    v_mfma_f32_16x16x32_bf16 v[84:87], v[204:207], v[164:167], v[84:87]
    ds_read_b64_tr_b16 v[122:123], v9 offset:38336
    ds_read_b64_tr_b16 v[124:125], v10 offset:37088
    v_mfma_f32_16x16x32_bf16 v[48:51], v[200:203], v[168:171], v[48:51]
    ds_read_b64_tr_b16 v[126:127], v10 offset:38368
    v_mfma_f32_16x16x32_bf16 v[88:91], v[204:207], v[168:171], v[88:91]
    ds_read_b64_tr_b16 v[128:129], v9 offset:37120
    ds_read_b64_tr_b16 v[130:131], v9 offset:38400
    v_mfma_f32_16x16x32_bf16 v[52:55], v[200:203], v[172:175], v[52:55]
    ds_read_b64_tr_b16 v[132:133], v10 offset:37152
    v_mfma_f32_16x16x32_bf16 v[92:95], v[204:207], v[172:175], v[92:95]
    ds_read_b64_tr_b16 v[134:135], v10 offset:38432
    s_waitcnt lgkmcnt(11)
    v_mfma_f32_16x16x32_bf16 v[16:19], v[176:179], v[96:99], v[16:19]
    ds_read_b64_tr_b16 v[136:137], v9 offset:47104
    v_mfma_f32_16x16x32_bf16 v[56:59], v[180:183], v[96:99], v[56:59]
    ds_read_b64_tr_b16 v[138:139], v9 offset:48384
    v_mfma_f32_16x16x32_bf16 v[20:23], v[176:179], v[100:103], v[20:23]
    ds_read_b64_tr_b16 v[140:141], v10 offset:47136
    v_mfma_f32_16x16x32_bf16 v[60:63], v[180:183], v[100:103], v[60:63]
    ds_read_b64_tr_b16 v[142:143], v10 offset:48416
    v_mfma_f32_16x16x32_bf16 v[24:27], v[176:179], v[104:107], v[24:27]
    ds_read_b64_tr_b16 v[144:145], v9 offset:47168
    v_mfma_f32_16x16x32_bf16 v[64:67], v[180:183], v[104:107], v[64:67]
    ds_read_b64_tr_b16 v[146:147], v9 offset:48448
    v_mfma_f32_16x16x32_bf16 v[28:31], v[176:179], v[108:111], v[28:31]
    ds_read_b64_tr_b16 v[148:149], v10 offset:47200
    v_mfma_f32_16x16x32_bf16 v[68:71], v[180:183], v[108:111], v[68:71]
    ds_read_b64_tr_b16 v[150:151], v10 offset:48480
    s_waitcnt lgkmcnt(10)
    v_mfma_f32_16x16x32_bf16 v[32:35], v[176:179], v[112:115], v[32:35]
    ds_read_b64_tr_b16 v[152:153], v9 offset:47232
    v_mfma_f32_16x16x32_bf16 v[72:75], v[180:183], v[112:115], v[72:75]
    ds_read_b64_tr_b16 v[154:155], v9 offset:48512
    v_mfma_f32_16x16x32_bf16 v[36:39], v[176:179], v[116:119], v[36:39]
    ds_read_b64_tr_b16 v[156:157], v10 offset:47264
    v_mfma_f32_16x16x32_bf16 v[76:79], v[180:183], v[116:119], v[76:79]
    ds_read_b64_tr_b16 v[158:159], v10 offset:48544
    v_mfma_f32_16x16x32_bf16 v[40:43], v[176:179], v[120:123], v[40:43]
    ds_read_b64_tr_b16 v[160:161], v9 offset:47296
    v_mfma_f32_16x16x32_bf16 v[80:83], v[180:183], v[120:123], v[80:83]
    ds_read_b64_tr_b16 v[162:163], v9 offset:48576
    v_mfma_f32_16x16x32_bf16 v[44:47], v[176:179], v[124:127], v[44:47]
    ds_read_b64_tr_b16 v[164:165], v10 offset:47328
    v_mfma_f32_16x16x32_bf16 v[84:87], v[180:183], v[124:127], v[84:87]
    ds_read_b64_tr_b16 v[166:167], v10 offset:48608
    v_mfma_f32_16x16x32_bf16 v[48:51], v[176:179], v[128:131], v[48:51]
    ds_read_b64_tr_b16 v[168:169], v9 offset:47360
    v_mfma_f32_16x16x32_bf16 v[88:91], v[180:183], v[128:131], v[88:91]
    ds_read_b64_tr_b16 v[170:171], v9 offset:48640
    s_waitcnt lgkmcnt(10)
    v_mfma_f32_16x16x32_bf16 v[52:55], v[176:179], v[132:135], v[52:55]
    ds_read_b64_tr_b16 v[172:173], v10 offset:47392
    v_mfma_f32_16x16x32_bf16 v[92:95], v[180:183], v[132:135], v[92:95]
    ds_read_b64_tr_b16 v[174:175], v10 offset:48672
    v_mfma_f32_16x16x32_bf16 v[16:19], v[184:187], v[136:139], v[16:19]
    v_mfma_f32_16x16x32_bf16 v[56:59], v[188:191], v[136:139], v[56:59]
    v_mfma_f32_16x16x32_bf16 v[20:23], v[184:187], v[140:143], v[20:23]
    s_waitcnt lgkmcnt(0)
    s_barrier
    v_mfma_f32_16x16x32_bf16 v[60:63], v[188:191], v[140:143], v[60:63]
    ds_read_b128 v[192:195], v11 offset:0
    ds_read_b128 v[196:199], v11 offset:2048
    v_mfma_f32_16x16x32_bf16 v[24:27], v[184:187], v[144:147], v[24:27]
    ds_read_b128 v[200:203], v12 offset:0
    v_mfma_f32_16x16x32_bf16 v[64:67], v[188:191], v[144:147], v[64:67]
    ds_read_b128 v[204:207], v12 offset:2048
    ds_read_b64_tr_b16 v[96:97], v9 offset:0
    v_mfma_f32_16x16x32_bf16 v[28:31], v[184:187], v[148:151], v[28:31]
    ds_read_b64_tr_b16 v[98:99], v9 offset:1280
    v_mfma_f32_16x16x32_bf16 v[68:71], v[188:191], v[148:151], v[68:71]
    ds_read_b64_tr_b16 v[100:101], v10 offset:32
    ds_read_b64_tr_b16 v[102:103], v10 offset:1312
    v_mfma_f32_16x16x32_bf16 v[32:35], v[184:187], v[152:155], v[32:35]
    ds_read_b64_tr_b16 v[104:105], v9 offset:64
    v_mfma_f32_16x16x32_bf16 v[72:75], v[188:191], v[152:155], v[72:75]
    ds_read_b64_tr_b16 v[106:107], v9 offset:1344
    v_mfma_f32_16x16x32_bf16 v[36:39], v[184:187], v[156:159], v[36:39]
    ds_read_b64_tr_b16 v[108:109], v10 offset:96
    ds_read_b64_tr_b16 v[110:111], v10 offset:1376
    v_mfma_f32_16x16x32_bf16 v[76:79], v[188:191], v[156:159], v[76:79]
    ds_read_b64_tr_b16 v[112:113], v9 offset:128
    v_mfma_f32_16x16x32_bf16 v[40:43], v[184:187], v[160:163], v[40:43]
    ds_read_b64_tr_b16 v[114:115], v9 offset:1408
    ds_read_b64_tr_b16 v[116:117], v10 offset:160
    v_mfma_f32_16x16x32_bf16 v[80:83], v[188:191], v[160:163], v[80:83]
    ds_read_b64_tr_b16 v[118:119], v10 offset:1440
    v_mfma_f32_16x16x32_bf16 v[44:47], v[184:187], v[164:167], v[44:47]
    ds_read_b64_tr_b16 v[120:121], v9 offset:192
    v_mfma_f32_16x16x32_bf16 v[84:87], v[188:191], v[164:167], v[84:87]
    ds_read_b64_tr_b16 v[122:123], v9 offset:1472
    ds_read_b64_tr_b16 v[124:125], v10 offset:224
    v_mfma_f32_16x16x32_bf16 v[48:51], v[184:187], v[168:171], v[48:51]
    ds_read_b64_tr_b16 v[126:127], v10 offset:1504
    v_mfma_f32_16x16x32_bf16 v[88:91], v[188:191], v[168:171], v[88:91]
    ds_read_b64_tr_b16 v[128:129], v9 offset:256
    ds_read_b64_tr_b16 v[130:131], v9 offset:1536
    v_mfma_f32_16x16x32_bf16 v[52:55], v[184:187], v[172:175], v[52:55]
    ds_read_b64_tr_b16 v[132:133], v10 offset:288
    v_mfma_f32_16x16x32_bf16 v[92:95], v[188:191], v[172:175], v[92:95]
    ds_read_b64_tr_b16 v[134:135], v10 offset:1568
    s_waitcnt lgkmcnt(11)
    v_mfma_f32_16x16x32_bf16 v[16:19], v[192:195], v[96:99], v[16:19]
    ds_read_b64_tr_b16 v[136:137], v9 offset:10240
    v_mfma_f32_16x16x32_bf16 v[56:59], v[196:199], v[96:99], v[56:59]
    ds_read_b64_tr_b16 v[138:139], v9 offset:11520
    v_mfma_f32_16x16x32_bf16 v[20:23], v[192:195], v[100:103], v[20:23]
    ds_read_b64_tr_b16 v[140:141], v10 offset:10272
    v_mfma_f32_16x16x32_bf16 v[60:63], v[196:199], v[100:103], v[60:63]
    ds_read_b64_tr_b16 v[142:143], v10 offset:11552
    v_mfma_f32_16x16x32_bf16 v[24:27], v[192:195], v[104:107], v[24:27]
    ds_read_b64_tr_b16 v[144:145], v9 offset:10304
    v_mfma_f32_16x16x32_bf16 v[64:67], v[196:199], v[104:107], v[64:67]
    ds_read_b64_tr_b16 v[146:147], v9 offset:11584
    v_mfma_f32_16x16x32_bf16 v[28:31], v[192:195], v[108:111], v[28:31]
    ds_read_b64_tr_b16 v[148:149], v10 offset:10336
    v_mfma_f32_16x16x32_bf16 v[68:71], v[196:199], v[108:111], v[68:71]
    ds_read_b64_tr_b16 v[150:151], v10 offset:11616
    s_waitcnt lgkmcnt(10)
    v_mfma_f32_16x16x32_bf16 v[32:35], v[192:195], v[112:115], v[32:35]
    ds_read_b64_tr_b16 v[152:153], v9 offset:10368
    v_mfma_f32_16x16x32_bf16 v[72:75], v[196:199], v[112:115], v[72:75]
    ds_read_b64_tr_b16 v[154:155], v9 offset:11648
    v_mfma_f32_16x16x32_bf16 v[36:39], v[192:195], v[116:119], v[36:39]
    ds_read_b64_tr_b16 v[156:157], v10 offset:10400
    v_mfma_f32_16x16x32_bf16 v[76:79], v[196:199], v[116:119], v[76:79]
    ds_read_b64_tr_b16 v[158:159], v10 offset:11680
    v_mfma_f32_16x16x32_bf16 v[40:43], v[192:195], v[120:123], v[40:43]
    ds_read_b64_tr_b16 v[160:161], v9 offset:10432
    v_mfma_f32_16x16x32_bf16 v[80:83], v[196:199], v[120:123], v[80:83]
    ds_read_b64_tr_b16 v[162:163], v9 offset:11712
    v_mfma_f32_16x16x32_bf16 v[44:47], v[192:195], v[124:127], v[44:47]
    ds_read_b64_tr_b16 v[164:165], v10 offset:10464
    v_mfma_f32_16x16x32_bf16 v[84:87], v[196:199], v[124:127], v[84:87]
    ds_read_b64_tr_b16 v[166:167], v10 offset:11744
    v_mfma_f32_16x16x32_bf16 v[48:51], v[192:195], v[128:131], v[48:51]
    ds_read_b64_tr_b16 v[168:169], v9 offset:10496
    v_mfma_f32_16x16x32_bf16 v[88:91], v[196:199], v[128:131], v[88:91]
    ds_read_b64_tr_b16 v[170:171], v9 offset:11776
    s_waitcnt lgkmcnt(10)
    v_mfma_f32_16x16x32_bf16 v[52:55], v[192:195], v[132:135], v[52:55]
    ds_read_b64_tr_b16 v[172:173], v10 offset:10528
    v_mfma_f32_16x16x32_bf16 v[92:95], v[196:199], v[132:135], v[92:95]
    ds_read_b64_tr_b16 v[174:175], v10 offset:11808
    v_mfma_f32_16x16x32_bf16 v[16:19], v[200:203], v[136:139], v[16:19]
    v_mfma_f32_16x16x32_bf16 v[56:59], v[204:207], v[136:139], v[56:59]
    v_mfma_f32_16x16x32_bf16 v[20:23], v[200:203], v[140:143], v[20:23]
    s_waitcnt lgkmcnt(0)
    s_barrier
    v_mfma_f32_16x16x32_bf16 v[60:63], v[204:207], v[140:143], v[60:63]
    ds_read_b128 v[176:179], v4 offset:36864
    ds_read_b128 v[180:183], v4 offset:38912
    v_mfma_f32_16x16x32_bf16 v[24:27], v[200:203], v[144:147], v[24:27]
    ds_read_b128 v[184:187], v5 offset:36864
    v_mfma_f32_16x16x32_bf16 v[64:67], v[204:207], v[144:147], v[64:67]
    ds_read_b128 v[188:191], v5 offset:38912
    ds_read_b64_tr_b16 v[96:97], v2 offset:36864
    v_mfma_f32_16x16x32_bf16 v[28:31], v[200:203], v[148:151], v[28:31]
    ds_read_b64_tr_b16 v[98:99], v2 offset:38144
    v_mfma_f32_16x16x32_bf16 v[68:71], v[204:207], v[148:151], v[68:71]
    ds_read_b64_tr_b16 v[100:101], v3 offset:36896
    ds_read_b64_tr_b16 v[102:103], v3 offset:38176
    v_mfma_f32_16x16x32_bf16 v[32:35], v[200:203], v[152:155], v[32:35]
    ds_read_b64_tr_b16 v[104:105], v2 offset:36928
    v_mfma_f32_16x16x32_bf16 v[72:75], v[204:207], v[152:155], v[72:75]
    ds_read_b64_tr_b16 v[106:107], v2 offset:38208
    v_mfma_f32_16x16x32_bf16 v[36:39], v[200:203], v[156:159], v[36:39]
    ds_read_b64_tr_b16 v[108:109], v3 offset:36960
    ds_read_b64_tr_b16 v[110:111], v3 offset:38240
    v_mfma_f32_16x16x32_bf16 v[76:79], v[204:207], v[156:159], v[76:79]
    ds_read_b64_tr_b16 v[112:113], v2 offset:36992
    v_mfma_f32_16x16x32_bf16 v[40:43], v[200:203], v[160:163], v[40:43]
    ds_read_b64_tr_b16 v[114:115], v2 offset:38272
    ds_read_b64_tr_b16 v[116:117], v3 offset:37024
    v_mfma_f32_16x16x32_bf16 v[80:83], v[204:207], v[160:163], v[80:83]
    ds_read_b64_tr_b16 v[118:119], v3 offset:38304
    v_mfma_f32_16x16x32_bf16 v[44:47], v[200:203], v[164:167], v[44:47]
    ds_read_b64_tr_b16 v[120:121], v2 offset:37056
    v_mfma_f32_16x16x32_bf16 v[84:87], v[204:207], v[164:167], v[84:87]
    ds_read_b64_tr_b16 v[122:123], v2 offset:38336
    ds_read_b64_tr_b16 v[124:125], v3 offset:37088
    v_mfma_f32_16x16x32_bf16 v[48:51], v[200:203], v[168:171], v[48:51]
    ds_read_b64_tr_b16 v[126:127], v3 offset:38368
    v_mfma_f32_16x16x32_bf16 v[88:91], v[204:207], v[168:171], v[88:91]
    ds_read_b64_tr_b16 v[128:129], v2 offset:37120
    ds_read_b64_tr_b16 v[130:131], v2 offset:38400
    v_mfma_f32_16x16x32_bf16 v[52:55], v[200:203], v[172:175], v[52:55]
    ds_read_b64_tr_b16 v[132:133], v3 offset:37152
    v_mfma_f32_16x16x32_bf16 v[92:95], v[204:207], v[172:175], v[92:95]
    ds_read_b64_tr_b16 v[134:135], v3 offset:38432
    s_waitcnt lgkmcnt(11)
    v_mfma_f32_16x16x32_bf16 v[16:19], v[176:179], v[96:99], v[16:19]
    ds_read_b64_tr_b16 v[136:137], v2 offset:47104
    v_mfma_f32_16x16x32_bf16 v[56:59], v[180:183], v[96:99], v[56:59]
    ds_read_b64_tr_b16 v[138:139], v2 offset:48384
    v_mfma_f32_16x16x32_bf16 v[20:23], v[176:179], v[100:103], v[20:23]
    ds_read_b64_tr_b16 v[140:141], v3 offset:47136
    v_mfma_f32_16x16x32_bf16 v[60:63], v[180:183], v[100:103], v[60:63]
    ds_read_b64_tr_b16 v[142:143], v3 offset:48416
    v_mfma_f32_16x16x32_bf16 v[24:27], v[176:179], v[104:107], v[24:27]
    ds_read_b64_tr_b16 v[144:145], v2 offset:47168
    v_mfma_f32_16x16x32_bf16 v[64:67], v[180:183], v[104:107], v[64:67]
    ds_read_b64_tr_b16 v[146:147], v2 offset:48448
    v_mfma_f32_16x16x32_bf16 v[28:31], v[176:179], v[108:111], v[28:31]
    ds_read_b64_tr_b16 v[148:149], v3 offset:47200
    v_mfma_f32_16x16x32_bf16 v[68:71], v[180:183], v[108:111], v[68:71]
    ds_read_b64_tr_b16 v[150:151], v3 offset:48480
    s_waitcnt lgkmcnt(10)
    v_mfma_f32_16x16x32_bf16 v[32:35], v[176:179], v[112:115], v[32:35]
    ds_read_b64_tr_b16 v[152:153], v2 offset:47232
    v_mfma_f32_16x16x32_bf16 v[72:75], v[180:183], v[112:115], v[72:75]
    ds_read_b64_tr_b16 v[154:155], v2 offset:48512
    v_mfma_f32_16x16x32_bf16 v[36:39], v[176:179], v[116:119], v[36:39]
    ds_read_b64_tr_b16 v[156:157], v3 offset:47264
    v_mfma_f32_16x16x32_bf16 v[76:79], v[180:183], v[116:119], v[76:79]
    ds_read_b64_tr_b16 v[158:159], v3 offset:48544
    v_mfma_f32_16x16x32_bf16 v[40:43], v[176:179], v[120:123], v[40:43]
    ds_read_b64_tr_b16 v[160:161], v2 offset:47296
    v_mfma_f32_16x16x32_bf16 v[80:83], v[180:183], v[120:123], v[80:83]
    ds_read_b64_tr_b16 v[162:163], v2 offset:48576
    v_mfma_f32_16x16x32_bf16 v[44:47], v[176:179], v[124:127], v[44:47]
    ds_read_b64_tr_b16 v[164:165], v3 offset:47328
    v_mfma_f32_16x16x32_bf16 v[84:87], v[180:183], v[124:127], v[84:87]
    ds_read_b64_tr_b16 v[166:167], v3 offset:48608
    v_mfma_f32_16x16x32_bf16 v[48:51], v[176:179], v[128:131], v[48:51]
    ds_read_b64_tr_b16 v[168:169], v2 offset:47360
    v_mfma_f32_16x16x32_bf16 v[88:91], v[180:183], v[128:131], v[88:91]
    ds_read_b64_tr_b16 v[170:171], v2 offset:48640
    s_waitcnt lgkmcnt(10)
    v_mfma_f32_16x16x32_bf16 v[52:55], v[176:179], v[132:135], v[52:55]
    ds_read_b64_tr_b16 v[172:173], v3 offset:47392
    v_mfma_f32_16x16x32_bf16 v[92:95], v[180:183], v[132:135], v[92:95]
    ds_read_b64_tr_b16 v[174:175], v3 offset:48672
    v_mfma_f32_16x16x32_bf16 v[16:19], v[184:187], v[136:139], v[16:19]
    v_mfma_f32_16x16x32_bf16 v[56:59], v[188:191], v[136:139], v[56:59]
    v_mfma_f32_16x16x32_bf16 v[20:23], v[184:187], v[140:143], v[20:23]
    s_waitcnt lgkmcnt(0)
    s_barrier
    v_mfma_f32_16x16x32_bf16 v[60:63], v[188:191], v[140:143], v[60:63]
    ds_read_b128 v[192:195], v4 offset:0
    ds_read_b128 v[196:199], v4 offset:2048
    v_mfma_f32_16x16x32_bf16 v[24:27], v[184:187], v[144:147], v[24:27]
    ds_read_b128 v[200:203], v5 offset:0
    v_mfma_f32_16x16x32_bf16 v[64:67], v[188:191], v[144:147], v[64:67]
    ds_read_b128 v[204:207], v5 offset:2048
    ds_read_b64_tr_b16 v[96:97], v2 offset:0
    v_mfma_f32_16x16x32_bf16 v[28:31], v[184:187], v[148:151], v[28:31]
    ds_read_b64_tr_b16 v[98:99], v2 offset:1280
    v_mfma_f32_16x16x32_bf16 v[68:71], v[188:191], v[148:151], v[68:71]
    ds_read_b64_tr_b16 v[100:101], v3 offset:32
    ds_read_b64_tr_b16 v[102:103], v3 offset:1312
    v_mfma_f32_16x16x32_bf16 v[32:35], v[184:187], v[152:155], v[32:35]
    ds_read_b64_tr_b16 v[104:105], v2 offset:64
    v_mfma_f32_16x16x32_bf16 v[72:75], v[188:191], v[152:155], v[72:75]
    ds_read_b64_tr_b16 v[106:107], v2 offset:1344
    v_mfma_f32_16x16x32_bf16 v[36:39], v[184:187], v[156:159], v[36:39]
    ds_read_b64_tr_b16 v[108:109], v3 offset:96
    ds_read_b64_tr_b16 v[110:111], v3 offset:1376
    v_mfma_f32_16x16x32_bf16 v[76:79], v[188:191], v[156:159], v[76:79]
    ds_read_b64_tr_b16 v[112:113], v2 offset:128
    v_mfma_f32_16x16x32_bf16 v[40:43], v[184:187], v[160:163], v[40:43]
    ds_read_b64_tr_b16 v[114:115], v2 offset:1408
    ds_read_b64_tr_b16 v[116:117], v3 offset:160
    v_mfma_f32_16x16x32_bf16 v[80:83], v[188:191], v[160:163], v[80:83]
    ds_read_b64_tr_b16 v[118:119], v3 offset:1440
    v_mfma_f32_16x16x32_bf16 v[44:47], v[184:187], v[164:167], v[44:47]
    ds_read_b64_tr_b16 v[120:121], v2 offset:192
    v_mfma_f32_16x16x32_bf16 v[84:87], v[188:191], v[164:167], v[84:87]
    ds_read_b64_tr_b16 v[122:123], v2 offset:1472
    ds_read_b64_tr_b16 v[124:125], v3 offset:224
    v_mfma_f32_16x16x32_bf16 v[48:51], v[184:187], v[168:171], v[48:51]
    ds_read_b64_tr_b16 v[126:127], v3 offset:1504
    v_mfma_f32_16x16x32_bf16 v[88:91], v[188:191], v[168:171], v[88:91]
    ds_read_b64_tr_b16 v[128:129], v2 offset:256
    ds_read_b64_tr_b16 v[130:131], v2 offset:1536
    v_mfma_f32_16x16x32_bf16 v[52:55], v[184:187], v[172:175], v[52:55]
    ds_read_b64_tr_b16 v[132:133], v3 offset:288
    v_mfma_f32_16x16x32_bf16 v[92:95], v[188:191], v[172:175], v[92:95]
    ds_read_b64_tr_b16 v[134:135], v3 offset:1568
    s_waitcnt lgkmcnt(11)
    v_mfma_f32_16x16x32_bf16 v[16:19], v[192:195], v[96:99], v[16:19]
    ds_read_b64_tr_b16 v[136:137], v2 offset:10240
    v_mfma_f32_16x16x32_bf16 v[56:59], v[196:199], v[96:99], v[56:59]
    ds_read_b64_tr_b16 v[138:139], v2 offset:11520
    v_mfma_f32_16x16x32_bf16 v[20:23], v[192:195], v[100:103], v[20:23]
    ds_read_b64_tr_b16 v[140:141], v3 offset:10272
    v_mfma_f32_16x16x32_bf16 v[60:63], v[196:199], v[100:103], v[60:63]
    ds_read_b64_tr_b16 v[142:143], v3 offset:11552
    v_mfma_f32_16x16x32_bf16 v[24:27], v[192:195], v[104:107], v[24:27]
    ds_read_b64_tr_b16 v[144:145], v2 offset:10304
    v_mfma_f32_16x16x32_bf16 v[64:67], v[196:199], v[104:107], v[64:67]
    ds_read_b64_tr_b16 v[146:147], v2 offset:11584
    v_mfma_f32_16x16x32_bf16 v[28:31], v[192:195], v[108:111], v[28:31]
    ds_read_b64_tr_b16 v[148:149], v3 offset:10336
    v_mfma_f32_16x16x32_bf16 v[68:71], v[196:199], v[108:111], v[68:71]
    ds_read_b64_tr_b16 v[150:151], v3 offset:11616
    s_waitcnt lgkmcnt(10)
    v_mfma_f32_16x16x32_bf16 v[32:35], v[192:195], v[112:115], v[32:35]
    ds_read_b64_tr_b16 v[152:153], v2 offset:10368
    v_mfma_f32_16x16x32_bf16 v[72:75], v[196:199], v[112:115], v[72:75]
    ds_read_b64_tr_b16 v[154:155], v2 offset:11648
    v_mfma_f32_16x16x32_bf16 v[36:39], v[192:195], v[116:119], v[36:39]
    ds_read_b64_tr_b16 v[156:157], v3 offset:10400
    v_mfma_f32_16x16x32_bf16 v[76:79], v[196:199], v[116:119], v[76:79]
    ds_read_b64_tr_b16 v[158:159], v3 offset:11680
    v_mfma_f32_16x16x32_bf16 v[40:43], v[192:195], v[120:123], v[40:43]
    ds_read_b64_tr_b16 v[160:161], v2 offset:10432
    v_mfma_f32_16x16x32_bf16 v[80:83], v[196:199], v[120:123], v[80:83]
    ds_read_b64_tr_b16 v[162:163], v2 offset:11712
    v_mfma_f32_16x16x32_bf16 v[44:47], v[192:195], v[124:127], v[44:47]
    ds_read_b64_tr_b16 v[164:165], v3 offset:10464
    v_mfma_f32_16x16x32_bf16 v[84:87], v[196:199], v[124:127], v[84:87]
    ds_read_b64_tr_b16 v[166:167], v3 offset:11744
    v_mfma_f32_16x16x32_bf16 v[48:51], v[192:195], v[128:131], v[48:51]
    ds_read_b64_tr_b16 v[168:169], v2 offset:10496
    v_mfma_f32_16x16x32_bf16 v[88:91], v[196:199], v[128:131], v[88:91]
    ds_read_b64_tr_b16 v[170:171], v2 offset:11776
    s_waitcnt lgkmcnt(10)
    v_mfma_f32_16x16x32_bf16 v[52:55], v[192:195], v[132:135], v[52:55]
    ds_read_b64_tr_b16 v[172:173], v3 offset:10528
    v_mfma_f32_16x16x32_bf16 v[92:95], v[196:199], v[132:135], v[92:95]
    ds_read_b64_tr_b16 v[174:175], v3 offset:11808
    v_mfma_f32_16x16x32_bf16 v[16:19], v[200:203], v[136:139], v[16:19]
    v_mfma_f32_16x16x32_bf16 v[56:59], v[204:207], v[136:139], v[56:59]
    v_mfma_f32_16x16x32_bf16 v[20:23], v[200:203], v[140:143], v[20:23]
    s_waitcnt lgkmcnt(0)
    s_barrier
    v_mfma_f32_16x16x32_bf16 v[60:63], v[204:207], v[140:143], v[60:63]
    ds_read_b128 v[176:179], v11 offset:36864
    ds_read_b128 v[180:183], v11 offset:38912
    v_mfma_f32_16x16x32_bf16 v[24:27], v[200:203], v[144:147], v[24:27]
    ds_read_b128 v[184:187], v12 offset:36864
    v_mfma_f32_16x16x32_bf16 v[64:67], v[204:207], v[144:147], v[64:67]
    ds_read_b128 v[188:191], v12 offset:38912
    ds_read_b64_tr_b16 v[96:97], v9 offset:36864
    v_mfma_f32_16x16x32_bf16 v[28:31], v[200:203], v[148:151], v[28:31]
    ds_read_b64_tr_b16 v[98:99], v9 offset:38144
    v_mfma_f32_16x16x32_bf16 v[68:71], v[204:207], v[148:151], v[68:71]
    ds_read_b64_tr_b16 v[100:101], v10 offset:36896
    ds_read_b64_tr_b16 v[102:103], v10 offset:38176
    v_mfma_f32_16x16x32_bf16 v[32:35], v[200:203], v[152:155], v[32:35]
    ds_read_b64_tr_b16 v[104:105], v9 offset:36928
    v_mfma_f32_16x16x32_bf16 v[72:75], v[204:207], v[152:155], v[72:75]
    ds_read_b64_tr_b16 v[106:107], v9 offset:38208
    v_mfma_f32_16x16x32_bf16 v[36:39], v[200:203], v[156:159], v[36:39]
    ds_read_b64_tr_b16 v[108:109], v10 offset:36960
    ds_read_b64_tr_b16 v[110:111], v10 offset:38240
    v_mfma_f32_16x16x32_bf16 v[76:79], v[204:207], v[156:159], v[76:79]
    ds_read_b64_tr_b16 v[112:113], v9 offset:36992
    v_mfma_f32_16x16x32_bf16 v[40:43], v[200:203], v[160:163], v[40:43]
    ds_read_b64_tr_b16 v[114:115], v9 offset:38272
    ds_read_b64_tr_b16 v[116:117], v10 offset:37024
    v_mfma_f32_16x16x32_bf16 v[80:83], v[204:207], v[160:163], v[80:83]
    ds_read_b64_tr_b16 v[118:119], v10 offset:38304
    v_mfma_f32_16x16x32_bf16 v[44:47], v[200:203], v[164:167], v[44:47]
    ds_read_b64_tr_b16 v[120:121], v9 offset:37056
    v_mfma_f32_16x16x32_bf16 v[84:87], v[204:207], v[164:167], v[84:87]
    ds_read_b64_tr_b16 v[122:123], v9 offset:38336
    ds_read_b64_tr_b16 v[124:125], v10 offset:37088
    v_mfma_f32_16x16x32_bf16 v[48:51], v[200:203], v[168:171], v[48:51]
    ds_read_b64_tr_b16 v[126:127], v10 offset:38368
    v_mfma_f32_16x16x32_bf16 v[88:91], v[204:207], v[168:171], v[88:91]
    ds_read_b64_tr_b16 v[128:129], v9 offset:37120
    ds_read_b64_tr_b16 v[130:131], v9 offset:38400
    v_mfma_f32_16x16x32_bf16 v[52:55], v[200:203], v[172:175], v[52:55]
    ds_read_b64_tr_b16 v[132:133], v10 offset:37152
    v_mfma_f32_16x16x32_bf16 v[92:95], v[204:207], v[172:175], v[92:95]
    ds_read_b64_tr_b16 v[134:135], v10 offset:38432
    s_waitcnt lgkmcnt(11)
    v_mfma_f32_16x16x32_bf16 v[16:19], v[176:179], v[96:99], v[16:19]
    ds_read_b64_tr_b16 v[136:137], v9 offset:47104
    v_mfma_f32_16x16x32_bf16 v[56:59], v[180:183], v[96:99], v[56:59]
    ds_read_b64_tr_b16 v[138:139], v9 offset:48384
    v_mfma_f32_16x16x32_bf16 v[20:23], v[176:179], v[100:103], v[20:23]
    ds_read_b64_tr_b16 v[140:141], v10 offset:47136
    v_mfma_f32_16x16x32_bf16 v[60:63], v[180:183], v[100:103], v[60:63]
    ds_read_b64_tr_b16 v[142:143], v10 offset:48416
    v_mfma_f32_16x16x32_bf16 v[24:27], v[176:179], v[104:107], v[24:27]
    ds_read_b64_tr_b16 v[144:145], v9 offset:47168
    v_mfma_f32_16x16x32_bf16 v[64:67], v[180:183], v[104:107], v[64:67]
    ds_read_b64_tr_b16 v[146:147], v9 offset:48448
    v_mfma_f32_16x16x32_bf16 v[28:31], v[176:179], v[108:111], v[28:31]
    ds_read_b64_tr_b16 v[148:149], v10 offset:47200
    v_mfma_f32_16x16x32_bf16 v[68:71], v[180:183], v[108:111], v[68:71]
    ds_read_b64_tr_b16 v[150:151], v10 offset:48480
    s_waitcnt lgkmcnt(10)
    v_mfma_f32_16x16x32_bf16 v[32:35], v[176:179], v[112:115], v[32:35]
    ds_read_b64_tr_b16 v[152:153], v9 offset:47232
    v_mfma_f32_16x16x32_bf16 v[72:75], v[180:183], v[112:115], v[72:75]
    ds_read_b64_tr_b16 v[154:155], v9 offset:48512
    v_mfma_f32_16x16x32_bf16 v[36:39], v[176:179], v[116:119], v[36:39]
    ds_read_b64_tr_b16 v[156:157], v10 offset:47264
    v_mfma_f32_16x16x32_bf16 v[76:79], v[180:183], v[116:119], v[76:79]
    ds_read_b64_tr_b16 v[158:159], v10 offset:48544
    v_mfma_f32_16x16x32_bf16 v[40:43], v[176:179], v[120:123], v[40:43]
    ds_read_b64_tr_b16 v[160:161], v9 offset:47296
    v_mfma_f32_16x16x32_bf16 v[80:83], v[180:183], v[120:123], v[80:83]
    ds_read_b64_tr_b16 v[162:163], v9 offset:48576
    v_mfma_f32_16x16x32_bf16 v[44:47], v[176:179], v[124:127], v[44:47]
    ds_read_b64_tr_b16 v[164:165], v10 offset:47328
    v_mfma_f32_16x16x32_bf16 v[84:87], v[180:183], v[124:127], v[84:87]
    ds_read_b64_tr_b16 v[166:167], v10 offset:48608
    v_mfma_f32_16x16x32_bf16 v[48:51], v[176:179], v[128:131], v[48:51]
    ds_read_b64_tr_b16 v[168:169], v9 offset:47360
    v_mfma_f32_16x16x32_bf16 v[88:91], v[180:183], v[128:131], v[88:91]
    ds_read_b64_tr_b16 v[170:171], v9 offset:48640
    s_waitcnt lgkmcnt(10)
    v_mfma_f32_16x16x32_bf16 v[52:55], v[176:179], v[132:135], v[52:55]
    ds_read_b64_tr_b16 v[172:173], v10 offset:47392
    v_mfma_f32_16x16x32_bf16 v[92:95], v[180:183], v[132:135], v[92:95]
    ds_read_b64_tr_b16 v[174:175], v10 offset:48672
    v_mfma_f32_16x16x32_bf16 v[16:19], v[184:187], v[136:139], v[16:19]
    v_mfma_f32_16x16x32_bf16 v[56:59], v[188:191], v[136:139], v[56:59]
    v_mfma_f32_16x16x32_bf16 v[20:23], v[184:187], v[140:143], v[20:23]
    s_waitcnt lgkmcnt(0)
    s_barrier
    v_mfma_f32_16x16x32_bf16 v[60:63], v[188:191], v[140:143], v[60:63]
    ds_read_b128 v[192:195], v11 offset:0
    ds_read_b128 v[196:199], v11 offset:2048
    v_mfma_f32_16x16x32_bf16 v[24:27], v[184:187], v[144:147], v[24:27]
    ds_read_b128 v[200:203], v12 offset:0
    v_mfma_f32_16x16x32_bf16 v[64:67], v[188:191], v[144:147], v[64:67]
    ds_read_b128 v[204:207], v12 offset:2048
    ds_read_b64_tr_b16 v[96:97], v9 offset:0
    v_mfma_f32_16x16x32_bf16 v[28:31], v[184:187], v[148:151], v[28:31]
    ds_read_b64_tr_b16 v[98:99], v9 offset:1280
    v_mfma_f32_16x16x32_bf16 v[68:71], v[188:191], v[148:151], v[68:71]
    ds_read_b64_tr_b16 v[100:101], v10 offset:32
    ds_read_b64_tr_b16 v[102:103], v10 offset:1312
    v_mfma_f32_16x16x32_bf16 v[32:35], v[184:187], v[152:155], v[32:35]
    ds_read_b64_tr_b16 v[104:105], v9 offset:64
    v_mfma_f32_16x16x32_bf16 v[72:75], v[188:191], v[152:155], v[72:75]
    ds_read_b64_tr_b16 v[106:107], v9 offset:1344
    v_mfma_f32_16x16x32_bf16 v[36:39], v[184:187], v[156:159], v[36:39]
    ds_read_b64_tr_b16 v[108:109], v10 offset:96
    ds_read_b64_tr_b16 v[110:111], v10 offset:1376
    v_mfma_f32_16x16x32_bf16 v[76:79], v[188:191], v[156:159], v[76:79]
    ds_read_b64_tr_b16 v[112:113], v9 offset:128
    v_mfma_f32_16x16x32_bf16 v[40:43], v[184:187], v[160:163], v[40:43]
    ds_read_b64_tr_b16 v[114:115], v9 offset:1408
    ds_read_b64_tr_b16 v[116:117], v10 offset:160
    v_mfma_f32_16x16x32_bf16 v[80:83], v[188:191], v[160:163], v[80:83]
    ds_read_b64_tr_b16 v[118:119], v10 offset:1440
    v_mfma_f32_16x16x32_bf16 v[44:47], v[184:187], v[164:167], v[44:47]
    ds_read_b64_tr_b16 v[120:121], v9 offset:192
    v_mfma_f32_16x16x32_bf16 v[84:87], v[188:191], v[164:167], v[84:87]
    ds_read_b64_tr_b16 v[122:123], v9 offset:1472
    ds_read_b64_tr_b16 v[124:125], v10 offset:224
    v_mfma_f32_16x16x32_bf16 v[48:51], v[184:187], v[168:171], v[48:51]
    ds_read_b64_tr_b16 v[126:127], v10 offset:1504
    v_mfma_f32_16x16x32_bf16 v[88:91], v[188:191], v[168:171], v[88:91]
    ds_read_b64_tr_b16 v[128:129], v9 offset:256
    ds_read_b64_tr_b16 v[130:131], v9 offset:1536
    v_mfma_f32_16x16x32_bf16 v[52:55], v[184:187], v[172:175], v[52:55]
    ds_read_b64_tr_b16 v[132:133], v10 offset:288
    v_mfma_f32_16x16x32_bf16 v[92:95], v[188:191], v[172:175], v[92:95]
    ds_read_b64_tr_b16 v[134:135], v10 offset:1568
    s_waitcnt lgkmcnt(11)
    v_mfma_f32_16x16x32_bf16 v[16:19], v[192:195], v[96:99], v[16:19]
    ds_read_b64_tr_b16 v[136:137], v9 offset:10240
    ds_read_b64_tr_b16 v[138:139], v9 offset:11520
    v_mfma_f32_16x16x32_bf16 v[56:59], v[196:199], v[96:99], v[56:59]
    ds_read_b64_tr_b16 v[140:141], v10 offset:10272
    ds_read_b64_tr_b16 v[142:143], v10 offset:11552
    v_mfma_f32_16x16x32_bf16 v[20:23], v[192:195], v[100:103], v[20:23]
    ds_read_b64_tr_b16 v[144:145], v9 offset:10304
    ds_read_b64_tr_b16 v[146:147], v9 offset:11584
    v_mfma_f32_16x16x32_bf16 v[60:63], v[196:199], v[100:103], v[60:63]
    ds_read_b64_tr_b16 v[148:149], v10 offset:10336
    ds_read_b64_tr_b16 v[150:151], v10 offset:11616
    v_mfma_f32_16x16x32_bf16 v[24:27], v[192:195], v[104:107], v[24:27]
    ds_read_b64_tr_b16 v[152:153], v9 offset:10368
    ds_read_b64_tr_b16 v[154:155], v9 offset:11648
    v_mfma_f32_16x16x32_bf16 v[64:67], v[196:199], v[104:107], v[64:67]
    ds_read_b64_tr_b16 v[156:157], v10 offset:10400
    ds_read_b64_tr_b16 v[158:159], v10 offset:11680
    v_mfma_f32_16x16x32_bf16 v[28:31], v[192:195], v[108:111], v[28:31]
    ds_read_b64_tr_b16 v[160:161], v9 offset:10432
    ds_read_b64_tr_b16 v[162:163], v9 offset:11712
    v_mfma_f32_16x16x32_bf16 v[68:71], v[196:199], v[108:111], v[68:71]
    ds_read_b64_tr_b16 v[164:165], v10 offset:10464
    ds_read_b64_tr_b16 v[166:167], v10 offset:11744
    s_waitcnt lgkmcnt(13)
    v_mfma_f32_16x16x32_bf16 v[32:35], v[192:195], v[112:115], v[32:35]
    ds_read_b64_tr_b16 v[168:169], v9 offset:10496
    ds_read_b64_tr_b16 v[170:171], v9 offset:11776
    v_mfma_f32_16x16x32_bf16 v[72:75], v[196:199], v[112:115], v[72:75]
    ds_read_b64_tr_b16 v[172:173], v10 offset:10528
    ds_read_b64_tr_b16 v[174:175], v10 offset:11808
    v_mfma_f32_16x16x32_bf16 v[16:19], v[200:203], v[136:139], v[16:19]
    v_mfma_f32_16x16x32_bf16 v[56:59], v[204:207], v[136:139], v[56:59]
    s_waitcnt lgkmcnt(12)
    v_mfma_f32_16x16x32_bf16 v[20:23], v[200:203], v[140:143], v[20:23]
    v_mfma_f32_16x16x32_bf16 v[60:63], v[204:207], v[140:143], v[60:63]
    v_mfma_f32_16x16x32_bf16 v[24:27], v[200:203], v[144:147], v[24:27]
    v_mfma_f32_16x16x32_bf16 v[64:67], v[204:207], v[144:147], v[64:67]
    v_mfma_f32_16x16x32_bf16 v[28:31], v[200:203], v[148:151], v[28:31]
    s_nop 0
    v_mul_f32 v240, s70, v16
    v_mul_f32 v241, s70, v17
    v_mfma_f32_16x16x32_bf16 v[68:71], v[204:207], v[148:151], v[68:71]
    v_mul_f32 v242, s70, v18
    v_mul_f32 v243, s70, v19
    s_waitcnt lgkmcnt(5)
    v_mfma_f32_16x16x32_bf16 v[32:35], v[200:203], v[152:155], v[32:35]
    v_mul_f32 v244, s70, v56
    v_mul_f32 v245, s70, v57
    v_mfma_f32_16x16x32_bf16 v[72:75], v[204:207], v[152:155], v[72:75]
    v_mul_f32 v246, s70, v58
    v_mul_f32 v247, s70, v59
    v_mfma_f32_16x16x32_bf16 v[36:39], v[192:195], v[116:119], v[36:39]
    v_exp_f32 v240, v240 clamp
    v_max_f32 v16, s71, v16
    v_mfma_f32_16x16x32_bf16 v[76:79], v[196:199], v[116:119], v[76:79]
    v_exp_f32 v241, v241 clamp
    v_max_f32 v17, s71, v17
    v_mfma_f32_16x16x32_bf16 v[40:43], v[192:195], v[120:123], v[40:43]
    v_exp_f32 v242, v242 clamp
    v_max_f32 v18, s71, v18
    v_mfma_f32_16x16x32_bf16 v[80:83], v[196:199], v[120:123], v[80:83]
    v_exp_f32 v243, v243 clamp
    v_max_f32 v19, s71, v19
    v_mfma_f32_16x16x32_bf16 v[44:47], v[192:195], v[124:127], v[44:47]
    v_exp_f32 v244, v244 clamp
    v_max_f32 v56, s71, v56
    v_mfma_f32_16x16x32_bf16 v[84:87], v[196:199], v[124:127], v[84:87]
    v_exp_f32 v245, v245 clamp
    v_max_f32 v57, s71, v57
    v_mfma_f32_16x16x32_bf16 v[48:51], v[192:195], v[128:131], v[48:51]
    v_exp_f32 v246, v246 clamp
    v_max_f32 v58, s71, v58
    v_mfma_f32_16x16x32_bf16 v[88:91], v[196:199], v[128:131], v[88:91]
    v_exp_f32 v247, v247 clamp
    v_max_f32 v59, s71, v59
    v_mfma_f32_16x16x32_bf16 v[52:55], v[192:195], v[132:135], v[52:55]
    v_add_f32 v16, v16, v240
    v_add_f32 v17, v17, v241
    v_mfma_f32_16x16x32_bf16 v[92:95], v[196:199], v[132:135], v[92:95]
    v_add_f32 v18, v18, v242
    v_add_f32 v19, v19, v243
    v_mfma_f32_16x16x32_bf16 v[36:39], v[200:203], v[156:159], v[36:39]
    v_add_f32 v56, v56, v244
    v_add_f32 v57, v57, v245
    v_mfma_f32_16x16x32_bf16 v[76:79], v[204:207], v[156:159], v[76:79]
    v_add_f32 v58, v58, v246
    v_add_f32 v59, v59, v247
    v_mfma_f32_16x16x32_bf16 v[40:43], v[200:203], v[160:163], v[40:43]
    v_cvt_pk_bf16_f32 v96, v16, v17
    v_cvt_pk_bf16_f32 v97, v18, v19
    v_mfma_f32_16x16x32_bf16 v[80:83], v[204:207], v[160:163], v[80:83]
    v_cvt_pk_bf16_f32 v98, v56, v57
    v_cvt_pk_bf16_f32 v99, v58, v59
    s_waitcnt lgkmcnt(0)
    v_mfma_f32_16x16x32_bf16 v[44:47], v[200:203], v[164:167], v[44:47]
    ds_write_b128 v214, v[96:99] offset:0
    v_mul_f32 v240, s70, v20
    v_mfma_f32_16x16x32_bf16 v[84:87], v[204:207], v[164:167], v[84:87]
    v_mul_f32 v241, s70, v21
    v_mul_f32 v242, s70, v22
    v_mfma_f32_16x16x32_bf16 v[48:51], v[200:203], v[168:171], v[48:51]
    v_mul_f32 v243, s70, v23
    v_mul_f32 v244, s70, v60
    v_mfma_f32_16x16x32_bf16 v[88:91], v[204:207], v[168:171], v[88:91]
    v_mul_f32 v245, s70, v61
    v_mul_f32 v246, s70, v62
    v_mfma_f32_16x16x32_bf16 v[52:55], v[200:203], v[172:175], v[52:55]
    v_mul_f32 v247, s70, v63
    v_exp_f32 v240, v240 clamp
    v_mfma_f32_16x16x32_bf16 v[92:95], v[204:207], v[172:175], v[92:95]
    v_max_f32 v20, s71, v20
    v_exp_f32 v241, v241 clamp
    v_max_f32 v21, s71, v21
    v_exp_f32 v242, v242 clamp
    v_max_f32 v22, s71, v22
    v_exp_f32 v243, v243 clamp
    v_max_f32 v23, s71, v23
    v_exp_f32 v244, v244 clamp
    v_max_f32 v60, s71, v60
    v_exp_f32 v245, v245 clamp
    v_max_f32 v61, s71, v61
    v_exp_f32 v246, v246 clamp
    v_max_f32 v62, s71, v62
    v_exp_f32 v247, v247 clamp
    v_max_f32 v63, s71, v63
    v_add_f32 v20, v20, v240
    v_add_f32 v21, v21, v241
    v_add_f32 v22, v22, v242
    v_add_f32 v23, v23, v243
    v_add_f32 v60, v60, v244
    v_add_f32 v61, v61, v245
    v_add_f32 v62, v62, v246
    v_add_f32 v63, v63, v247
    v_cvt_pk_bf16_f32 v100, v20, v21
    v_cvt_pk_bf16_f32 v101, v22, v23
    v_cvt_pk_bf16_f32 v102, v60, v61
    v_cvt_pk_bf16_f32 v103, v62, v63
    ds_write_b128 v214, v[100:103] offset:1024
    v_cvt_pk_bf16_f32 v116, v36, v37
    v_cvt_pk_bf16_f32 v117, v38, v39
    v_cvt_pk_bf16_f32 v118, v76, v77
    v_cvt_pk_bf16_f32 v119, v78, v79
    ds_write_b128 v214, v[116:119] offset:5120
    v_mul_f32 v240, s70, v24
    v_mul_f32 v241, s70, v25
    v_mul_f32 v242, s70, v26
    v_mul_f32 v243, s70, v27
    v_mul_f32 v244, s70, v64
    v_mul_f32 v245, s70, v65
    v_mul_f32 v246, s70, v66
    v_mul_f32 v247, s70, v67
    v_exp_f32 v240, v240 clamp
    v_max_f32 v24, s71, v24
    v_exp_f32 v241, v241 clamp
    v_max_f32 v25, s71, v25
    v_exp_f32 v242, v242 clamp
    v_max_f32 v26, s71, v26
    v_exp_f32 v243, v243 clamp
    v_max_f32 v27, s71, v27
    v_exp_f32 v244, v244 clamp
    v_max_f32 v64, s71, v64
    v_exp_f32 v245, v245 clamp
    v_max_f32 v65, s71, v65
    v_exp_f32 v246, v246 clamp
    v_max_f32 v66, s71, v66
    v_exp_f32 v247, v247 clamp
    v_max_f32 v67, s71, v67
    v_add_f32 v24, v24, v240
    v_add_f32 v25, v25, v241
    v_add_f32 v26, v26, v242
    v_add_f32 v27, v27, v243
    v_add_f32 v64, v64, v244
    v_add_f32 v65, v65, v245
    v_add_f32 v66, v66, v246
    v_add_f32 v67, v67, v247
    v_cvt_pk_bf16_f32 v104, v24, v25
    v_cvt_pk_bf16_f32 v105, v26, v27
    v_cvt_pk_bf16_f32 v106, v64, v65
    v_cvt_pk_bf16_f32 v107, v66, v67
    ds_write_b128 v214, v[104:107] offset:2048
    v_cvt_pk_bf16_f32 v120, v40, v41
    v_cvt_pk_bf16_f32 v121, v42, v43
    v_cvt_pk_bf16_f32 v122, v80, v81
    v_cvt_pk_bf16_f32 v123, v82, v83
    ds_write_b128 v214, v[120:123] offset:6144
    v_cvt_pk_bf16_f32 v124, v44, v45
    v_cvt_pk_bf16_f32 v125, v46, v47
    v_cvt_pk_bf16_f32 v126, v84, v85
    v_cvt_pk_bf16_f32 v127, v86, v87
    ds_write_b128 v214, v[124:127] offset:7168
    v_mul_f32 v240, s70, v28
    v_mul_f32 v241, s70, v29
    v_mul_f32 v242, s70, v30
    v_mul_f32 v243, s70, v31
    v_mul_f32 v244, s70, v68
    v_mul_f32 v245, s70, v69
    v_mul_f32 v246, s70, v70
    v_mul_f32 v247, s70, v71
    v_exp_f32 v240, v240 clamp
    v_max_f32 v28, s71, v28
    v_exp_f32 v241, v241 clamp
    v_max_f32 v29, s71, v29
    v_exp_f32 v242, v242 clamp
    v_max_f32 v30, s71, v30
    v_exp_f32 v243, v243 clamp
    v_max_f32 v31, s71, v31
    v_exp_f32 v244, v244 clamp
    v_max_f32 v68, s71, v68
    v_exp_f32 v245, v245 clamp
    v_max_f32 v69, s71, v69
    v_exp_f32 v246, v246 clamp
    v_max_f32 v70, s71, v70
    v_exp_f32 v247, v247 clamp
    v_max_f32 v71, s71, v71
    v_add_f32 v28, v28, v240
    v_add_f32 v29, v29, v241
    v_add_f32 v30, v30, v242
    v_add_f32 v31, v31, v243
    v_add_f32 v68, v68, v244
    v_add_f32 v69, v69, v245
    v_add_f32 v70, v70, v246
    v_add_f32 v71, v71, v247
    v_cvt_pk_bf16_f32 v108, v28, v29
    v_cvt_pk_bf16_f32 v109, v30, v31
    v_cvt_pk_bf16_f32 v110, v68, v69
    v_cvt_pk_bf16_f32 v111, v70, v71
    ds_write_b128 v214, v[108:111] offset:3072
    v_cvt_pk_bf16_f32 v128, v48, v49
    v_cvt_pk_bf16_f32 v129, v50, v51
    v_cvt_pk_bf16_f32 v130, v88, v89
    v_cvt_pk_bf16_f32 v131, v90, v91
    ds_write_b128 v214, v[128:131] offset:8192
    v_cvt_pk_bf16_f32 v132, v52, v53
    v_cvt_pk_bf16_f32 v133, v54, v55
    v_cvt_pk_bf16_f32 v134, v92, v93
    v_cvt_pk_bf16_f32 v135, v94, v95
    ds_write_b128 v214, v[132:135] offset:9216
    v_mul_f32 v240, s70, v32
    v_mul_f32 v241, s70, v33
    v_mul_f32 v242, s70, v34
    v_mul_f32 v243, s70, v35
    v_mul_f32 v244, s70, v72
    v_mul_f32 v245, s70, v73
    v_mul_f32 v246, s70, v74
    v_mul_f32 v247, s70, v75
    v_exp_f32 v240, v240 clamp
    v_max_f32 v32, s71, v32
    v_exp_f32 v241, v241 clamp
    v_max_f32 v33, s71, v33
    v_exp_f32 v242, v242 clamp
    v_max_f32 v34, s71, v34
    v_exp_f32 v243, v243 clamp
    v_max_f32 v35, s71, v35
    v_exp_f32 v244, v244 clamp
    v_max_f32 v72, s71, v72
    v_exp_f32 v245, v245 clamp
    v_max_f32 v73, s71, v73
    v_exp_f32 v246, v246 clamp
    v_max_f32 v74, s71, v74
    v_exp_f32 v247, v247 clamp
    v_max_f32 v75, s71, v75
    v_add_f32 v32, v32, v240
    v_add_f32 v33, v33, v241
    v_add_f32 v34, v34, v242
    v_add_f32 v35, v35, v243
    v_add_f32 v72, v72, v244
    v_add_f32 v73, v73, v245
    v_add_f32 v74, v74, v246
    v_add_f32 v75, v75, v247
    v_cvt_pk_bf16_f32 v112, v32, v33
    v_cvt_pk_bf16_f32 v113, v34, v35
    v_cvt_pk_bf16_f32 v114, v72, v73
    v_cvt_pk_bf16_f32 v115, v74, v75
    ds_write_b128 v214, v[112:115] offset:4096
    v_mov_b32 v13, s75
    v_mov_b32 v14, 1
    v_add_u32 v13, 81856, v13
    s_add_u32 s76, s76, 4
    s_mov_b64 exec, 1
    ds_add_u32 v13, v14
    s_mov_b64 exec, -1
    buffer_load_dword v7, v8, s[48:51], s61 offen sc1
    s_mov_b32 s67, 0
L_BW_0:
    ds_read_b32 v14, v13
    s_waitcnt lgkmcnt(0)
    v_cmp_gt_u32 vcc, s76, v14
    s_nop 1
    s_cbranch_vccnz L_BW_0
    ds_read_b128 v[136:139], v215 offset:0
    ds_read_b128 v[144:147], v215 offset:5120
    ds_read_b128 v[140:143], v215 offset:1024
    ds_read_b128 v[148:151], v215 offset:6144
    ds_read_b128 v[152:155], v215 offset:10240
    ds_read_b128 v[160:163], v215 offset:15360
    ds_read_b128 v[156:159], v215 offset:11264
    ds_read_b128 v[164:167], v215 offset:16384
    ds_read_b128 v[168:171], v215 offset:20480
    ds_read_b128 v[176:179], v215 offset:25600
    ds_read_b128 v[172:175], v215 offset:21504
    ds_read_b128 v[180:183], v215 offset:26624
    ds_read_b128 v[184:187], v215 offset:30720
    ds_read_b128 v[192:195], v215 offset:35840
    ds_read_b128 v[188:191], v215 offset:31744
    ds_read_b128 v[196:199], v215 offset:36864
    s_waitcnt lgkmcnt(15)
    v_mfma_f32_16x16x32_bf16 v[32:35], v[136:139], v[220:223], 0
    s_waitcnt lgkmcnt(14)
    v_mfma_f32_16x16x32_bf16 v[16:19], v[136:139], v[144:147], 0
    s_waitcnt lgkmcnt(12)
    v_mfma_f32_16x16x32_bf16 v[20:23], v[136:139], v[148:151], 0
    v_mfma_f32_16x16x32_bf16 v[36:39], v[140:143], v[220:223], 0
    v_mfma_f32_16x16x32_bf16 v[24:27], v[140:143], v[144:147], 0
    v_mfma_f32_16x16x32_bf16 v[28:31], v[140:143], v[148:151], 0
    s_waitcnt lgkmcnt(11)
    v_mfma_f32_16x16x32_bf16 v[32:35], v[152:155], v[220:223], v[32:35]
    s_waitcnt lgkmcnt(10)
    v_mfma_f32_16x16x32_bf16 v[16:19], v[152:155], v[160:163], v[16:19]
    s_waitcnt lgkmcnt(8)
    v_mfma_f32_16x16x32_bf16 v[20:23], v[152:155], v[164:167], v[20:23]
    v_mfma_f32_16x16x32_bf16 v[36:39], v[156:159], v[220:223], v[36:39]
    v_mfma_f32_16x16x32_bf16 v[24:27], v[156:159], v[160:163], v[24:27]
    v_mfma_f32_16x16x32_bf16 v[28:31], v[156:159], v[164:167], v[28:31]
    s_waitcnt lgkmcnt(7)
    v_mfma_f32_16x16x32_bf16 v[32:35], v[168:171], v[220:223], v[32:35]
    s_waitcnt lgkmcnt(6)
    v_mfma_f32_16x16x32_bf16 v[16:19], v[168:171], v[176:179], v[16:19]
    s_waitcnt lgkmcnt(4)
    v_mfma_f32_16x16x32_bf16 v[20:23], v[168:171], v[180:183], v[20:23]
    v_mfma_f32_16x16x32_bf16 v[36:39], v[172:175], v[220:223], v[36:39]
    v_mfma_f32_16x16x32_bf16 v[24:27], v[172:175], v[176:179], v[24:27]
    v_mfma_f32_16x16x32_bf16 v[28:31], v[172:175], v[180:183], v[28:31]
    s_waitcnt lgkmcnt(1)
    v_mfma_f32_16x16x32_bf16 v[32:35], v[184:187], v[220:223], v[32:35]
    v_mfma_f32_16x16x32_bf16 v[16:19], v[184:187], v[192:195], v[16:19]
    s_waitcnt lgkmcnt(0)
    v_mfma_f32_16x16x32_bf16 v[20:23], v[184:187], v[196:199], v[20:23]
    v_mfma_f32_16x16x32_bf16 v[36:39], v[188:191], v[220:223], v[36:39]
    v_mfma_f32_16x16x32_bf16 v[24:27], v[188:191], v[192:195], v[24:27]
    v_mfma_f32_16x16x32_bf16 v[28:31], v[188:191], v[196:199], v[28:31]
    s_nop 1
    ds_write_b128 v212, v[32:35]
    ds_write_b128 v208, v[16:19]
    s_nop 0
    ds_write_b128 v209, v[20:23]
    ds_write_b128 v213, v[36:39]
    ds_write_b128 v210, v[24:27]
    ds_write_b128 v211, v[28:31]
    ds_read_b32 v48, v217 offset:0
    ds_read_b32 v49, v217 offset:256
    ds_read_b32 v50, v217 offset:512
    ds_read_b32 v51, v217 offset:768
    ds_read_b32 v52, v217 offset:1024
    ds_read_b32 v53, v217 offset:1280
    ds_read_b32 v54, v217 offset:1536
    s_waitcnt lgkmcnt(6)
    buffer_atomic_add_f32 v48, v216, s[48:51], s52 offen offset:0
    s_waitcnt lgkmcnt(5)
    buffer_atomic_add_f32 v49, v216, s[48:51], s52 offen offset:256
    s_waitcnt lgkmcnt(4)
    buffer_atomic_add_f32 v50, v216, s[48:51], s52 offen offset:512
    s_waitcnt lgkmcnt(3)
    buffer_atomic_add_f32 v51, v216, s[48:51], s52 offen offset:768
    s_waitcnt lgkmcnt(2)
    buffer_atomic_add_f32 v52, v216, s[48:51], s52 offen offset:1024
    s_waitcnt lgkmcnt(1)
    buffer_atomic_add_f32 v53, v216, s[48:51], s52 offen offset:1280
    s_mov_b32 exec_hi, 0xf
    s_waitcnt lgkmcnt(0)
    buffer_atomic_add_f32 v54, v216, s[48:51], s52 offen offset:1536
    s_mov_b64 exec, -1
    s_waitcnt vmcnt(7)
    v_cmp_gt_u32 vcc, 1, v7
    s_nop 1
    s_cbranch_vccnz L_MU3
    buffer_load_dwordx4 v[232:235], v6, s[48:51], s62 offen sc1
    s_mov_b32 s67, 1
L_MU3:
    ds_write_b128 v6, v[224:227] offset:8480
    ds_write_b128 v6, v[228:231] offset:12704
    s_cmp_lg_u32 s3, 0
    s_cbranch_scc1 L_MC0
    v_mov_b32 v56, 0
    v_mov_b32 v57, 0
    v_mov_b32 v58, 0
    v_mov_b32 v59, 0
    ds_write_b128 v250, v[56:59] offset:8448
    ds_write_b32 v8, v236 offset:8480
    ds_write_b32 v8, v236 offset:12700
    ds_write_b128 v249, v[56:59] offset:18944
L_MC0:
    s_waitcnt vmcnt(0)
    v_mov_b32 v13, 81856
    v_mov_b32 v14, 1
    s_mov_b64 exec, 1
    ds_add_rtn_u32 v12, v13, v14 offset:8
    s_mov_b64 exec, -1
    s_mov_b32 s79, 1
    s_waitcnt lgkmcnt(0)
    v_readfirstlane_b32 s53, v12
    s_nop 0
    s_cmp_lg_u32 s53, 3
    s_cbranch_scc1 L_MS0
    s_atomic_add s79, s[6:7], 32768 glc
L_MS0:
    s_cmp_eq_u32 s67, 1
    s_cbranch_scc1 L_MU1
    s_waitcnt lgkmcnt(0)
    s_cmp_lg_u32 s79, 15
    s_cbranch_scc1 L_MS2
    s_mov_b32 s79, 1
    v_lshlrev_b32 v12, 10, v1
    s_mov_b64 exec, 255
    global_store_dword v12, v14, s[6:7] sc1
    s_mov_b64 exec, -1
L_MS2:
    v_cmp_gt_u32 vcc, 1, v7
    s_mov_b32 s78, 0
    s_nop 0
    s_cbranch_vccz L_OK_mu
L_POLL_mu:
    s_sleep 2
    buffer_load_dword v7, v8, s[48:51], s61 offen sc1
    s_add_u32 s78, s78, 1
    s_waitcnt vmcnt(0)
    v_cmp_gt_u32 vcc, 1, v7
    s_cmp_ge_u32 s78, 0x20000
    s_cbranch_scc1 L_OK_mu
    s_cbranch_vccnz L_POLL_mu
L_OK_mu:
    buffer_load_dwordx4 v[232:235], v6, s[48:51], s62 offen sc1
    s_waitcnt vmcnt(0)
L_MU1:
    ds_write_b128 v248, v[232:235]
    v_mov_b32 v13, s75
    v_mov_b32 v14, 1
    v_add_u32 v13, 81856, v13
    s_add_u32 s76, s76, 4
    s_mov_b64 exec, 1
    ds_add_u32 v13, v14
    s_mov_b64 exec, -1
    s_waitcnt lgkmcnt(0)
    s_cmp_lg_u32 s79, 15
    s_cbranch_scc1 L_MS1
    s_mov_b32 s79, 1
    v_lshlrev_b32 v12, 10, v1
    s_mov_b64 exec, 255
    global_store_dword v12, v14, s[6:7] sc1
    s_mov_b64 exec, -1
L_MS1:
L_BW_1:
    ds_read_b32 v14, v13
    s_waitcnt lgkmcnt(0)
    v_cmp_gt_u32 vcc, s76, v14
    s_nop 1
    s_cbranch_vccnz L_BW_1
    s_setprio 3
    ds_read_b64 v[80:81], v237 offset:0
    ds_read_b64 v[82:83], v237 offset:8
    ds_read_b64 v[84:85], v237 offset:16
    ds_read_b128 v[160:163], v239 offset:1792
    ds_read_b128 v[164:167], v239 offset:1536
    ds_read_b128 v[168:171], v239 offset:1280
    ds_read_b128 v[172:175], v239 offset:1024
    ds_read_b128 v[176:179], v239 offset:768
    ds_read_b128 v[180:183], v239 offset:512
    ds_read_b128 v[184:187], v239 offset:256
    ds_read_b128 v[188:191], v239 offset:0
    ds_read_b64 v[90:91], v237 offset:512
    ds_read_b64 v[92:93], v237 offset:520
    ds_read_b64 v[94:95], v237 offset:528
    ds_read_b64 v[100:101], v237 offset:1024
    ds_read_b64 v[102:103], v237 offset:1032
    ds_read_b64 v[104:105], v237 offset:1040
    ds_read_b64 v[110:111], v237 offset:1536
    ds_read_b64 v[112:113], v237 offset:1544
    ds_read_b64 v[114:115], v237 offset:1552
    ds_read_b64 v[120:121], v237 offset:2048
    ds_read_b64 v[122:123], v237 offset:2056
    ds_read_b64 v[124:125], v237 offset:2064
    ds_read_b64 v[130:131], v237 offset:2560
    ds_read_b64 v[132:133], v237 offset:2568
    ds_read_b64 v[134:135], v237 offset:2576
    ds_read_b64 v[140:141], v237 offset:3072
    ds_read_b64 v[142:143], v237 offset:3080
    ds_read_b64 v[144:145], v237 offset:3088
    ds_read_b64 v[150:151], v237 offset:3584
    ds_read_b64 v[152:153], v237 offset:3592
    ds_read_b64 v[154:155], v237 offset:3600
    s_waitcnt lgkmcnt(15)
    v_alignbit_b32 v48, v81, v80, v238
    v_alignbit_b32 v49, v82, v81, v238
    v_alignbit_b32 v50, v83, v82, v238
    v_alignbit_b32 v51, v84, v83, v238
    s_nop 1
    v_mfma_f32_16x16x32_bf16 v[16:19], v[48:51], v[160:163], 0
    v_alignbit_b32 v52, v91, v90, v238
    v_alignbit_b32 v53, v92, v91, v238
    v_mfma_f32_16x16x32_bf16 v[20:23], v[48:51], v[164:167], 0
    v_alignbit_b32 v54, v93, v92, v238
    v_alignbit_b32 v55, v94, v93, v238
    v_mfma_f32_16x16x32_bf16 v[24:27], v[48:51], v[168:171], 0
    v_alignbit_b32 v56, v101, v100, v238
    ds_read_b128 v[192:195], v239 offset:4096
    v_mfma_f32_16x16x32_bf16 v[28:31], v[48:51], v[172:175], 0
    v_alignbit_b32 v57, v102, v101, v238
    ds_read_b128 v[196:199], v239 offset:3840
    v_mfma_f32_16x16x32_bf16 v[32:35], v[48:51], v[176:179], 0
    v_alignbit_b32 v58, v103, v102, v238
    ds_read_b128 v[200:203], v239 offset:3584
    v_mfma_f32_16x16x32_bf16 v[36:39], v[48:51], v[180:183], 0
    v_alignbit_b32 v59, v104, v103, v238
    ds_read_b128 v[204:207], v239 offset:3328
    v_mfma_f32_16x16x32_bf16 v[40:43], v[48:51], v[184:187], 0
    s_waitcnt lgkmcnt(4)
    v_alignbit_b32 v60, v111, v110, v238
    ds_read_b128 v[208:211], v239 offset:3072
    v_mfma_f32_16x16x32_bf16 v[44:47], v[48:51], v[188:191], 0
    v_alignbit_b32 v61, v112, v111, v238
    ds_read_b128 v[212:215], v239 offset:2816
    v_mfma_f32_16x16x32_bf16 v[20:23], v[52:55], v[160:163], v[20:23]
    v_alignbit_b32 v62, v113, v112, v238
    ds_read_b128 v[216:219], v239 offset:2560
    v_mfma_f32_16x16x32_bf16 v[24:27], v[52:55], v[164:167], v[24:27]
    v_alignbit_b32 v63, v114, v113, v238
    ds_read_b128 v[220:223], v239 offset:2304
    v_mfma_f32_16x16x32_bf16 v[28:31], v[52:55], v[168:171], v[28:31]
    v_alignbit_b32 v64, v121, v120, v238
    ds_read_b64 v[86:87], v237 offset:24
    v_mfma_f32_16x16x32_bf16 v[32:35], v[52:55], v[172:175], v[32:35]
    v_alignbit_b32 v65, v122, v121, v238
    ds_read_b64 v[88:89], v237 offset:32
    v_mfma_f32_16x16x32_bf16 v[36:39], v[52:55], v[176:179], v[36:39]
    v_alignbit_b32 v66, v123, v122, v238
    ds_read_b64 v[96:97], v237 offset:536
    v_mfma_f32_16x16x32_bf16 v[40:43], v[52:55], v[180:183], v[40:43]
    v_alignbit_b32 v67, v124, v123, v238
    ds_read_b64 v[98:99], v237 offset:544
    v_mfma_f32_16x16x32_bf16 v[44:47], v[52:55], v[184:187], v[44:47]
    v_alignbit_b32 v68, v131, v130, v238
    ds_read_b64 v[106:107], v237 offset:1048
    v_mfma_f32_16x16x32_bf16 v[24:27], v[56:59], v[160:163], v[24:27]
    v_alignbit_b32 v69, v132, v131, v238
    ds_read_b64 v[108:109], v237 offset:1056
    v_mfma_f32_16x16x32_bf16 v[28:31], v[56:59], v[164:167], v[28:31]
    v_alignbit_b32 v70, v133, v132, v238
    ds_read_b64 v[116:117], v237 offset:1560
    v_mfma_f32_16x16x32_bf16 v[32:35], v[56:59], v[168:171], v[32:35]
    v_alignbit_b32 v71, v134, v133, v238
    ds_read_b64 v[118:119], v237 offset:1568
    v_mfma_f32_16x16x32_bf16 v[36:39], v[56:59], v[172:175], v[36:39]
    v_alignbit_b32 v72, v141, v140, v238
    ds_read_b64 v[126:127], v237 offset:2072
    v_mfma_f32_16x16x32_bf16 v[40:43], v[56:59], v[176:179], v[40:43]
    v_alignbit_b32 v73, v142, v141, v238
    ds_read_b64 v[128:129], v237 offset:2080
    v_mfma_f32_16x16x32_bf16 v[44:47], v[56:59], v[180:183], v[44:47]
    v_alignbit_b32 v74, v143, v142, v238
    ds_read_b64 v[136:137], v237 offset:2584
    v_mfma_f32_16x16x32_bf16 v[28:31], v[60:63], v[160:163], v[28:31]
    v_alignbit_b32 v75, v144, v143, v238
    ds_read_b64 v[138:139], v237 offset:2592
    v_mfma_f32_16x16x32_bf16 v[32:35], v[60:63], v[164:167], v[32:35]
    v_alignbit_b32 v76, v151, v150, v238
    ds_read_b64 v[146:147], v237 offset:3096
    v_mfma_f32_16x16x32_bf16 v[36:39], v[60:63], v[168:171], v[36:39]
    v_alignbit_b32 v77, v152, v151, v238
    ds_read_b64 v[148:149], v237 offset:3104
    v_mfma_f32_16x16x32_bf16 v[40:43], v[60:63], v[172:175], v[40:43]
    v_alignbit_b32 v78, v153, v152, v238
    ds_read_b64 v[156:157], v237 offset:3608
    v_mfma_f32_16x16x32_bf16 v[44:47], v[60:63], v[176:179], v[44:47]
    v_alignbit_b32 v79, v154, v153, v238
    ds_read_b64 v[158:159], v237 offset:3616
    v_mfma_f32_16x16x32_bf16 v[32:35], v[64:67], v[160:163], v[32:35]
    v_alignbit_b32 v48, v85, v84, v238
    s_waitcnt lgkmcnt(6)
    v_alignbit_b32 v49, v86, v85, v238
    v_mfma_f32_16x16x32_bf16 v[36:39], v[64:67], v[164:167], v[36:39]
    v_alignbit_b32 v50, v87, v86, v238
    v_alignbit_b32 v51, v88, v87, v238
    v_mfma_f32_16x16x32_bf16 v[40:43], v[64:67], v[168:171], v[40:43]
    v_alignbit_b32 v52, v95, v94, v238
    v_alignbit_b32 v53, v96, v95, v238
    v_mfma_f32_16x16x32_bf16 v[44:47], v[64:67], v[172:175], v[44:47]
    v_alignbit_b32 v54, v97, v96, v238
    v_alignbit_b32 v55, v98, v97, v238
    v_mfma_f32_16x16x32_bf16 v[36:39], v[68:71], v[160:163], v[36:39]
    v_alignbit_b32 v56, v105, v104, v238
    v_alignbit_b32 v57, v106, v105, v238
    v_mfma_f32_16x16x32_bf16 v[40:43], v[68:71], v[164:167], v[40:43]
    v_alignbit_b32 v58, v107, v106, v238
    v_alignbit_b32 v59, v108, v107, v238
    v_mfma_f32_16x16x32_bf16 v[44:47], v[68:71], v[168:171], v[44:47]
    v_alignbit_b32 v60, v115, v114, v238
    v_alignbit_b32 v61, v116, v115, v238
    v_mfma_f32_16x16x32_bf16 v[40:43], v[72:75], v[160:163], v[40:43]
    v_alignbit_b32 v62, v117, v116, v238
    v_alignbit_b32 v63, v118, v117, v238
    v_mfma_f32_16x16x32_bf16 v[44:47], v[72:75], v[164:167], v[44:47]
    v_alignbit_b32 v64, v125, v124, v238
    v_alignbit_b32 v65, v126, v125, v238
    v_mfma_f32_16x16x32_bf16 v[44:47], v[76:79], v[160:163], v[44:47]
    v_alignbit_b32 v66, v127, v126, v238
    v_alignbit_b32 v67, v128, v127, v238
    v_mfma_f32_16x16x32_bf16 v[16:19], v[48:51], v[192:195], v[16:19]
    v_alignbit_b32 v68, v135, v134, v238
    s_waitcnt lgkmcnt(0)
    v_alignbit_b32 v69, v136, v135, v238
    v_mfma_f32_16x16x32_bf16 v[20:23], v[48:51], v[196:199], v[20:23]
    v_alignbit_b32 v70, v137, v136, v238
    v_alignbit_b32 v71, v138, v137, v238
    v_mfma_f32_16x16x32_bf16 v[24:27], v[48:51], v[200:203], v[24:27]
    v_alignbit_b32 v72, v145, v144, v238
    v_alignbit_b32 v73, v146, v145, v238
    v_mfma_f32_16x16x32_bf16 v[28:31], v[48:51], v[204:207], v[28:31]
    v_alignbit_b32 v74, v147, v146, v238
    v_alignbit_b32 v75, v148, v147, v238
    v_mfma_f32_16x16x32_bf16 v[32:35], v[48:51], v[208:211], v[32:35]
    v_alignbit_b32 v76, v155, v154, v238
    v_alignbit_b32 v77, v156, v155, v238
    v_mfma_f32_16x16x32_bf16 v[36:39], v[48:51], v[212:215], v[36:39]
    v_alignbit_b32 v78, v157, v156, v238
    v_alignbit_b32 v79, v158, v157, v238
    v_mfma_f32_16x16x32_bf16 v[40:43], v[48:51], v[216:219], v[40:43]
    v_mfma_f32_16x16x32_bf16 v[44:47], v[48:51], v[220:223], v[44:47]
    v_mfma_f32_16x16x32_bf16 v[20:23], v[52:55], v[192:195], v[20:23]
    v_mfma_f32_16x16x32_bf16 v[24:27], v[52:55], v[196:199], v[24:27]
    v_mfma_f32_16x16x32_bf16 v[28:31], v[52:55], v[200:203], v[28:31]
    v_mfma_f32_16x16x32_bf16 v[32:35], v[52:55], v[204:207], v[32:35]
    v_mfma_f32_16x16x32_bf16 v[36:39], v[52:55], v[208:211], v[36:39]
    v_mfma_f32_16x16x32_bf16 v[40:43], v[52:55], v[212:215], v[40:43]
    v_mfma_f32_16x16x32_bf16 v[44:47], v[52:55], v[216:219], v[44:47]
    v_mfma_f32_16x16x32_bf16 v[24:27], v[56:59], v[192:195], v[24:27]
    v_mfma_f32_16x16x32_bf16 v[28:31], v[56:59], v[196:199], v[28:31]
    v_mfma_f32_16x16x32_bf16 v[32:35], v[56:59], v[200:203], v[32:35]
    v_mfma_f32_16x16x32_bf16 v[36:39], v[56:59], v[204:207], v[36:39]
    v_mfma_f32_16x16x32_bf16 v[40:43], v[56:59], v[208:211], v[40:43]
    v_mfma_f32_16x16x32_bf16 v[44:47], v[56:59], v[212:215], v[44:47]
    v_mfma_f32_16x16x32_bf16 v[28:31], v[60:63], v[192:195], v[28:31]
    ds_write_b128 v251, v[16:19] offset:0
    v_mfma_f32_16x16x32_bf16 v[32:35], v[60:63], v[196:199], v[32:35]
    v_mfma_f32_16x16x32_bf16 v[36:39], v[60:63], v[200:203], v[36:39]
    v_mfma_f32_16x16x32_bf16 v[40:43], v[60:63], v[204:207], v[40:43]
    v_mfma_f32_16x16x32_bf16 v[44:47], v[60:63], v[208:211], v[44:47]
    v_mfma_f32_16x16x32_bf16 v[32:35], v[64:67], v[192:195], v[32:35]
    ds_write_b128 v251, v[20:23] offset:1024
    v_mfma_f32_16x16x32_bf16 v[36:39], v[64:67], v[196:199], v[36:39]
    v_mfma_f32_16x16x32_bf16 v[40:43], v[64:67], v[200:203], v[40:43]
    v_mfma_f32_16x16x32_bf16 v[44:47], v[64:67], v[204:207], v[44:47]
    v_mfma_f32_16x16x32_bf16 v[36:39], v[68:71], v[192:195], v[36:39]
    ds_write_b128 v251, v[24:27] offset:2048
    v_mfma_f32_16x16x32_bf16 v[40:43], v[68:71], v[196:199], v[40:43]
    v_mfma_f32_16x16x32_bf16 v[44:47], v[68:71], v[200:203], v[44:47]
    v_mfma_f32_16x16x32_bf16 v[40:43], v[72:75], v[192:195], v[40:43]
    ds_write_b128 v251, v[28:31] offset:3072
    v_mfma_f32_16x16x32_bf16 v[44:47], v[72:75], v[196:199], v[44:47]
    v_mfma_f32_16x16x32_bf16 v[44:47], v[76:79], v[192:195], v[44:47]
    ds_write_b128 v251, v[32:35] offset:4096
    ds_write_b128 v251, v[36:39] offset:5120
    s_nop 2
    ds_write_b128 v251, v[40:43] offset:6144
    s_nop 1
    ds_write_b128 v251, v[44:47] offset:7168
    v_mov_b32 v13, s75
    v_mov_b32 v14, 1
    v_add_u32 v13, 81856, v13
    s_add_u32 s76, s76, 4
    s_mov_b64 exec, 1
    ds_add_u32 v13, v14
    s_mov_b64 exec, -1
L_BW_2:
    ds_read_b32 v14, v13
    s_waitcnt lgkmcnt(0)
    v_cmp_gt_u32 vcc, s76, v14
    s_nop 1
    s_cbranch_vccnz L_BW_2
    ds_read_b128 v[48:51], v252 offset:0
    ds_read_b128 v[52:55], v252 offset:256
    ds_read_b128 v[56:59], v252 offset:21504
    ds_read_b128 v[60:63], v252 offset:21760
    ds_read_b128 v[64:67], v252 offset:29696
    ds_read_b128 v[68:71], v252 offset:29952
    ds_read_b128 v[72:75], v252 offset:37888
    ds_read_b128 v[76:79], v252 offset:38144
    s_waitcnt lgkmcnt(5)
    v_add_f32 v48, v48, v56
    v_add_f32 v49, v49, v57
    v_add_f32 v50, v50, v58
    v_add_f32 v51, v51, v59
    s_waitcnt lgkmcnt(4)
    v_add_f32 v52, v52, v60
    v_add_f32 v53, v53, v61
    v_add_f32 v54, v54, v62
    v_add_f32 v55, v55, v63
    s_waitcnt lgkmcnt(1)
    v_add_f32 v64, v64, v72
    v_add_f32 v65, v65, v73
    v_add_f32 v66, v66, v74
    v_add_f32 v67, v67, v75
    s_waitcnt lgkmcnt(0)
    v_add_f32 v68, v68, v76
    v_add_f32 v69, v69, v77
    v_add_f32 v70, v70, v78
    v_add_f32 v71, v71, v79
    v_add_f32 v48, v48, v64
    v_add_f32 v49, v49, v65
    v_add_f32 v50, v50, v66
    v_add_f32 v51, v51, v67
    v_add_f32 v52, v52, v68
    v_add_f32 v53, v53, v69
    v_add_f32 v54, v54, v70
    v_add_f32 v55, v55, v71
    v_cvt_pk_bf16_f32 v80, v48, v49
    v_cvt_pk_bf16_f32 v81, v50, v51
    v_cvt_pk_bf16_f32 v82, v52, v53
    v_cvt_pk_bf16_f32 v83, v54, v55
    buffer_store_dwordx4 v[80:83], v6, s[48:51], s55 offen sc1
    v_mov_b32 v13, 81860
    v_mov_b32 v14, 1
    s_add_u32 s68, s26, s63
    s_addc_u32 s69, s27, 0
    s_mov_b32 s78, 1
    s_waitcnt vmcnt(0)
    s_mov_b64 exec, 1
    ds_add_rtn_u32 v12, v13, v14
    s_mov_b64 exec, -1
    s_waitcnt lgkmcnt(0)
    v_readfirstlane_b32 s79, v12
    s_nop 0
    s_cmp_lg_u32 s79, 3
    s_cbranch_scc1 L_SIG_0
    s_mov_b32 s79, 1
    s_atomic_add s79, s[68:69], 32768 glc
    s_waitcnt lgkmcnt(0)
    s_cmp_lg_u32 s79, 63
    s_cbranch_scc1 L_SIG_0
    s_atomic_add s78, s[68:69], 0
    s_waitcnt lgkmcnt(0)
L_SIG_0:
    s_branch L_FIN
L_Q:
    s_lshl_b32 s9, s57, 3
    s_lshl_b32 s53, s3, 1
    s_add_u32 s9, s9, s53
    s_mul_i32 s9, s9, 20
    s_sub_u32 s53, s58, 8
    s_mul_i32 s54, s53, 5
    s_add_u32 s9, s9, s54
    s_lshl_b32 s9, s9, 10
    s_add_u32 s9, s9, 7340032
    s_mul_i32 s55, s53, 17
    s_add_u32 s55, s55, s57
    s_lshl_b32 s55, s55, 7
    s_add_u32 s55, s55, 20480
    v_lshlrev_b32 v6, 4, v1
    s_waitcnt lgkmcnt(0)
    s_barrier
    ds_read_b128 v[176:179], v11 offset:36864
    ds_read_b128 v[180:183], v11 offset:38912
    ds_read_b128 v[184:187], v12 offset:36864
    ds_read_b128 v[188:191], v12 offset:38912
    ds_read_b64_tr_b16 v[96:97], v9 offset:36864
    ds_read_b64_tr_b16 v[98:99], v9 offset:38144
    ds_read_b64_tr_b16 v[100:101], v10 offset:36896
    ds_read_b64_tr_b16 v[102:103], v10 offset:38176
    ds_read_b64_tr_b16 v[104:105], v9 offset:36928
    ds_read_b64_tr_b16 v[106:107], v9 offset:38208
    ds_read_b64_tr_b16 v[108:109], v10 offset:36960
    ds_read_b64_tr_b16 v[110:111], v10 offset:38240
    ds_read_b64_tr_b16 v[112:113], v9 offset:36992
    ds_read_b64_tr_b16 v[114:115], v9 offset:38272
    ds_read_b64_tr_b16 v[116:117], v10 offset:37024
    ds_read_b64_tr_b16 v[118:119], v10 offset:38304
    ds_read_b64_tr_b16 v[120:121], v9 offset:37056
    ds_read_b64_tr_b16 v[122:123], v9 offset:38336
    ds_read_b64_tr_b16 v[124:125], v10 offset:37088
    ds_read_b64_tr_b16 v[126:127], v10 offset:38368
    ds_read_b64_tr_b16 v[128:129], v9 offset:37120
    ds_read_b64_tr_b16 v[130:131], v9 offset:38400
    ds_read_b64_tr_b16 v[132:133], v10 offset:37152
    ds_read_b64_tr_b16 v[134:135], v10 offset:38432
    s_waitcnt lgkmcnt(15)
    v_mfma_f32_16x16x32_bf16 v[16:19], v[96:99], v[176:179], 0
    ds_read_b64_tr_b16 v[136:137], v9 offset:47104
    v_mfma_f32_16x16x32_bf16 v[56:59], v[96:99], v[180:183], 0
    ds_read_b64_tr_b16 v[138:139], v9 offset:48384
    v_mfma_f32_16x16x32_bf16 v[20:23], v[100:103], v[176:179], 0
    ds_read_b64_tr_b16 v[140:141], v10 offset:47136
    v_mfma_f32_16x16x32_bf16 v[60:63], v[100:103], v[180:183], 0
    ds_read_b64_tr_b16 v[142:143], v10 offset:48416
    s_waitcnt lgkmcnt(15)
    v_mfma_f32_16x16x32_bf16 v[24:27], v[104:107], v[176:179], 0
    ds_read_b64_tr_b16 v[144:145], v9 offset:47168
    v_mfma_f32_16x16x32_bf16 v[64:67], v[104:107], v[180:183], 0
    ds_read_b64_tr_b16 v[146:147], v9 offset:48448
    v_mfma_f32_16x16x32_bf16 v[28:31], v[108:111], v[176:179], 0
    ds_read_b64_tr_b16 v[148:149], v10 offset:47200
    v_mfma_f32_16x16x32_bf16 v[68:71], v[108:111], v[180:183], 0
    ds_read_b64_tr_b16 v[150:151], v10 offset:48480
    s_waitcnt lgkmcnt(11)
    v_mfma_f32_16x16x32_bf16 v[32:35], v[112:115], v[176:179], 0
    ds_read_b64_tr_b16 v[152:153], v9 offset:47232
    v_mfma_f32_16x16x32_bf16 v[72:75], v[112:115], v[180:183], 0
    ds_read_b64_tr_b16 v[154:155], v9 offset:48512
    v_mfma_f32_16x16x32_bf16 v[36:39], v[116:119], v[176:179], 0
    ds_read_b64_tr_b16 v[156:157], v10 offset:47264
    v_mfma_f32_16x16x32_bf16 v[76:79], v[116:119], v[180:183], 0
    ds_read_b64_tr_b16 v[158:159], v10 offset:48544
    v_mfma_f32_16x16x32_bf16 v[40:43], v[120:123], v[176:179], 0
    ds_read_b64_tr_b16 v[160:161], v9 offset:47296
    v_mfma_f32_16x16x32_bf16 v[80:83], v[120:123], v[180:183], 0
    ds_read_b64_tr_b16 v[162:163], v9 offset:48576
    v_mfma_f32_16x16x32_bf16 v[44:47], v[124:127], v[176:179], 0
    ds_read_b64_tr_b16 v[164:165], v10 offset:47328
    v_mfma_f32_16x16x32_bf16 v[84:87], v[124:127], v[180:183], 0
    ds_read_b64_tr_b16 v[166:167], v10 offset:48608
    s_waitcnt lgkmcnt(10)
    v_mfma_f32_16x16x32_bf16 v[48:51], v[128:131], v[176:179], 0
    ds_read_b64_tr_b16 v[168:169], v9 offset:47360
    v_mfma_f32_16x16x32_bf16 v[88:91], v[128:131], v[180:183], 0
    ds_read_b64_tr_b16 v[170:171], v9 offset:48640
    v_mfma_f32_16x16x32_bf16 v[52:55], v[132:135], v[176:179], 0
    ds_read_b64_tr_b16 v[172:173], v10 offset:47392
    v_mfma_f32_16x16x32_bf16 v[92:95], v[132:135], v[180:183], 0
    ds_read_b64_tr_b16 v[174:175], v10 offset:48672
    v_mfma_f32_16x16x32_bf16 v[16:19], v[136:139], v[184:187], v[16:19]
    v_mfma_f32_16x16x32_bf16 v[56:59], v[136:139], v[188:191], v[56:59]
    v_mfma_f32_16x16x32_bf16 v[20:23], v[140:143], v[184:187], v[20:23]
    s_waitcnt lgkmcnt(0)
    s_barrier
    v_mfma_f32_16x16x32_bf16 v[60:63], v[140:143], v[188:191], v[60:63]
    ds_read_b128 v[192:195], v11 offset:0
    ds_read_b128 v[196:199], v11 offset:2048
    v_mfma_f32_16x16x32_bf16 v[24:27], v[144:147], v[184:187], v[24:27]
    ds_read_b128 v[200:203], v12 offset:0
    v_mfma_f32_16x16x32_bf16 v[64:67], v[144:147], v[188:191], v[64:67]
    ds_read_b128 v[204:207], v12 offset:2048
    ds_read_b64_tr_b16 v[96:97], v9 offset:0
    v_mfma_f32_16x16x32_bf16 v[28:31], v[148:151], v[184:187], v[28:31]
    ds_read_b64_tr_b16 v[98:99], v9 offset:1280
    v_mfma_f32_16x16x32_bf16 v[68:71], v[148:151], v[188:191], v[68:71]
    ds_read_b64_tr_b16 v[100:101], v10 offset:32
    ds_read_b64_tr_b16 v[102:103], v10 offset:1312
    v_mfma_f32_16x16x32_bf16 v[32:35], v[152:155], v[184:187], v[32:35]
    ds_read_b64_tr_b16 v[104:105], v9 offset:64
    v_mfma_f32_16x16x32_bf16 v[72:75], v[152:155], v[188:191], v[72:75]
    ds_read_b64_tr_b16 v[106:107], v9 offset:1344
    v_mfma_f32_16x16x32_bf16 v[36:39], v[156:159], v[184:187], v[36:39]
    ds_read_b64_tr_b16 v[108:109], v10 offset:96
    ds_read_b64_tr_b16 v[110:111], v10 offset:1376
    v_mfma_f32_16x16x32_bf16 v[76:79], v[156:159], v[188:191], v[76:79]
    ds_read_b64_tr_b16 v[112:113], v9 offset:128
    v_mfma_f32_16x16x32_bf16 v[40:43], v[160:163], v[184:187], v[40:43]
    ds_read_b64_tr_b16 v[114:115], v9 offset:1408
    ds_read_b64_tr_b16 v[116:117], v10 offset:160
    v_mfma_f32_16x16x32_bf16 v[80:83], v[160:163], v[188:191], v[80:83]
    ds_read_b64_tr_b16 v[118:119], v10 offset:1440
    v_mfma_f32_16x16x32_bf16 v[44:47], v[164:167], v[184:187], v[44:47]
    ds_read_b64_tr_b16 v[120:121], v9 offset:192
    v_mfma_f32_16x16x32_bf16 v[84:87], v[164:167], v[188:191], v[84:87]
    ds_read_b64_tr_b16 v[122:123], v9 offset:1472
    ds_read_b64_tr_b16 v[124:125], v10 offset:224
    v_mfma_f32_16x16x32_bf16 v[48:51], v[168:171], v[184:187], v[48:51]
    ds_read_b64_tr_b16 v[126:127], v10 offset:1504
    v_mfma_f32_16x16x32_bf16 v[88:91], v[168:171], v[188:191], v[88:91]
    ds_read_b64_tr_b16 v[128:129], v9 offset:256
    ds_read_b64_tr_b16 v[130:131], v9 offset:1536
    v_mfma_f32_16x16x32_bf16 v[52:55], v[172:175], v[184:187], v[52:55]
    ds_read_b64_tr_b16 v[132:133], v10 offset:288
    v_mfma_f32_16x16x32_bf16 v[92:95], v[172:175], v[188:191], v[92:95]
    ds_read_b64_tr_b16 v[134:135], v10 offset:1568
    s_waitcnt lgkmcnt(11)
    v_mfma_f32_16x16x32_bf16 v[16:19], v[96:99], v[192:195], v[16:19]
    ds_read_b64_tr_b16 v[136:137], v9 offset:10240
    v_mfma_f32_16x16x32_bf16 v[56:59], v[96:99], v[196:199], v[56:59]
    ds_read_b64_tr_b16 v[138:139], v9 offset:11520
    v_mfma_f32_16x16x32_bf16 v[20:23], v[100:103], v[192:195], v[20:23]
    ds_read_b64_tr_b16 v[140:141], v10 offset:10272
    v_mfma_f32_16x16x32_bf16 v[60:63], v[100:103], v[196:199], v[60:63]
    ds_read_b64_tr_b16 v[142:143], v10 offset:11552
    v_mfma_f32_16x16x32_bf16 v[24:27], v[104:107], v[192:195], v[24:27]
    ds_read_b64_tr_b16 v[144:145], v9 offset:10304
    v_mfma_f32_16x16x32_bf16 v[64:67], v[104:107], v[196:199], v[64:67]
    ds_read_b64_tr_b16 v[146:147], v9 offset:11584
    v_mfma_f32_16x16x32_bf16 v[28:31], v[108:111], v[192:195], v[28:31]
    ds_read_b64_tr_b16 v[148:149], v10 offset:10336
    v_mfma_f32_16x16x32_bf16 v[68:71], v[108:111], v[196:199], v[68:71]
    ds_read_b64_tr_b16 v[150:151], v10 offset:11616
    s_waitcnt lgkmcnt(10)
    v_mfma_f32_16x16x32_bf16 v[32:35], v[112:115], v[192:195], v[32:35]
    ds_read_b64_tr_b16 v[152:153], v9 offset:10368
    v_mfma_f32_16x16x32_bf16 v[72:75], v[112:115], v[196:199], v[72:75]
    ds_read_b64_tr_b16 v[154:155], v9 offset:11648
    v_mfma_f32_16x16x32_bf16 v[36:39], v[116:119], v[192:195], v[36:39]
    ds_read_b64_tr_b16 v[156:157], v10 offset:10400
    v_mfma_f32_16x16x32_bf16 v[76:79], v[116:119], v[196:199], v[76:79]
    ds_read_b64_tr_b16 v[158:159], v10 offset:11680
    v_mfma_f32_16x16x32_bf16 v[40:43], v[120:123], v[192:195], v[40:43]
    ds_read_b64_tr_b16 v[160:161], v9 offset:10432
    v_mfma_f32_16x16x32_bf16 v[80:83], v[120:123], v[196:199], v[80:83]
    ds_read_b64_tr_b16 v[162:163], v9 offset:11712
    v_mfma_f32_16x16x32_bf16 v[44:47], v[124:127], v[192:195], v[44:47]
    ds_read_b64_tr_b16 v[164:165], v10 offset:10464
    v_mfma_f32_16x16x32_bf16 v[84:87], v[124:127], v[196:199], v[84:87]
    ds_read_b64_tr_b16 v[166:167], v10 offset:11744
    v_mfma_f32_16x16x32_bf16 v[48:51], v[128:131], v[192:195], v[48:51]
    ds_read_b64_tr_b16 v[168:169], v9 offset:10496
    v_mfma_f32_16x16x32_bf16 v[88:91], v[128:131], v[196:199], v[88:91]
    ds_read_b64_tr_b16 v[170:171], v9 offset:11776
    s_waitcnt lgkmcnt(10)
    v_mfma_f32_16x16x32_bf16 v[52:55], v[132:135], v[192:195], v[52:55]
    ds_read_b64_tr_b16 v[172:173], v10 offset:10528
    v_mfma_f32_16x16x32_bf16 v[92:95], v[132:135], v[196:199], v[92:95]
    ds_read_b64_tr_b16 v[174:175], v10 offset:11808
    v_mfma_f32_16x16x32_bf16 v[16:19], v[136:139], v[200:203], v[16:19]
    v_mfma_f32_16x16x32_bf16 v[56:59], v[136:139], v[204:207], v[56:59]
    v_mfma_f32_16x16x32_bf16 v[20:23], v[140:143], v[200:203], v[20:23]
    s_waitcnt lgkmcnt(0)
    s_barrier
    v_mfma_f32_16x16x32_bf16 v[60:63], v[140:143], v[204:207], v[60:63]
    ds_read_b128 v[176:179], v4 offset:36864
    ds_read_b128 v[180:183], v4 offset:38912
    v_mfma_f32_16x16x32_bf16 v[24:27], v[144:147], v[200:203], v[24:27]
    ds_read_b128 v[184:187], v5 offset:36864
    v_mfma_f32_16x16x32_bf16 v[64:67], v[144:147], v[204:207], v[64:67]
    ds_read_b128 v[188:191], v5 offset:38912
    ds_read_b64_tr_b16 v[96:97], v2 offset:36864
    v_mfma_f32_16x16x32_bf16 v[28:31], v[148:151], v[200:203], v[28:31]
    ds_read_b64_tr_b16 v[98:99], v2 offset:38144
    v_mfma_f32_16x16x32_bf16 v[68:71], v[148:151], v[204:207], v[68:71]
    ds_read_b64_tr_b16 v[100:101], v3 offset:36896
    ds_read_b64_tr_b16 v[102:103], v3 offset:38176
    v_mfma_f32_16x16x32_bf16 v[32:35], v[152:155], v[200:203], v[32:35]
    ds_read_b64_tr_b16 v[104:105], v2 offset:36928
    v_mfma_f32_16x16x32_bf16 v[72:75], v[152:155], v[204:207], v[72:75]
    ds_read_b64_tr_b16 v[106:107], v2 offset:38208
    v_mfma_f32_16x16x32_bf16 v[36:39], v[156:159], v[200:203], v[36:39]
    ds_read_b64_tr_b16 v[108:109], v3 offset:36960
    ds_read_b64_tr_b16 v[110:111], v3 offset:38240
    v_mfma_f32_16x16x32_bf16 v[76:79], v[156:159], v[204:207], v[76:79]
    ds_read_b64_tr_b16 v[112:113], v2 offset:36992
    v_mfma_f32_16x16x32_bf16 v[40:43], v[160:163], v[200:203], v[40:43]
    ds_read_b64_tr_b16 v[114:115], v2 offset:38272
    ds_read_b64_tr_b16 v[116:117], v3 offset:37024
    v_mfma_f32_16x16x32_bf16 v[80:83], v[160:163], v[204:207], v[80:83]
    ds_read_b64_tr_b16 v[118:119], v3 offset:38304
    v_mfma_f32_16x16x32_bf16 v[44:47], v[164:167], v[200:203], v[44:47]
    ds_read_b64_tr_b16 v[120:121], v2 offset:37056
    v_mfma_f32_16x16x32_bf16 v[84:87], v[164:167], v[204:207], v[84:87]
    ds_read_b64_tr_b16 v[122:123], v2 offset:38336
    ds_read_b64_tr_b16 v[124:125], v3 offset:37088
    v_mfma_f32_16x16x32_bf16 v[48:51], v[168:171], v[200:203], v[48:51]
    ds_read_b64_tr_b16 v[126:127], v3 offset:38368
    v_mfma_f32_16x16x32_bf16 v[88:91], v[168:171], v[204:207], v[88:91]
    ds_read_b64_tr_b16 v[128:129], v2 offset:37120
    ds_read_b64_tr_b16 v[130:131], v2 offset:38400
    v_mfma_f32_16x16x32_bf16 v[52:55], v[172:175], v[200:203], v[52:55]
    ds_read_b64_tr_b16 v[132:133], v3 offset:37152
    v_mfma_f32_16x16x32_bf16 v[92:95], v[172:175], v[204:207], v[92:95]
    ds_read_b64_tr_b16 v[134:135], v3 offset:38432
    s_waitcnt lgkmcnt(11)
    v_mfma_f32_16x16x32_bf16 v[16:19], v[96:99], v[176:179], v[16:19]
    ds_read_b64_tr_b16 v[136:137], v2 offset:47104
    v_mfma_f32_16x16x32_bf16 v[56:59], v[96:99], v[180:183], v[56:59]
    ds_read_b64_tr_b16 v[138:139], v2 offset:48384
    v_mfma_f32_16x16x32_bf16 v[20:23], v[100:103], v[176:179], v[20:23]
    ds_read_b64_tr_b16 v[140:141], v3 offset:47136
    v_mfma_f32_16x16x32_bf16 v[60:63], v[100:103], v[180:183], v[60:63]
    ds_read_b64_tr_b16 v[142:143], v3 offset:48416
    v_mfma_f32_16x16x32_bf16 v[24:27], v[104:107], v[176:179], v[24:27]
    ds_read_b64_tr_b16 v[144:145], v2 offset:47168
    v_mfma_f32_16x16x32_bf16 v[64:67], v[104:107], v[180:183], v[64:67]
    ds_read_b64_tr_b16 v[146:147], v2 offset:48448
    v_mfma_f32_16x16x32_bf16 v[28:31], v[108:111], v[176:179], v[28:31]
    ds_read_b64_tr_b16 v[148:149], v3 offset:47200
    v_mfma_f32_16x16x32_bf16 v[68:71], v[108:111], v[180:183], v[68:71]
    ds_read_b64_tr_b16 v[150:151], v3 offset:48480
    s_waitcnt lgkmcnt(10)
    v_mfma_f32_16x16x32_bf16 v[32:35], v[112:115], v[176:179], v[32:35]
    ds_read_b64_tr_b16 v[152:153], v2 offset:47232
    v_mfma_f32_16x16x32_bf16 v[72:75], v[112:115], v[180:183], v[72:75]
    ds_read_b64_tr_b16 v[154:155], v2 offset:48512
    v_mfma_f32_16x16x32_bf16 v[36:39], v[116:119], v[176:179], v[36:39]
    ds_read_b64_tr_b16 v[156:157], v3 offset:47264
    v_mfma_f32_16x16x32_bf16 v[76:79], v[116:119], v[180:183], v[76:79]
    ds_read_b64_tr_b16 v[158:159], v3 offset:48544
    v_mfma_f32_16x16x32_bf16 v[40:43], v[120:123], v[176:179], v[40:43]
    ds_read_b64_tr_b16 v[160:161], v2 offset:47296
    v_mfma_f32_16x16x32_bf16 v[80:83], v[120:123], v[180:183], v[80:83]
    ds_read_b64_tr_b16 v[162:163], v2 offset:48576
    v_mfma_f32_16x16x32_bf16 v[44:47], v[124:127], v[176:179], v[44:47]
    ds_read_b64_tr_b16 v[164:165], v3 offset:47328
    v_mfma_f32_16x16x32_bf16 v[84:87], v[124:127], v[180:183], v[84:87]
    ds_read_b64_tr_b16 v[166:167], v3 offset:48608
    v_mfma_f32_16x16x32_bf16 v[48:51], v[128:131], v[176:179], v[48:51]
    ds_read_b64_tr_b16 v[168:169], v2 offset:47360
    v_mfma_f32_16x16x32_bf16 v[88:91], v[128:131], v[180:183], v[88:91]
    ds_read_b64_tr_b16 v[170:171], v2 offset:48640
    s_waitcnt lgkmcnt(10)
    v_mfma_f32_16x16x32_bf16 v[52:55], v[132:135], v[176:179], v[52:55]
    ds_read_b64_tr_b16 v[172:173], v3 offset:47392
    v_mfma_f32_16x16x32_bf16 v[92:95], v[132:135], v[180:183], v[92:95]
    ds_read_b64_tr_b16 v[174:175], v3 offset:48672
    v_mfma_f32_16x16x32_bf16 v[16:19], v[136:139], v[184:187], v[16:19]
    v_mfma_f32_16x16x32_bf16 v[56:59], v[136:139], v[188:191], v[56:59]
    v_mfma_f32_16x16x32_bf16 v[20:23], v[140:143], v[184:187], v[20:23]
    s_waitcnt lgkmcnt(0)
    s_barrier
    v_mfma_f32_16x16x32_bf16 v[60:63], v[140:143], v[188:191], v[60:63]
    ds_read_b128 v[192:195], v4 offset:0
    ds_read_b128 v[196:199], v4 offset:2048
    v_mfma_f32_16x16x32_bf16 v[24:27], v[144:147], v[184:187], v[24:27]
    ds_read_b128 v[200:203], v5 offset:0
    v_mfma_f32_16x16x32_bf16 v[64:67], v[144:147], v[188:191], v[64:67]
    ds_read_b128 v[204:207], v5 offset:2048
    ds_read_b64_tr_b16 v[96:97], v2 offset:0
    v_mfma_f32_16x16x32_bf16 v[28:31], v[148:151], v[184:187], v[28:31]
    ds_read_b64_tr_b16 v[98:99], v2 offset:1280
    v_mfma_f32_16x16x32_bf16 v[68:71], v[148:151], v[188:191], v[68:71]
    ds_read_b64_tr_b16 v[100:101], v3 offset:32
    ds_read_b64_tr_b16 v[102:103], v3 offset:1312
    v_mfma_f32_16x16x32_bf16 v[32:35], v[152:155], v[184:187], v[32:35]
    ds_read_b64_tr_b16 v[104:105], v2 offset:64
    v_mfma_f32_16x16x32_bf16 v[72:75], v[152:155], v[188:191], v[72:75]
    ds_read_b64_tr_b16 v[106:107], v2 offset:1344
    v_mfma_f32_16x16x32_bf16 v[36:39], v[156:159], v[184:187], v[36:39]
    ds_read_b64_tr_b16 v[108:109], v3 offset:96
    ds_read_b64_tr_b16 v[110:111], v3 offset:1376
    v_mfma_f32_16x16x32_bf16 v[76:79], v[156:159], v[188:191], v[76:79]
    ds_read_b64_tr_b16 v[112:113], v2 offset:128
    v_mfma_f32_16x16x32_bf16 v[40:43], v[160:163], v[184:187], v[40:43]
    ds_read_b64_tr_b16 v[114:115], v2 offset:1408
    ds_read_b64_tr_b16 v[116:117], v3 offset:160
    v_mfma_f32_16x16x32_bf16 v[80:83], v[160:163], v[188:191], v[80:83]
    ds_read_b64_tr_b16 v[118:119], v3 offset:1440
    v_mfma_f32_16x16x32_bf16 v[44:47], v[164:167], v[184:187], v[44:47]
    ds_read_b64_tr_b16 v[120:121], v2 offset:192
    v_mfma_f32_16x16x32_bf16 v[84:87], v[164:167], v[188:191], v[84:87]
    ds_read_b64_tr_b16 v[122:123], v2 offset:1472
    ds_read_b64_tr_b16 v[124:125], v3 offset:224
    v_mfma_f32_16x16x32_bf16 v[48:51], v[168:171], v[184:187], v[48:51]
    ds_read_b64_tr_b16 v[126:127], v3 offset:1504
    v_mfma_f32_16x16x32_bf16 v[88:91], v[168:171], v[188:191], v[88:91]
    ds_read_b64_tr_b16 v[128:129], v2 offset:256
    ds_read_b64_tr_b16 v[130:131], v2 offset:1536
    v_mfma_f32_16x16x32_bf16 v[52:55], v[172:175], v[184:187], v[52:55]
    ds_read_b64_tr_b16 v[132:133], v3 offset:288
    v_mfma_f32_16x16x32_bf16 v[92:95], v[172:175], v[188:191], v[92:95]
    ds_read_b64_tr_b16 v[134:135], v3 offset:1568
    s_waitcnt lgkmcnt(11)
    v_mfma_f32_16x16x32_bf16 v[16:19], v[96:99], v[192:195], v[16:19]
    ds_read_b64_tr_b16 v[136:137], v2 offset:10240
    v_mfma_f32_16x16x32_bf16 v[56:59], v[96:99], v[196:199], v[56:59]
    ds_read_b64_tr_b16 v[138:139], v2 offset:11520
    v_mfma_f32_16x16x32_bf16 v[20:23], v[100:103], v[192:195], v[20:23]
    ds_read_b64_tr_b16 v[140:141], v3 offset:10272
    v_mfma_f32_16x16x32_bf16 v[60:63], v[100:103], v[196:199], v[60:63]
    ds_read_b64_tr_b16 v[142:143], v3 offset:11552
    v_mfma_f32_16x16x32_bf16 v[24:27], v[104:107], v[192:195], v[24:27]
    ds_read_b64_tr_b16 v[144:145], v2 offset:10304
    v_mfma_f32_16x16x32_bf16 v[64:67], v[104:107], v[196:199], v[64:67]
    ds_read_b64_tr_b16 v[146:147], v2 offset:11584
    v_mfma_f32_16x16x32_bf16 v[28:31], v[108:111], v[192:195], v[28:31]
    ds_read_b64_tr_b16 v[148:149], v3 offset:10336
    v_mfma_f32_16x16x32_bf16 v[68:71], v[108:111], v[196:199], v[68:71]
    ds_read_b64_tr_b16 v[150:151], v3 offset:11616
    s_waitcnt lgkmcnt(10)
    v_mfma_f32_16x16x32_bf16 v[32:35], v[112:115], v[192:195], v[32:35]
    ds_read_b64_tr_b16 v[152:153], v2 offset:10368
    v_mfma_f32_16x16x32_bf16 v[72:75], v[112:115], v[196:199], v[72:75]
    ds_read_b64_tr_b16 v[154:155], v2 offset:11648
    v_mfma_f32_16x16x32_bf16 v[36:39], v[116:119], v[192:195], v[36:39]
    ds_read_b64_tr_b16 v[156:157], v3 offset:10400
    v_mfma_f32_16x16x32_bf16 v[76:79], v[116:119], v[196:199], v[76:79]
    ds_read_b64_tr_b16 v[158:159], v3 offset:11680
    v_mfma_f32_16x16x32_bf16 v[40:43], v[120:123], v[192:195], v[40:43]
    ds_read_b64_tr_b16 v[160:161], v2 offset:10432
    v_mfma_f32_16x16x32_bf16 v[80:83], v[120:123], v[196:199], v[80:83]
    ds_read_b64_tr_b16 v[162:163], v2 offset:11712
    v_mfma_f32_16x16x32_bf16 v[44:47], v[124:127], v[192:195], v[44:47]
    ds_read_b64_tr_b16 v[164:165], v3 offset:10464
    v_mfma_f32_16x16x32_bf16 v[84:87], v[124:127], v[196:199], v[84:87]
    ds_read_b64_tr_b16 v[166:167], v3 offset:11744
    v_mfma_f32_16x16x32_bf16 v[48:51], v[128:131], v[192:195], v[48:51]
    ds_read_b64_tr_b16 v[168:169], v2 offset:10496
    v_mfma_f32_16x16x32_bf16 v[88:91], v[128:131], v[196:199], v[88:91]
    ds_read_b64_tr_b16 v[170:171], v2 offset:11776
    s_waitcnt lgkmcnt(10)
    v_mfma_f32_16x16x32_bf16 v[52:55], v[132:135], v[192:195], v[52:55]
    ds_read_b64_tr_b16 v[172:173], v3 offset:10528
    v_mfma_f32_16x16x32_bf16 v[92:95], v[132:135], v[196:199], v[92:95]
    ds_read_b64_tr_b16 v[174:175], v3 offset:11808
    v_mfma_f32_16x16x32_bf16 v[16:19], v[136:139], v[200:203], v[16:19]
    v_mfma_f32_16x16x32_bf16 v[56:59], v[136:139], v[204:207], v[56:59]
    v_mfma_f32_16x16x32_bf16 v[20:23], v[140:143], v[200:203], v[20:23]
    s_waitcnt lgkmcnt(0)
    s_barrier
    v_mfma_f32_16x16x32_bf16 v[60:63], v[140:143], v[204:207], v[60:63]
    ds_read_b128 v[176:179], v11 offset:36864
    ds_read_b128 v[180:183], v11 offset:38912
    v_mfma_f32_16x16x32_bf16 v[24:27], v[144:147], v[200:203], v[24:27]
    ds_read_b128 v[184:187], v12 offset:36864
    v_mfma_f32_16x16x32_bf16 v[64:67], v[144:147], v[204:207], v[64:67]
    ds_read_b128 v[188:191], v12 offset:38912
    ds_read_b64_tr_b16 v[96:97], v9 offset:36864
    v_mfma_f32_16x16x32_bf16 v[28:31], v[148:151], v[200:203], v[28:31]
    ds_read_b64_tr_b16 v[98:99], v9 offset:38144
    v_mfma_f32_16x16x32_bf16 v[68:71], v[148:151], v[204:207], v[68:71]
    ds_read_b64_tr_b16 v[100:101], v10 offset:36896
    ds_read_b64_tr_b16 v[102:103], v10 offset:38176
    v_mfma_f32_16x16x32_bf16 v[32:35], v[152:155], v[200:203], v[32:35]
    ds_read_b64_tr_b16 v[104:105], v9 offset:36928
    v_mfma_f32_16x16x32_bf16 v[72:75], v[152:155], v[204:207], v[72:75]
    ds_read_b64_tr_b16 v[106:107], v9 offset:38208
    v_mfma_f32_16x16x32_bf16 v[36:39], v[156:159], v[200:203], v[36:39]
    ds_read_b64_tr_b16 v[108:109], v10 offset:36960
    ds_read_b64_tr_b16 v[110:111], v10 offset:38240
    v_mfma_f32_16x16x32_bf16 v[76:79], v[156:159], v[204:207], v[76:79]
    ds_read_b64_tr_b16 v[112:113], v9 offset:36992
    v_mfma_f32_16x16x32_bf16 v[40:43], v[160:163], v[200:203], v[40:43]
    ds_read_b64_tr_b16 v[114:115], v9 offset:38272
    ds_read_b64_tr_b16 v[116:117], v10 offset:37024
    v_mfma_f32_16x16x32_bf16 v[80:83], v[160:163], v[204:207], v[80:83]
    ds_read_b64_tr_b16 v[118:119], v10 offset:38304
    v_mfma_f32_16x16x32_bf16 v[44:47], v[164:167], v[200:203], v[44:47]
    ds_read_b64_tr_b16 v[120:121], v9 offset:37056
    v_mfma_f32_16x16x32_bf16 v[84:87], v[164:167], v[204:207], v[84:87]
    ds_read_b64_tr_b16 v[122:123], v9 offset:38336
    ds_read_b64_tr_b16 v[124:125], v10 offset:37088
    v_mfma_f32_16x16x32_bf16 v[48:51], v[168:171], v[200:203], v[48:51]
    ds_read_b64_tr_b16 v[126:127], v10 offset:38368
    v_mfma_f32_16x16x32_bf16 v[88:91], v[168:171], v[204:207], v[88:91]
    ds_read_b64_tr_b16 v[128:129], v9 offset:37120
    ds_read_b64_tr_b16 v[130:131], v9 offset:38400
    v_mfma_f32_16x16x32_bf16 v[52:55], v[172:175], v[200:203], v[52:55]
    ds_read_b64_tr_b16 v[132:133], v10 offset:37152
    v_mfma_f32_16x16x32_bf16 v[92:95], v[172:175], v[204:207], v[92:95]
    ds_read_b64_tr_b16 v[134:135], v10 offset:38432
    s_waitcnt lgkmcnt(11)
    v_mfma_f32_16x16x32_bf16 v[16:19], v[96:99], v[176:179], v[16:19]
    ds_read_b64_tr_b16 v[136:137], v9 offset:47104
    v_mfma_f32_16x16x32_bf16 v[56:59], v[96:99], v[180:183], v[56:59]
    ds_read_b64_tr_b16 v[138:139], v9 offset:48384
    v_mfma_f32_16x16x32_bf16 v[20:23], v[100:103], v[176:179], v[20:23]
    ds_read_b64_tr_b16 v[140:141], v10 offset:47136
    v_mfma_f32_16x16x32_bf16 v[60:63], v[100:103], v[180:183], v[60:63]
    ds_read_b64_tr_b16 v[142:143], v10 offset:48416
    v_mfma_f32_16x16x32_bf16 v[24:27], v[104:107], v[176:179], v[24:27]
    ds_read_b64_tr_b16 v[144:145], v9 offset:47168
    v_mfma_f32_16x16x32_bf16 v[64:67], v[104:107], v[180:183], v[64:67]
    ds_read_b64_tr_b16 v[146:147], v9 offset:48448
    v_mfma_f32_16x16x32_bf16 v[28:31], v[108:111], v[176:179], v[28:31]
    ds_read_b64_tr_b16 v[148:149], v10 offset:47200
    v_mfma_f32_16x16x32_bf16 v[68:71], v[108:111], v[180:183], v[68:71]
    ds_read_b64_tr_b16 v[150:151], v10 offset:48480
    s_waitcnt lgkmcnt(10)
    v_mfma_f32_16x16x32_bf16 v[32:35], v[112:115], v[176:179], v[32:35]
    ds_read_b64_tr_b16 v[152:153], v9 offset:47232
    v_mfma_f32_16x16x32_bf16 v[72:75], v[112:115], v[180:183], v[72:75]
    ds_read_b64_tr_b16 v[154:155], v9 offset:48512
    v_mfma_f32_16x16x32_bf16 v[36:39], v[116:119], v[176:179], v[36:39]
    ds_read_b64_tr_b16 v[156:157], v10 offset:47264
    v_mfma_f32_16x16x32_bf16 v[76:79], v[116:119], v[180:183], v[76:79]
    ds_read_b64_tr_b16 v[158:159], v10 offset:48544
    v_mfma_f32_16x16x32_bf16 v[40:43], v[120:123], v[176:179], v[40:43]
    ds_read_b64_tr_b16 v[160:161], v9 offset:47296
    v_mfma_f32_16x16x32_bf16 v[80:83], v[120:123], v[180:183], v[80:83]
    ds_read_b64_tr_b16 v[162:163], v9 offset:48576
    v_mfma_f32_16x16x32_bf16 v[44:47], v[124:127], v[176:179], v[44:47]
    ds_read_b64_tr_b16 v[164:165], v10 offset:47328
    v_mfma_f32_16x16x32_bf16 v[84:87], v[124:127], v[180:183], v[84:87]
    ds_read_b64_tr_b16 v[166:167], v10 offset:48608
    v_mfma_f32_16x16x32_bf16 v[48:51], v[128:131], v[176:179], v[48:51]
    ds_read_b64_tr_b16 v[168:169], v9 offset:47360
    v_mfma_f32_16x16x32_bf16 v[88:91], v[128:131], v[180:183], v[88:91]
    ds_read_b64_tr_b16 v[170:171], v9 offset:48640
    s_waitcnt lgkmcnt(10)
    v_mfma_f32_16x16x32_bf16 v[52:55], v[132:135], v[176:179], v[52:55]
    ds_read_b64_tr_b16 v[172:173], v10 offset:47392
    v_mfma_f32_16x16x32_bf16 v[92:95], v[132:135], v[180:183], v[92:95]
    ds_read_b64_tr_b16 v[174:175], v10 offset:48672
    v_mfma_f32_16x16x32_bf16 v[16:19], v[136:139], v[184:187], v[16:19]
    v_mfma_f32_16x16x32_bf16 v[56:59], v[136:139], v[188:191], v[56:59]
    v_mfma_f32_16x16x32_bf16 v[20:23], v[140:143], v[184:187], v[20:23]
    s_waitcnt lgkmcnt(0)
    s_barrier
    v_mfma_f32_16x16x32_bf16 v[60:63], v[140:143], v[188:191], v[60:63]
    ds_read_b128 v[192:195], v11 offset:0
    ds_read_b128 v[196:199], v11 offset:2048
    v_mfma_f32_16x16x32_bf16 v[24:27], v[144:147], v[184:187], v[24:27]
    ds_read_b128 v[200:203], v12 offset:0
    v_mfma_f32_16x16x32_bf16 v[64:67], v[144:147], v[188:191], v[64:67]
    ds_read_b128 v[204:207], v12 offset:2048
    ds_read_b64_tr_b16 v[96:97], v9 offset:0
    v_mfma_f32_16x16x32_bf16 v[28:31], v[148:151], v[184:187], v[28:31]
    ds_read_b64_tr_b16 v[98:99], v9 offset:1280
    v_mfma_f32_16x16x32_bf16 v[68:71], v[148:151], v[188:191], v[68:71]
    ds_read_b64_tr_b16 v[100:101], v10 offset:32
    ds_read_b64_tr_b16 v[102:103], v10 offset:1312
    v_mfma_f32_16x16x32_bf16 v[32:35], v[152:155], v[184:187], v[32:35]
    ds_read_b64_tr_b16 v[104:105], v9 offset:64
    v_mfma_f32_16x16x32_bf16 v[72:75], v[152:155], v[188:191], v[72:75]
    ds_read_b64_tr_b16 v[106:107], v9 offset:1344
    v_mfma_f32_16x16x32_bf16 v[36:39], v[156:159], v[184:187], v[36:39]
    ds_read_b64_tr_b16 v[108:109], v10 offset:96
    ds_read_b64_tr_b16 v[110:111], v10 offset:1376
    v_mfma_f32_16x16x32_bf16 v[76:79], v[156:159], v[188:191], v[76:79]
    ds_read_b64_tr_b16 v[112:113], v9 offset:128
    v_mfma_f32_16x16x32_bf16 v[40:43], v[160:163], v[184:187], v[40:43]
    ds_read_b64_tr_b16 v[114:115], v9 offset:1408
    ds_read_b64_tr_b16 v[116:117], v10 offset:160
    v_mfma_f32_16x16x32_bf16 v[80:83], v[160:163], v[188:191], v[80:83]
    ds_read_b64_tr_b16 v[118:119], v10 offset:1440
    v_mfma_f32_16x16x32_bf16 v[44:47], v[164:167], v[184:187], v[44:47]
    ds_read_b64_tr_b16 v[120:121], v9 offset:192
    v_mfma_f32_16x16x32_bf16 v[84:87], v[164:167], v[188:191], v[84:87]
    ds_read_b64_tr_b16 v[122:123], v9 offset:1472
    ds_read_b64_tr_b16 v[124:125], v10 offset:224
    v_mfma_f32_16x16x32_bf16 v[48:51], v[168:171], v[184:187], v[48:51]
    ds_read_b64_tr_b16 v[126:127], v10 offset:1504
    v_mfma_f32_16x16x32_bf16 v[88:91], v[168:171], v[188:191], v[88:91]
    ds_read_b64_tr_b16 v[128:129], v9 offset:256
    ds_read_b64_tr_b16 v[130:131], v9 offset:1536
    v_mfma_f32_16x16x32_bf16 v[52:55], v[172:175], v[184:187], v[52:55]
    ds_read_b64_tr_b16 v[132:133], v10 offset:288
    v_mfma_f32_16x16x32_bf16 v[92:95], v[172:175], v[188:191], v[92:95]
    ds_read_b64_tr_b16 v[134:135], v10 offset:1568
    s_waitcnt lgkmcnt(11)
    v_mfma_f32_16x16x32_bf16 v[16:19], v[96:99], v[192:195], v[16:19]
    ds_read_b64_tr_b16 v[136:137], v9 offset:10240
    v_mfma_f32_16x16x32_bf16 v[56:59], v[96:99], v[196:199], v[56:59]
    ds_read_b64_tr_b16 v[138:139], v9 offset:11520
    v_mfma_f32_16x16x32_bf16 v[20:23], v[100:103], v[192:195], v[20:23]
    ds_read_b64_tr_b16 v[140:141], v10 offset:10272
    v_mfma_f32_16x16x32_bf16 v[60:63], v[100:103], v[196:199], v[60:63]
    ds_read_b64_tr_b16 v[142:143], v10 offset:11552
    v_mfma_f32_16x16x32_bf16 v[24:27], v[104:107], v[192:195], v[24:27]
    ds_read_b64_tr_b16 v[144:145], v9 offset:10304
    v_mfma_f32_16x16x32_bf16 v[64:67], v[104:107], v[196:199], v[64:67]
    ds_read_b64_tr_b16 v[146:147], v9 offset:11584
    v_mfma_f32_16x16x32_bf16 v[28:31], v[108:111], v[192:195], v[28:31]
    ds_read_b64_tr_b16 v[148:149], v10 offset:10336
    v_mfma_f32_16x16x32_bf16 v[68:71], v[108:111], v[196:199], v[68:71]
    ds_read_b64_tr_b16 v[150:151], v10 offset:11616
    s_waitcnt lgkmcnt(10)
    v_mfma_f32_16x16x32_bf16 v[32:35], v[112:115], v[192:195], v[32:35]
    ds_read_b64_tr_b16 v[152:153], v9 offset:10368
    v_mfma_f32_16x16x32_bf16 v[72:75], v[112:115], v[196:199], v[72:75]
    ds_read_b64_tr_b16 v[154:155], v9 offset:11648
    v_mfma_f32_16x16x32_bf16 v[36:39], v[116:119], v[192:195], v[36:39]
    ds_read_b64_tr_b16 v[156:157], v10 offset:10400
    v_mfma_f32_16x16x32_bf16 v[76:79], v[116:119], v[196:199], v[76:79]
    ds_read_b64_tr_b16 v[158:159], v10 offset:11680
    v_mfma_f32_16x16x32_bf16 v[40:43], v[120:123], v[192:195], v[40:43]
    ds_read_b64_tr_b16 v[160:161], v9 offset:10432
    v_mfma_f32_16x16x32_bf16 v[80:83], v[120:123], v[196:199], v[80:83]
    ds_read_b64_tr_b16 v[162:163], v9 offset:11712
    v_mfma_f32_16x16x32_bf16 v[44:47], v[124:127], v[192:195], v[44:47]
    ds_read_b64_tr_b16 v[164:165], v10 offset:10464
    v_mfma_f32_16x16x32_bf16 v[84:87], v[124:127], v[196:199], v[84:87]
    ds_read_b64_tr_b16 v[166:167], v10 offset:11744
    v_mfma_f32_16x16x32_bf16 v[48:51], v[128:131], v[192:195], v[48:51]
    ds_read_b64_tr_b16 v[168:169], v9 offset:10496
    v_mfma_f32_16x16x32_bf16 v[88:91], v[128:131], v[196:199], v[88:91]
    ds_read_b64_tr_b16 v[170:171], v9 offset:11776
    s_waitcnt lgkmcnt(10)
    v_mfma_f32_16x16x32_bf16 v[52:55], v[132:135], v[192:195], v[52:55]
    ds_read_b64_tr_b16 v[172:173], v10 offset:10528
    v_mfma_f32_16x16x32_bf16 v[92:95], v[132:135], v[196:199], v[92:95]
    ds_read_b64_tr_b16 v[174:175], v10 offset:11808
    v_mfma_f32_16x16x32_bf16 v[16:19], v[136:139], v[200:203], v[16:19]
    v_mfma_f32_16x16x32_bf16 v[56:59], v[136:139], v[204:207], v[56:59]
    v_mfma_f32_16x16x32_bf16 v[20:23], v[140:143], v[200:203], v[20:23]
    s_waitcnt lgkmcnt(0)
    s_barrier
    v_mfma_f32_16x16x32_bf16 v[60:63], v[140:143], v[204:207], v[60:63]
    ds_read_b128 v[176:179], v4 offset:36864
    ds_read_b128 v[180:183], v4 offset:38912
    v_mfma_f32_16x16x32_bf16 v[24:27], v[144:147], v[200:203], v[24:27]
    ds_read_b128 v[184:187], v5 offset:36864
    v_mfma_f32_16x16x32_bf16 v[64:67], v[144:147], v[204:207], v[64:67]
    ds_read_b128 v[188:191], v5 offset:38912
    ds_read_b64_tr_b16 v[96:97], v2 offset:36864
    v_mfma_f32_16x16x32_bf16 v[28:31], v[148:151], v[200:203], v[28:31]
    ds_read_b64_tr_b16 v[98:99], v2 offset:38144
    v_mfma_f32_16x16x32_bf16 v[68:71], v[148:151], v[204:207], v[68:71]
    ds_read_b64_tr_b16 v[100:101], v3 offset:36896
    ds_read_b64_tr_b16 v[102:103], v3 offset:38176
    v_mfma_f32_16x16x32_bf16 v[32:35], v[152:155], v[200:203], v[32:35]
    ds_read_b64_tr_b16 v[104:105], v2 offset:36928
    v_mfma_f32_16x16x32_bf16 v[72:75], v[152:155], v[204:207], v[72:75]
    ds_read_b64_tr_b16 v[106:107], v2 offset:38208
    v_mfma_f32_16x16x32_bf16 v[36:39], v[156:159], v[200:203], v[36:39]
    ds_read_b64_tr_b16 v[108:109], v3 offset:36960
    ds_read_b64_tr_b16 v[110:111], v3 offset:38240
    v_mfma_f32_16x16x32_bf16 v[76:79], v[156:159], v[204:207], v[76:79]
    ds_read_b64_tr_b16 v[112:113], v2 offset:36992
    v_mfma_f32_16x16x32_bf16 v[40:43], v[160:163], v[200:203], v[40:43]
    ds_read_b64_tr_b16 v[114:115], v2 offset:38272
    ds_read_b64_tr_b16 v[116:117], v3 offset:37024
    v_mfma_f32_16x16x32_bf16 v[80:83], v[160:163], v[204:207], v[80:83]
    ds_read_b64_tr_b16 v[118:119], v3 offset:38304
    v_mfma_f32_16x16x32_bf16 v[44:47], v[164:167], v[200:203], v[44:47]
    ds_read_b64_tr_b16 v[120:121], v2 offset:37056
    v_mfma_f32_16x16x32_bf16 v[84:87], v[164:167], v[204:207], v[84:87]
    ds_read_b64_tr_b16 v[122:123], v2 offset:38336
    ds_read_b64_tr_b16 v[124:125], v3 offset:37088
    v_mfma_f32_16x16x32_bf16 v[48:51], v[168:171], v[200:203], v[48:51]
    ds_read_b64_tr_b16 v[126:127], v3 offset:38368
    v_mfma_f32_16x16x32_bf16 v[88:91], v[168:171], v[204:207], v[88:91]
    ds_read_b64_tr_b16 v[128:129], v2 offset:37120
    ds_read_b64_tr_b16 v[130:131], v2 offset:38400
    v_mfma_f32_16x16x32_bf16 v[52:55], v[172:175], v[200:203], v[52:55]
    ds_read_b64_tr_b16 v[132:133], v3 offset:37152
    v_mfma_f32_16x16x32_bf16 v[92:95], v[172:175], v[204:207], v[92:95]
    ds_read_b64_tr_b16 v[134:135], v3 offset:38432
    s_waitcnt lgkmcnt(11)
    v_mfma_f32_16x16x32_bf16 v[16:19], v[96:99], v[176:179], v[16:19]
    ds_read_b64_tr_b16 v[136:137], v2 offset:47104
    v_mfma_f32_16x16x32_bf16 v[56:59], v[96:99], v[180:183], v[56:59]
    ds_read_b64_tr_b16 v[138:139], v2 offset:48384
    v_mfma_f32_16x16x32_bf16 v[20:23], v[100:103], v[176:179], v[20:23]
    ds_read_b64_tr_b16 v[140:141], v3 offset:47136
    v_mfma_f32_16x16x32_bf16 v[60:63], v[100:103], v[180:183], v[60:63]
    ds_read_b64_tr_b16 v[142:143], v3 offset:48416
    v_mfma_f32_16x16x32_bf16 v[24:27], v[104:107], v[176:179], v[24:27]
    ds_read_b64_tr_b16 v[144:145], v2 offset:47168
    v_mfma_f32_16x16x32_bf16 v[64:67], v[104:107], v[180:183], v[64:67]
    ds_read_b64_tr_b16 v[146:147], v2 offset:48448
    v_mfma_f32_16x16x32_bf16 v[28:31], v[108:111], v[176:179], v[28:31]
    ds_read_b64_tr_b16 v[148:149], v3 offset:47200
    v_mfma_f32_16x16x32_bf16 v[68:71], v[108:111], v[180:183], v[68:71]
    ds_read_b64_tr_b16 v[150:151], v3 offset:48480
    s_waitcnt lgkmcnt(10)
    v_mfma_f32_16x16x32_bf16 v[32:35], v[112:115], v[176:179], v[32:35]
    ds_read_b64_tr_b16 v[152:153], v2 offset:47232
    v_mfma_f32_16x16x32_bf16 v[72:75], v[112:115], v[180:183], v[72:75]
    ds_read_b64_tr_b16 v[154:155], v2 offset:48512
    v_mfma_f32_16x16x32_bf16 v[36:39], v[116:119], v[176:179], v[36:39]
    ds_read_b64_tr_b16 v[156:157], v3 offset:47264
    v_mfma_f32_16x16x32_bf16 v[76:79], v[116:119], v[180:183], v[76:79]
    ds_read_b64_tr_b16 v[158:159], v3 offset:48544
    v_mfma_f32_16x16x32_bf16 v[40:43], v[120:123], v[176:179], v[40:43]
    ds_read_b64_tr_b16 v[160:161], v2 offset:47296
    v_mfma_f32_16x16x32_bf16 v[80:83], v[120:123], v[180:183], v[80:83]
    ds_read_b64_tr_b16 v[162:163], v2 offset:48576
    v_mfma_f32_16x16x32_bf16 v[44:47], v[124:127], v[176:179], v[44:47]
    ds_read_b64_tr_b16 v[164:165], v3 offset:47328
    v_mfma_f32_16x16x32_bf16 v[84:87], v[124:127], v[180:183], v[84:87]
    ds_read_b64_tr_b16 v[166:167], v3 offset:48608
    v_mfma_f32_16x16x32_bf16 v[48:51], v[128:131], v[176:179], v[48:51]
    ds_read_b64_tr_b16 v[168:169], v2 offset:47360
    v_mfma_f32_16x16x32_bf16 v[88:91], v[128:131], v[180:183], v[88:91]
    ds_read_b64_tr_b16 v[170:171], v2 offset:48640
    s_waitcnt lgkmcnt(10)
    v_mfma_f32_16x16x32_bf16 v[52:55], v[132:135], v[176:179], v[52:55]
    ds_read_b64_tr_b16 v[172:173], v3 offset:47392
    v_mfma_f32_16x16x32_bf16 v[92:95], v[132:135], v[180:183], v[92:95]
    ds_read_b64_tr_b16 v[174:175], v3 offset:48672
    v_mfma_f32_16x16x32_bf16 v[16:19], v[136:139], v[184:187], v[16:19]
    v_mfma_f32_16x16x32_bf16 v[56:59], v[136:139], v[188:191], v[56:59]
    v_mfma_f32_16x16x32_bf16 v[20:23], v[140:143], v[184:187], v[20:23]
    s_waitcnt lgkmcnt(0)
    s_barrier
    v_mfma_f32_16x16x32_bf16 v[60:63], v[140:143], v[188:191], v[60:63]
    ds_read_b128 v[192:195], v4 offset:0
    ds_read_b128 v[196:199], v4 offset:2048
    v_mfma_f32_16x16x32_bf16 v[24:27], v[144:147], v[184:187], v[24:27]
    ds_read_b128 v[200:203], v5 offset:0
    v_mfma_f32_16x16x32_bf16 v[64:67], v[144:147], v[188:191], v[64:67]
    ds_read_b128 v[204:207], v5 offset:2048
    ds_read_b64_tr_b16 v[96:97], v2 offset:0
    v_mfma_f32_16x16x32_bf16 v[28:31], v[148:151], v[184:187], v[28:31]
    ds_read_b64_tr_b16 v[98:99], v2 offset:1280
    v_mfma_f32_16x16x32_bf16 v[68:71], v[148:151], v[188:191], v[68:71]
    ds_read_b64_tr_b16 v[100:101], v3 offset:32
    ds_read_b64_tr_b16 v[102:103], v3 offset:1312
    v_mfma_f32_16x16x32_bf16 v[32:35], v[152:155], v[184:187], v[32:35]
    ds_read_b64_tr_b16 v[104:105], v2 offset:64
    v_mfma_f32_16x16x32_bf16 v[72:75], v[152:155], v[188:191], v[72:75]
    ds_read_b64_tr_b16 v[106:107], v2 offset:1344
    v_mfma_f32_16x16x32_bf16 v[36:39], v[156:159], v[184:187], v[36:39]
    ds_read_b64_tr_b16 v[108:109], v3 offset:96
    ds_read_b64_tr_b16 v[110:111], v3 offset:1376
    v_mfma_f32_16x16x32_bf16 v[76:79], v[156:159], v[188:191], v[76:79]
    ds_read_b64_tr_b16 v[112:113], v2 offset:128
    v_mfma_f32_16x16x32_bf16 v[40:43], v[160:163], v[184:187], v[40:43]
    ds_read_b64_tr_b16 v[114:115], v2 offset:1408
    ds_read_b64_tr_b16 v[116:117], v3 offset:160
    v_mfma_f32_16x16x32_bf16 v[80:83], v[160:163], v[188:191], v[80:83]
    ds_read_b64_tr_b16 v[118:119], v3 offset:1440
    v_mfma_f32_16x16x32_bf16 v[44:47], v[164:167], v[184:187], v[44:47]
    ds_read_b64_tr_b16 v[120:121], v2 offset:192
    v_mfma_f32_16x16x32_bf16 v[84:87], v[164:167], v[188:191], v[84:87]
    ds_read_b64_tr_b16 v[122:123], v2 offset:1472
    ds_read_b64_tr_b16 v[124:125], v3 offset:224
    v_mfma_f32_16x16x32_bf16 v[48:51], v[168:171], v[184:187], v[48:51]
    ds_read_b64_tr_b16 v[126:127], v3 offset:1504
    v_mfma_f32_16x16x32_bf16 v[88:91], v[168:171], v[188:191], v[88:91]
    ds_read_b64_tr_b16 v[128:129], v2 offset:256
    ds_read_b64_tr_b16 v[130:131], v2 offset:1536
    v_mfma_f32_16x16x32_bf16 v[52:55], v[172:175], v[184:187], v[52:55]
    ds_read_b64_tr_b16 v[132:133], v3 offset:288
    v_mfma_f32_16x16x32_bf16 v[92:95], v[172:175], v[188:191], v[92:95]
    ds_read_b64_tr_b16 v[134:135], v3 offset:1568
    s_waitcnt lgkmcnt(11)
    v_mfma_f32_16x16x32_bf16 v[16:19], v[96:99], v[192:195], v[16:19]
    ds_read_b64_tr_b16 v[136:137], v2 offset:10240
    v_mfma_f32_16x16x32_bf16 v[56:59], v[96:99], v[196:199], v[56:59]
    ds_read_b64_tr_b16 v[138:139], v2 offset:11520
    v_mfma_f32_16x16x32_bf16 v[20:23], v[100:103], v[192:195], v[20:23]
    ds_read_b64_tr_b16 v[140:141], v3 offset:10272
    v_mfma_f32_16x16x32_bf16 v[60:63], v[100:103], v[196:199], v[60:63]
    ds_read_b64_tr_b16 v[142:143], v3 offset:11552
    v_mfma_f32_16x16x32_bf16 v[24:27], v[104:107], v[192:195], v[24:27]
    ds_read_b64_tr_b16 v[144:145], v2 offset:10304
    v_mfma_f32_16x16x32_bf16 v[64:67], v[104:107], v[196:199], v[64:67]
    ds_read_b64_tr_b16 v[146:147], v2 offset:11584
    v_mfma_f32_16x16x32_bf16 v[28:31], v[108:111], v[192:195], v[28:31]
    ds_read_b64_tr_b16 v[148:149], v3 offset:10336
    v_mfma_f32_16x16x32_bf16 v[68:71], v[108:111], v[196:199], v[68:71]
    ds_read_b64_tr_b16 v[150:151], v3 offset:11616
    s_waitcnt lgkmcnt(10)
    v_mfma_f32_16x16x32_bf16 v[32:35], v[112:115], v[192:195], v[32:35]
    ds_read_b64_tr_b16 v[152:153], v2 offset:10368
    v_mfma_f32_16x16x32_bf16 v[72:75], v[112:115], v[196:199], v[72:75]
    ds_read_b64_tr_b16 v[154:155], v2 offset:11648
    v_mfma_f32_16x16x32_bf16 v[36:39], v[116:119], v[192:195], v[36:39]
    ds_read_b64_tr_b16 v[156:157], v3 offset:10400
    v_mfma_f32_16x16x32_bf16 v[76:79], v[116:119], v[196:199], v[76:79]
    ds_read_b64_tr_b16 v[158:159], v3 offset:11680
    v_mfma_f32_16x16x32_bf16 v[40:43], v[120:123], v[192:195], v[40:43]
    ds_read_b64_tr_b16 v[160:161], v2 offset:10432
    v_mfma_f32_16x16x32_bf16 v[80:83], v[120:123], v[196:199], v[80:83]
    ds_read_b64_tr_b16 v[162:163], v2 offset:11712
    v_mfma_f32_16x16x32_bf16 v[44:47], v[124:127], v[192:195], v[44:47]
    ds_read_b64_tr_b16 v[164:165], v3 offset:10464
    v_mfma_f32_16x16x32_bf16 v[84:87], v[124:127], v[196:199], v[84:87]
    ds_read_b64_tr_b16 v[166:167], v3 offset:11744
    v_mfma_f32_16x16x32_bf16 v[48:51], v[128:131], v[192:195], v[48:51]
    ds_read_b64_tr_b16 v[168:169], v2 offset:10496
    v_mfma_f32_16x16x32_bf16 v[88:91], v[128:131], v[196:199], v[88:91]
    ds_read_b64_tr_b16 v[170:171], v2 offset:11776
    s_waitcnt lgkmcnt(10)
    v_mfma_f32_16x16x32_bf16 v[52:55], v[132:135], v[192:195], v[52:55]
    ds_read_b64_tr_b16 v[172:173], v3 offset:10528
    v_mfma_f32_16x16x32_bf16 v[92:95], v[132:135], v[196:199], v[92:95]
    ds_read_b64_tr_b16 v[174:175], v3 offset:11808
    v_mfma_f32_16x16x32_bf16 v[16:19], v[136:139], v[200:203], v[16:19]
    v_mfma_f32_16x16x32_bf16 v[56:59], v[136:139], v[204:207], v[56:59]
    v_mfma_f32_16x16x32_bf16 v[20:23], v[140:143], v[200:203], v[20:23]
    s_waitcnt lgkmcnt(0)
    s_barrier
    v_mfma_f32_16x16x32_bf16 v[60:63], v[140:143], v[204:207], v[60:63]
    ds_read_b128 v[176:179], v11 offset:36864
    ds_read_b128 v[180:183], v11 offset:38912
    v_mfma_f32_16x16x32_bf16 v[24:27], v[144:147], v[200:203], v[24:27]
    ds_read_b128 v[184:187], v12 offset:36864
    v_mfma_f32_16x16x32_bf16 v[64:67], v[144:147], v[204:207], v[64:67]
    ds_read_b128 v[188:191], v12 offset:38912
    ds_read_b64_tr_b16 v[96:97], v9 offset:36864
    v_mfma_f32_16x16x32_bf16 v[28:31], v[148:151], v[200:203], v[28:31]
    ds_read_b64_tr_b16 v[98:99], v9 offset:38144
    v_mfma_f32_16x16x32_bf16 v[68:71], v[148:151], v[204:207], v[68:71]
    ds_read_b64_tr_b16 v[100:101], v10 offset:36896
    ds_read_b64_tr_b16 v[102:103], v10 offset:38176
    v_mfma_f32_16x16x32_bf16 v[32:35], v[152:155], v[200:203], v[32:35]
    ds_read_b64_tr_b16 v[104:105], v9 offset:36928
    v_mfma_f32_16x16x32_bf16 v[72:75], v[152:155], v[204:207], v[72:75]
    ds_read_b64_tr_b16 v[106:107], v9 offset:38208
    v_mfma_f32_16x16x32_bf16 v[36:39], v[156:159], v[200:203], v[36:39]
    ds_read_b64_tr_b16 v[108:109], v10 offset:36960
    ds_read_b64_tr_b16 v[110:111], v10 offset:38240
    v_mfma_f32_16x16x32_bf16 v[76:79], v[156:159], v[204:207], v[76:79]
    ds_read_b64_tr_b16 v[112:113], v9 offset:36992
    v_mfma_f32_16x16x32_bf16 v[40:43], v[160:163], v[200:203], v[40:43]
    ds_read_b64_tr_b16 v[114:115], v9 offset:38272
    ds_read_b64_tr_b16 v[116:117], v10 offset:37024
    v_mfma_f32_16x16x32_bf16 v[80:83], v[160:163], v[204:207], v[80:83]
    ds_read_b64_tr_b16 v[118:119], v10 offset:38304
    v_mfma_f32_16x16x32_bf16 v[44:47], v[164:167], v[200:203], v[44:47]
    ds_read_b64_tr_b16 v[120:121], v9 offset:37056
    v_mfma_f32_16x16x32_bf16 v[84:87], v[164:167], v[204:207], v[84:87]
    ds_read_b64_tr_b16 v[122:123], v9 offset:38336
    ds_read_b64_tr_b16 v[124:125], v10 offset:37088
    v_mfma_f32_16x16x32_bf16 v[48:51], v[168:171], v[200:203], v[48:51]
    ds_read_b64_tr_b16 v[126:127], v10 offset:38368
    v_mfma_f32_16x16x32_bf16 v[88:91], v[168:171], v[204:207], v[88:91]
    ds_read_b64_tr_b16 v[128:129], v9 offset:37120
    ds_read_b64_tr_b16 v[130:131], v9 offset:38400
    v_mfma_f32_16x16x32_bf16 v[52:55], v[172:175], v[200:203], v[52:55]
    ds_read_b64_tr_b16 v[132:133], v10 offset:37152
    v_mfma_f32_16x16x32_bf16 v[92:95], v[172:175], v[204:207], v[92:95]
    ds_read_b64_tr_b16 v[134:135], v10 offset:38432
    s_waitcnt lgkmcnt(11)
    v_mfma_f32_16x16x32_bf16 v[16:19], v[96:99], v[176:179], v[16:19]
    ds_read_b64_tr_b16 v[136:137], v9 offset:47104
    v_mfma_f32_16x16x32_bf16 v[56:59], v[96:99], v[180:183], v[56:59]
    ds_read_b64_tr_b16 v[138:139], v9 offset:48384
    v_mfma_f32_16x16x32_bf16 v[20:23], v[100:103], v[176:179], v[20:23]
    ds_read_b64_tr_b16 v[140:141], v10 offset:47136
    v_mfma_f32_16x16x32_bf16 v[60:63], v[100:103], v[180:183], v[60:63]
    ds_read_b64_tr_b16 v[142:143], v10 offset:48416
    v_mfma_f32_16x16x32_bf16 v[24:27], v[104:107], v[176:179], v[24:27]
    ds_read_b64_tr_b16 v[144:145], v9 offset:47168
    v_mfma_f32_16x16x32_bf16 v[64:67], v[104:107], v[180:183], v[64:67]
    ds_read_b64_tr_b16 v[146:147], v9 offset:48448
    v_mfma_f32_16x16x32_bf16 v[28:31], v[108:111], v[176:179], v[28:31]
    ds_read_b64_tr_b16 v[148:149], v10 offset:47200
    v_mfma_f32_16x16x32_bf16 v[68:71], v[108:111], v[180:183], v[68:71]
    ds_read_b64_tr_b16 v[150:151], v10 offset:48480
    s_waitcnt lgkmcnt(10)
    v_mfma_f32_16x16x32_bf16 v[32:35], v[112:115], v[176:179], v[32:35]
    ds_read_b64_tr_b16 v[152:153], v9 offset:47232
    v_mfma_f32_16x16x32_bf16 v[72:75], v[112:115], v[180:183], v[72:75]
    ds_read_b64_tr_b16 v[154:155], v9 offset:48512
    v_mfma_f32_16x16x32_bf16 v[36:39], v[116:119], v[176:179], v[36:39]
    ds_read_b64_tr_b16 v[156:157], v10 offset:47264
    v_mfma_f32_16x16x32_bf16 v[76:79], v[116:119], v[180:183], v[76:79]
    ds_read_b64_tr_b16 v[158:159], v10 offset:48544
    v_mfma_f32_16x16x32_bf16 v[40:43], v[120:123], v[176:179], v[40:43]
    ds_read_b64_tr_b16 v[160:161], v9 offset:47296
    v_mfma_f32_16x16x32_bf16 v[80:83], v[120:123], v[180:183], v[80:83]
    ds_read_b64_tr_b16 v[162:163], v9 offset:48576
    v_mfma_f32_16x16x32_bf16 v[44:47], v[124:127], v[176:179], v[44:47]
    ds_read_b64_tr_b16 v[164:165], v10 offset:47328
    v_mfma_f32_16x16x32_bf16 v[84:87], v[124:127], v[180:183], v[84:87]
    ds_read_b64_tr_b16 v[166:167], v10 offset:48608
    v_mfma_f32_16x16x32_bf16 v[48:51], v[128:131], v[176:179], v[48:51]
    ds_read_b64_tr_b16 v[168:169], v9 offset:47360
    v_mfma_f32_16x16x32_bf16 v[88:91], v[128:131], v[180:183], v[88:91]
    ds_read_b64_tr_b16 v[170:171], v9 offset:48640
    s_waitcnt lgkmcnt(10)
    v_mfma_f32_16x16x32_bf16 v[52:55], v[132:135], v[176:179], v[52:55]
    ds_read_b64_tr_b16 v[172:173], v10 offset:47392
    v_mfma_f32_16x16x32_bf16 v[92:95], v[132:135], v[180:183], v[92:95]
    ds_read_b64_tr_b16 v[174:175], v10 offset:48672
    v_mfma_f32_16x16x32_bf16 v[16:19], v[136:139], v[184:187], v[16:19]
    v_mfma_f32_16x16x32_bf16 v[56:59], v[136:139], v[188:191], v[56:59]
    v_mfma_f32_16x16x32_bf16 v[20:23], v[140:143], v[184:187], v[20:23]
    s_waitcnt lgkmcnt(0)
    s_barrier
    v_mfma_f32_16x16x32_bf16 v[60:63], v[140:143], v[188:191], v[60:63]
    ds_read_b128 v[192:195], v11 offset:0
    ds_read_b128 v[196:199], v11 offset:2048
    v_mfma_f32_16x16x32_bf16 v[24:27], v[144:147], v[184:187], v[24:27]
    ds_read_b128 v[200:203], v12 offset:0
    v_mfma_f32_16x16x32_bf16 v[64:67], v[144:147], v[188:191], v[64:67]
    ds_read_b128 v[204:207], v12 offset:2048
    ds_read_b64_tr_b16 v[96:97], v9 offset:0
    v_mfma_f32_16x16x32_bf16 v[28:31], v[148:151], v[184:187], v[28:31]
    ds_read_b64_tr_b16 v[98:99], v9 offset:1280
    v_mfma_f32_16x16x32_bf16 v[68:71], v[148:151], v[188:191], v[68:71]
    ds_read_b64_tr_b16 v[100:101], v10 offset:32
    ds_read_b64_tr_b16 v[102:103], v10 offset:1312
    v_mfma_f32_16x16x32_bf16 v[32:35], v[152:155], v[184:187], v[32:35]
    ds_read_b64_tr_b16 v[104:105], v9 offset:64
    v_mfma_f32_16x16x32_bf16 v[72:75], v[152:155], v[188:191], v[72:75]
    ds_read_b64_tr_b16 v[106:107], v9 offset:1344
    v_mfma_f32_16x16x32_bf16 v[36:39], v[156:159], v[184:187], v[36:39]
    ds_read_b64_tr_b16 v[108:109], v10 offset:96
    ds_read_b64_tr_b16 v[110:111], v10 offset:1376
    v_mfma_f32_16x16x32_bf16 v[76:79], v[156:159], v[188:191], v[76:79]
    ds_read_b64_tr_b16 v[112:113], v9 offset:128
    v_mfma_f32_16x16x32_bf16 v[40:43], v[160:163], v[184:187], v[40:43]
    ds_read_b64_tr_b16 v[114:115], v9 offset:1408
    ds_read_b64_tr_b16 v[116:117], v10 offset:160
    v_mfma_f32_16x16x32_bf16 v[80:83], v[160:163], v[188:191], v[80:83]
    ds_read_b64_tr_b16 v[118:119], v10 offset:1440
    v_mfma_f32_16x16x32_bf16 v[44:47], v[164:167], v[184:187], v[44:47]
    ds_read_b64_tr_b16 v[120:121], v9 offset:192
    v_mfma_f32_16x16x32_bf16 v[84:87], v[164:167], v[188:191], v[84:87]
    ds_read_b64_tr_b16 v[122:123], v9 offset:1472
    ds_read_b64_tr_b16 v[124:125], v10 offset:224
    v_mfma_f32_16x16x32_bf16 v[48:51], v[168:171], v[184:187], v[48:51]
    ds_read_b64_tr_b16 v[126:127], v10 offset:1504
    v_mfma_f32_16x16x32_bf16 v[88:91], v[168:171], v[188:191], v[88:91]
    ds_read_b64_tr_b16 v[128:129], v9 offset:256
    ds_read_b64_tr_b16 v[130:131], v9 offset:1536
    v_mfma_f32_16x16x32_bf16 v[52:55], v[172:175], v[184:187], v[52:55]
    ds_read_b64_tr_b16 v[132:133], v10 offset:288
    v_mfma_f32_16x16x32_bf16 v[92:95], v[172:175], v[188:191], v[92:95]
    ds_read_b64_tr_b16 v[134:135], v10 offset:1568
    s_waitcnt lgkmcnt(11)
    v_mfma_f32_16x16x32_bf16 v[16:19], v[96:99], v[192:195], v[16:19]
    ds_read_b64_tr_b16 v[136:137], v9 offset:10240
    ds_read_b64_tr_b16 v[138:139], v9 offset:11520
    v_mfma_f32_16x16x32_bf16 v[56:59], v[96:99], v[196:199], v[56:59]
    ds_read_b64_tr_b16 v[140:141], v10 offset:10272
    ds_read_b64_tr_b16 v[142:143], v10 offset:11552
    v_mfma_f32_16x16x32_bf16 v[20:23], v[100:103], v[192:195], v[20:23]
    ds_read_b64_tr_b16 v[144:145], v9 offset:10304
    ds_read_b64_tr_b16 v[146:147], v9 offset:11584
    v_mfma_f32_16x16x32_bf16 v[60:63], v[100:103], v[196:199], v[60:63]
    ds_read_b64_tr_b16 v[148:149], v10 offset:10336
    ds_read_b64_tr_b16 v[150:151], v10 offset:11616
    v_mfma_f32_16x16x32_bf16 v[24:27], v[104:107], v[192:195], v[24:27]
    ds_read_b64_tr_b16 v[152:153], v9 offset:10368
    ds_read_b64_tr_b16 v[154:155], v9 offset:11648
    v_mfma_f32_16x16x32_bf16 v[64:67], v[104:107], v[196:199], v[64:67]
    ds_read_b64_tr_b16 v[156:157], v10 offset:10400
    ds_read_b64_tr_b16 v[158:159], v10 offset:11680
    v_mfma_f32_16x16x32_bf16 v[28:31], v[108:111], v[192:195], v[28:31]
    ds_read_b64_tr_b16 v[160:161], v9 offset:10432
    ds_read_b64_tr_b16 v[162:163], v9 offset:11712
    v_mfma_f32_16x16x32_bf16 v[68:71], v[108:111], v[196:199], v[68:71]
    ds_read_b64_tr_b16 v[164:165], v10 offset:10464
    ds_read_b64_tr_b16 v[166:167], v10 offset:11744
    s_waitcnt lgkmcnt(13)
    v_mfma_f32_16x16x32_bf16 v[32:35], v[112:115], v[192:195], v[32:35]
    ds_read_b64_tr_b16 v[168:169], v9 offset:10496
    ds_read_b64_tr_b16 v[170:171], v9 offset:11776
    v_mfma_f32_16x16x32_bf16 v[72:75], v[112:115], v[196:199], v[72:75]
    ds_read_b64_tr_b16 v[172:173], v10 offset:10528
    ds_read_b64_tr_b16 v[174:175], v10 offset:11808
    v_mov_b32 v13, s75
    v_mov_b32 v14, 1
    v_add_u32 v13, 81856, v13
    s_add_u32 s76, s76, 4
    s_mov_b64 exec, 1
    ds_add_u32 v13, v14
    s_mov_b64 exec, -1
    v_mfma_f32_16x16x32_bf16 v[16:19], v[136:139], v[200:203], v[16:19]
    v_mfma_f32_16x16x32_bf16 v[56:59], v[136:139], v[204:207], v[56:59]
    s_waitcnt lgkmcnt(8)
    v_mfma_f32_16x16x32_bf16 v[20:23], v[140:143], v[200:203], v[20:23]
    v_mfma_f32_16x16x32_bf16 v[60:63], v[140:143], v[204:207], v[60:63]
    v_mfma_f32_16x16x32_bf16 v[24:27], v[144:147], v[200:203], v[24:27]
    v_mfma_f32_16x16x32_bf16 v[64:67], v[144:147], v[204:207], v[64:67]
    v_mfma_f32_16x16x32_bf16 v[28:31], v[148:151], v[200:203], v[28:31]
    v_mfma_f32_16x16x32_bf16 v[68:71], v[148:151], v[204:207], v[68:71]
    v_mfma_f32_16x16x32_bf16 v[32:35], v[152:155], v[200:203], v[32:35]
    v_mul_f32 v240, s70, v16
    v_mul_f32 v241, s70, v17
    v_mfma_f32_16x16x32_bf16 v[72:75], v[152:155], v[204:207], v[72:75]
    v_mul_f32 v242, s70, v18
    v_mul_f32 v243, s70, v19
    v_mfma_f32_16x16x32_bf16 v[36:39], v[116:119], v[192:195], v[36:39]
    v_mul_f32 v244, s70, v20
    v_mul_f32 v245, s70, v21
    v_mfma_f32_16x16x32_bf16 v[76:79], v[116:119], v[196:199], v[76:79]
    v_mul_f32 v246, s70, v22
    v_mul_f32 v247, s70, v23
    v_mfma_f32_16x16x32_bf16 v[40:43], v[120:123], v[192:195], v[40:43]
    v_exp_f32 v240, v240 clamp
    v_max_f32 v16, s71, v16
    v_mfma_f32_16x16x32_bf16 v[80:83], v[120:123], v[196:199], v[80:83]
    v_exp_f32 v241, v241 clamp
    v_max_f32 v17, s71, v17
    v_mfma_f32_16x16x32_bf16 v[44:47], v[124:127], v[192:195], v[44:47]
    v_exp_f32 v242, v242 clamp
    v_max_f32 v18, s71, v18
    v_mfma_f32_16x16x32_bf16 v[84:87], v[124:127], v[196:199], v[84:87]
    v_exp_f32 v243, v243 clamp
    v_max_f32 v19, s71, v19
    v_mfma_f32_16x16x32_bf16 v[48:51], v[128:131], v[192:195], v[48:51]
    v_exp_f32 v244, v244 clamp
    v_max_f32 v20, s71, v20
    v_mfma_f32_16x16x32_bf16 v[88:91], v[128:131], v[196:199], v[88:91]
    v_exp_f32 v245, v245 clamp
    v_max_f32 v21, s71, v21
    v_mfma_f32_16x16x32_bf16 v[52:55], v[132:135], v[192:195], v[52:55]
    v_exp_f32 v246, v246 clamp
    v_max_f32 v22, s71, v22
    v_mfma_f32_16x16x32_bf16 v[92:95], v[132:135], v[196:199], v[92:95]
    v_exp_f32 v247, v247 clamp
    v_max_f32 v23, s71, v23
    v_mfma_f32_16x16x32_bf16 v[36:39], v[156:159], v[200:203], v[36:39]
    v_add_f32 v16, v16, v240
    v_add_f32 v17, v17, v241
    v_mfma_f32_16x16x32_bf16 v[76:79], v[156:159], v[204:207], v[76:79]
    v_add_f32 v18, v18, v242
    v_add_f32 v19, v19, v243
    s_waitcnt lgkmcnt(0)
    v_mfma_f32_16x16x32_bf16 v[40:43], v[160:163], v[200:203], v[40:43]
    v_add_f32 v20, v20, v244
    v_add_f32 v21, v21, v245
    v_mfma_f32_16x16x32_bf16 v[80:83], v[160:163], v[204:207], v[80:83]
    v_add_f32 v22, v22, v246
    v_add_f32 v23, v23, v247
    v_mfma_f32_16x16x32_bf16 v[44:47], v[164:167], v[200:203], v[44:47]
    v_cvt_pk_bf16_f32 v96, v16, v17
    v_cvt_pk_bf16_f32 v97, v18, v19
    v_mfma_f32_16x16x32_bf16 v[84:87], v[164:167], v[204:207], v[84:87]
    v_cvt_pk_bf16_f32 v98, v20, v21
    v_cvt_pk_bf16_f32 v99, v22, v23
    v_mfma_f32_16x16x32_bf16 v[48:51], v[168:171], v[200:203], v[48:51]
    s_add_u32 s54, s9, 0
    buffer_store_dwordx4 v[96:99], v6, s[48:51], s54 offen sc1
    v_mfma_f32_16x16x32_bf16 v[88:91], v[168:171], v[204:207], v[88:91]
    v_mul_f32 v240, s70, v56
    v_mul_f32 v241, s70, v57
    v_mfma_f32_16x16x32_bf16 v[52:55], v[172:175], v[200:203], v[52:55]
    v_mul_f32 v242, s70, v58
    v_mul_f32 v243, s70, v59
    v_mfma_f32_16x16x32_bf16 v[92:95], v[172:175], v[204:207], v[92:95]
    v_mul_f32 v244, s70, v60
    v_mul_f32 v245, s70, v61
    v_mul_f32 v246, s70, v62
    v_mul_f32 v247, s70, v63
    v_exp_f32 v240, v240 clamp
    v_max_f32 v56, s71, v56
    v_exp_f32 v241, v241 clamp
    v_max_f32 v57, s71, v57
    v_exp_f32 v242, v242 clamp
    v_max_f32 v58, s71, v58
    v_exp_f32 v243, v243 clamp
    v_max_f32 v59, s71, v59
    v_exp_f32 v244, v244 clamp
    v_max_f32 v60, s71, v60
    v_exp_f32 v245, v245 clamp
    v_max_f32 v61, s71, v61
    v_exp_f32 v246, v246 clamp
    v_max_f32 v62, s71, v62
    v_exp_f32 v247, v247 clamp
    v_max_f32 v63, s71, v63
    v_add_f32 v56, v56, v240
    v_add_f32 v57, v57, v241
    v_add_f32 v58, v58, v242
    v_add_f32 v59, v59, v243
    v_add_f32 v60, v60, v244
    v_add_f32 v61, v61, v245
    v_add_f32 v62, v62, v246
    v_add_f32 v63, v63, v247
    v_cvt_pk_bf16_f32 v116, v56, v57
    v_cvt_pk_bf16_f32 v117, v58, v59
    v_cvt_pk_bf16_f32 v118, v60, v61
    v_cvt_pk_bf16_f32 v119, v62, v63
    s_add_u32 s54, s9, 20480
    buffer_store_dwordx4 v[116:119], v6, s[48:51], s54 offen sc1
    v_mul_f32 v240, s70, v24
    v_mul_f32 v241, s70, v25
    v_mul_f32 v242, s70, v26
    v_mul_f32 v243, s70, v27
    v_mul_f32 v244, s70, v28
    v_mul_f32 v245, s70, v29
    v_mul_f32 v246, s70, v30
    v_mul_f32 v247, s70, v31
    v_exp_f32 v240, v240 clamp
    v_max_f32 v24, s71, v24
    v_exp_f32 v241, v241 clamp
    v_max_f32 v25, s71, v25
    v_exp_f32 v242, v242 clamp
    v_max_f32 v26, s71, v26
    v_exp_f32 v243, v243 clamp
    v_max_f32 v27, s71, v27
    v_exp_f32 v244, v244 clamp
    v_max_f32 v28, s71, v28
    v_exp_f32 v245, v245 clamp
    v_max_f32 v29, s71, v29
    v_exp_f32 v246, v246 clamp
    v_max_f32 v30, s71, v30
    v_exp_f32 v247, v247 clamp
    v_max_f32 v31, s71, v31
    v_add_f32 v24, v24, v240
    v_add_f32 v25, v25, v241
    v_add_f32 v26, v26, v242
    v_add_f32 v27, v27, v243
    v_add_f32 v28, v28, v244
    v_add_f32 v29, v29, v245
    v_add_f32 v30, v30, v246
    v_add_f32 v31, v31, v247
    v_cvt_pk_bf16_f32 v100, v24, v25
    v_cvt_pk_bf16_f32 v101, v26, v27
    v_cvt_pk_bf16_f32 v102, v28, v29
    v_cvt_pk_bf16_f32 v103, v30, v31
    s_add_u32 s54, s9, 1024
    buffer_store_dwordx4 v[100:103], v6, s[48:51], s54 offen sc1
    v_mul_f32 v240, s70, v64
    v_mul_f32 v241, s70, v65
    v_mul_f32 v242, s70, v66
    v_mul_f32 v243, s70, v67
    v_mul_f32 v244, s70, v68
    v_mul_f32 v245, s70, v69
    v_mul_f32 v246, s70, v70
    v_mul_f32 v247, s70, v71
    v_exp_f32 v240, v240 clamp
    v_max_f32 v64, s71, v64
    v_exp_f32 v241, v241 clamp
    v_max_f32 v65, s71, v65
    v_exp_f32 v242, v242 clamp
    v_max_f32 v66, s71, v66
    v_exp_f32 v243, v243 clamp
    v_max_f32 v67, s71, v67
    v_exp_f32 v244, v244 clamp
    v_max_f32 v68, s71, v68
    v_exp_f32 v245, v245 clamp
    v_max_f32 v69, s71, v69
    v_exp_f32 v246, v246 clamp
    v_max_f32 v70, s71, v70
    v_exp_f32 v247, v247 clamp
    v_max_f32 v71, s71, v71
    v_add_f32 v64, v64, v240
    v_add_f32 v65, v65, v241
    v_add_f32 v66, v66, v242
    v_add_f32 v67, v67, v243
    v_add_f32 v68, v68, v244
    v_add_f32 v69, v69, v245
    v_add_f32 v70, v70, v246
    v_add_f32 v71, v71, v247
    v_cvt_pk_bf16_f32 v120, v64, v65
    v_cvt_pk_bf16_f32 v121, v66, v67
    v_cvt_pk_bf16_f32 v122, v68, v69
    v_cvt_pk_bf16_f32 v123, v70, v71
    s_add_u32 s54, s9, 21504
    buffer_store_dwordx4 v[120:123], v6, s[48:51], s54 offen sc1
    v_mul_f32 v240, s70, v32
    v_mul_f32 v241, s70, v33
    v_mul_f32 v242, s70, v34
    v_mul_f32 v243, s70, v35
    v_mul_f32 v244, s70, v36
    v_mul_f32 v245, s70, v37
    v_mul_f32 v246, s70, v38
    v_mul_f32 v247, s70, v39
    v_exp_f32 v240, v240 clamp
    v_max_f32 v32, s71, v32
    v_exp_f32 v241, v241 clamp
    v_max_f32 v33, s71, v33
    v_exp_f32 v242, v242 clamp
    v_max_f32 v34, s71, v34
    v_exp_f32 v243, v243 clamp
    v_max_f32 v35, s71, v35
    v_exp_f32 v244, v244 clamp
    v_max_f32 v36, s71, v36
    v_exp_f32 v245, v245 clamp
    v_max_f32 v37, s71, v37
    v_exp_f32 v246, v246 clamp
    v_max_f32 v38, s71, v38
    v_exp_f32 v247, v247 clamp
    v_max_f32 v39, s71, v39
    v_add_f32 v32, v32, v240
    v_add_f32 v33, v33, v241
    v_add_f32 v34, v34, v242
    v_add_f32 v35, v35, v243
    v_add_f32 v36, v36, v244
    v_add_f32 v37, v37, v245
    v_add_f32 v38, v38, v246
    v_add_f32 v39, v39, v247
    v_cvt_pk_bf16_f32 v104, v32, v33
    v_cvt_pk_bf16_f32 v105, v34, v35
    v_cvt_pk_bf16_f32 v106, v36, v37
    v_cvt_pk_bf16_f32 v107, v38, v39
    s_add_u32 s54, s9, 2048
    buffer_store_dwordx4 v[104:107], v6, s[48:51], s54 offen sc1
    v_mul_f32 v240, s70, v72
    v_mul_f32 v241, s70, v73
    v_mul_f32 v242, s70, v74
    v_mul_f32 v243, s70, v75
    v_mul_f32 v244, s70, v76
    v_mul_f32 v245, s70, v77
    v_mul_f32 v246, s70, v78
    v_mul_f32 v247, s70, v79
    v_exp_f32 v240, v240 clamp
    v_max_f32 v72, s71, v72
    v_exp_f32 v241, v241 clamp
    v_max_f32 v73, s71, v73
    v_exp_f32 v242, v242 clamp
    v_max_f32 v74, s71, v74
    v_exp_f32 v243, v243 clamp
    v_max_f32 v75, s71, v75
    v_exp_f32 v244, v244 clamp
    v_max_f32 v76, s71, v76
    v_exp_f32 v245, v245 clamp
    v_max_f32 v77, s71, v77
    v_exp_f32 v246, v246 clamp
    v_max_f32 v78, s71, v78
    v_exp_f32 v247, v247 clamp
    v_max_f32 v79, s71, v79
    v_add_f32 v72, v72, v240
    v_add_f32 v73, v73, v241
    v_add_f32 v74, v74, v242
    v_add_f32 v75, v75, v243
    v_add_f32 v76, v76, v244
    v_add_f32 v77, v77, v245
    v_add_f32 v78, v78, v246
    v_add_f32 v79, v79, v247
    v_cvt_pk_bf16_f32 v124, v72, v73
    v_cvt_pk_bf16_f32 v125, v74, v75
    v_cvt_pk_bf16_f32 v126, v76, v77
    v_cvt_pk_bf16_f32 v127, v78, v79
    s_add_u32 s54, s9, 22528
    buffer_store_dwordx4 v[124:127], v6, s[48:51], s54 offen sc1
    v_mul_f32 v240, s70, v40
    v_mul_f32 v241, s70, v41
    v_mul_f32 v242, s70, v42
    v_mul_f32 v243, s70, v43
    v_mul_f32 v244, s70, v44
    v_mul_f32 v245, s70, v45
    v_mul_f32 v246, s70, v46
    v_mul_f32 v247, s70, v47
    v_exp_f32 v240, v240 clamp
    v_max_f32 v40, s71, v40
    v_exp_f32 v241, v241 clamp
    v_max_f32 v41, s71, v41
    v_exp_f32 v242, v242 clamp
    v_max_f32 v42, s71, v42
    v_exp_f32 v243, v243 clamp
    v_max_f32 v43, s71, v43
    v_exp_f32 v244, v244 clamp
    v_max_f32 v44, s71, v44
    v_exp_f32 v245, v245 clamp
    v_max_f32 v45, s71, v45
    v_exp_f32 v246, v246 clamp
    v_max_f32 v46, s71, v46
    v_exp_f32 v247, v247 clamp
    v_max_f32 v47, s71, v47
    v_add_f32 v40, v40, v240
    v_add_f32 v41, v41, v241
    v_add_f32 v42, v42, v242
    v_add_f32 v43, v43, v243
    v_add_f32 v44, v44, v244
    v_add_f32 v45, v45, v245
    v_add_f32 v46, v46, v246
    v_add_f32 v47, v47, v247
    v_cvt_pk_bf16_f32 v108, v40, v41
    v_cvt_pk_bf16_f32 v109, v42, v43
    v_cvt_pk_bf16_f32 v110, v44, v45
    v_cvt_pk_bf16_f32 v111, v46, v47
    s_add_u32 s54, s9, 3072
    buffer_store_dwordx4 v[108:111], v6, s[48:51], s54 offen sc1
    v_mul_f32 v240, s70, v80
    v_mul_f32 v241, s70, v81
    v_mul_f32 v242, s70, v82
    v_mul_f32 v243, s70, v83
    v_mul_f32 v244, s70, v84
    v_mul_f32 v245, s70, v85
    v_mul_f32 v246, s70, v86
    v_mul_f32 v247, s70, v87
    v_exp_f32 v240, v240 clamp
    v_max_f32 v80, s71, v80
    v_exp_f32 v241, v241 clamp
    v_max_f32 v81, s71, v81
    v_exp_f32 v242, v242 clamp
    v_max_f32 v82, s71, v82
    v_exp_f32 v243, v243 clamp
    v_max_f32 v83, s71, v83
    v_exp_f32 v244, v244 clamp
    v_max_f32 v84, s71, v84
    v_exp_f32 v245, v245 clamp
    v_max_f32 v85, s71, v85
    v_exp_f32 v246, v246 clamp
    v_max_f32 v86, s71, v86
    v_exp_f32 v247, v247 clamp
    v_max_f32 v87, s71, v87
    v_add_f32 v80, v80, v240
    v_add_f32 v81, v81, v241
    v_add_f32 v82, v82, v242
    v_add_f32 v83, v83, v243
    v_add_f32 v84, v84, v244
    v_add_f32 v85, v85, v245
    v_add_f32 v86, v86, v246
    v_add_f32 v87, v87, v247
    v_cvt_pk_bf16_f32 v128, v80, v81
    v_cvt_pk_bf16_f32 v129, v82, v83
    v_cvt_pk_bf16_f32 v130, v84, v85
    v_cvt_pk_bf16_f32 v131, v86, v87
    s_add_u32 s54, s9, 23552
    buffer_store_dwordx4 v[128:131], v6, s[48:51], s54 offen sc1
    v_mul_f32 v240, s70, v48
    v_mul_f32 v241, s70, v49
    v_mul_f32 v242, s70, v50
    v_mul_f32 v243, s70, v51
    v_mul_f32 v244, s70, v52
    v_mul_f32 v245, s70, v53
    v_mul_f32 v246, s70, v54
    v_mul_f32 v247, s70, v55
    v_exp_f32 v240, v240 clamp
    v_max_f32 v48, s71, v48
    v_exp_f32 v241, v241 clamp
    v_max_f32 v49, s71, v49
    v_exp_f32 v242, v242 clamp
    v_max_f32 v50, s71, v50
    v_exp_f32 v243, v243 clamp
    v_max_f32 v51, s71, v51
    v_exp_f32 v244, v244 clamp
    v_max_f32 v52, s71, v52
    v_exp_f32 v245, v245 clamp
    v_max_f32 v53, s71, v53
    v_exp_f32 v246, v246 clamp
    v_max_f32 v54, s71, v54
    v_exp_f32 v247, v247 clamp
    v_max_f32 v55, s71, v55
    v_add_f32 v48, v48, v240
    v_add_f32 v49, v49, v241
    v_add_f32 v50, v50, v242
    v_add_f32 v51, v51, v243
    v_add_f32 v52, v52, v244
    v_add_f32 v53, v53, v245
    v_add_f32 v54, v54, v246
    v_add_f32 v55, v55, v247
    v_cvt_pk_bf16_f32 v112, v48, v49
    v_cvt_pk_bf16_f32 v113, v50, v51
    v_cvt_pk_bf16_f32 v114, v52, v53
    v_cvt_pk_bf16_f32 v115, v54, v55
    s_add_u32 s54, s9, 4096
    buffer_store_dwordx4 v[112:115], v6, s[48:51], s54 offen sc1
    v_mul_f32 v240, s70, v88
    v_mul_f32 v241, s70, v89
    v_mul_f32 v242, s70, v90
    v_mul_f32 v243, s70, v91
    v_mul_f32 v244, s70, v92
    v_mul_f32 v245, s70, v93
    v_mul_f32 v246, s70, v94
    v_mul_f32 v247, s70, v95
    v_exp_f32 v240, v240 clamp
    v_max_f32 v88, s71, v88
    v_exp_f32 v241, v241 clamp
    v_max_f32 v89, s71, v89
    v_exp_f32 v242, v242 clamp
    v_max_f32 v90, s71, v90
    v_exp_f32 v243, v243 clamp
    v_max_f32 v91, s71, v91
    v_exp_f32 v244, v244 clamp
    v_max_f32 v92, s71, v92
    v_exp_f32 v245, v245 clamp
    v_max_f32 v93, s71, v93
    v_exp_f32 v246, v246 clamp
    v_max_f32 v94, s71, v94
    v_exp_f32 v247, v247 clamp
    v_max_f32 v95, s71, v95
    v_add_f32 v88, v88, v240
    v_add_f32 v89, v89, v241
    v_add_f32 v90, v90, v242
    v_add_f32 v91, v91, v243
    v_add_f32 v92, v92, v244
    v_add_f32 v93, v93, v245
    v_add_f32 v94, v94, v246
    v_add_f32 v95, v95, v247
    v_cvt_pk_bf16_f32 v132, v88, v89
    v_cvt_pk_bf16_f32 v133, v90, v91
    v_cvt_pk_bf16_f32 v134, v92, v93
    v_cvt_pk_bf16_f32 v135, v94, v95
    s_add_u32 s54, s9, 24576
    buffer_store_dwordx4 v[132:135], v6, s[48:51], s54 offen sc1
    v_mov_b32 v13, 81860
    v_mov_b32 v14, 1
    s_add_u32 s68, s26, s55
    s_addc_u32 s69, s27, 0
    s_mov_b32 s78, 1
    s_waitcnt vmcnt(0)
    s_mov_b64 exec, 1
    ds_add_rtn_u32 v12, v13, v14
    s_mov_b64 exec, -1
    s_waitcnt lgkmcnt(0)
    v_readfirstlane_b32 s79, v12
    s_nop 0
    s_cmp_lg_u32 s79, 3
    s_cbranch_scc1 L_SIG_1
    s_atomic_add s78, s[68:69], 0
    s_waitcnt lgkmcnt(0)
L_SIG_1:
    s_cmp_ge_u32 s2, 168
    s_cbranch_scc1 L_B2
    s_lshr_b32 s53, s2, 3
    s_mul_i32 s54, s74, 5
    s_add_u32 s56, s53, s54
    s_sub_u32 s56, s56, 16
    s_cmp_lt_u32 s53, 21
    s_cselect_b32 s56, s56, 15
    s_mul_i32 s60, s3, 8448
    s_add_u32 s60, s60, 16384
    v_lshl_add_u32 v10, v1, 4, s60
    s_and_b32 s52, s2, 7
    s_lshl_b32 s52, s52, 2
    s_add_u32 s52, s52, s3
    s_lshl_b32 s52, s52, 6
    s_lshl_b32 s53, s56, 6
    v_lshrrev_b32 v244, 3, v1
    v_lshl_add_u32 v245, v244, 3, s52
    v_and_b32 v246, 7, v1
    v_lshl_add_u32 v247, v246, 3, s53
    v_mul_u32_u24 v245, 1280, v245
    v_lshl_add_u32 v247, v247, 1, v245
    v_add_u32 v240, v247, v245
    v_add_u32 v245, s53, v244
    v_mul_u32_u24 v245, 4224, v245
    v_lshl_add_u32 v241, v246, 4, v245
    v_mul_u32_u24 v245, 1040, v246
    v_lshl_add_u32 v245, v244, 4, v245
    v_add_u32 v242, s60, v245
    s_lshl_b32 s64, s52, 1
    s_add_u32 s64, s64, 4194304
    s_movk_i32 s53, 5120
    s_mov_b32 s36, s4
    s_and_b32 s37, s5, 0xffff
    s_mov_b32 s38, 2621440
    s_mov_b32 s39, 0x20000
    s_mov_b32 s32, s22
    s_and_b32 s33, s23, 0xffff
    s_mov_b32 s34, 5242880
    s_mov_b32 s35, 0x20000
    s_cmp_ge_u32 s56, 10
    s_cselect_b32 s70, 0x40000000, 0
    s_add_u32 s71, s70, 5120
    buffer_load_dwordx4 v[192:195], v247, s[36:39], s70 offen offset:0
    buffer_load_dwordx4 v[196:199], v247, s[36:39], s70 offen offset:1280
    buffer_load_dwordx4 v[200:203], v247, s[36:39], s70 offen offset:2560
    buffer_load_dwordx4 v[204:207], v247, s[36:39], s70 offen offset:3840
    buffer_load_dwordx4 v[208:211], v247, s[36:39], s71 offen offset:0
    buffer_load_dwordx4 v[212:215], v247, s[36:39], s71 offen offset:1280
    buffer_load_dwordx4 v[216:219], v247, s[36:39], s71 offen offset:2560
    buffer_load_dwordx4 v[220:223], v247, s[36:39], s71 offen offset:3840
    v_mov_b32 v13, s75
    v_add_u32 v13, 81856, v13
L_BW_3:
    ds_read_b32 v14, v13
    s_waitcnt lgkmcnt(0)
    v_cmp_gt_u32 vcc, s76, v14
    s_nop 1
    s_cbranch_vccnz L_BW_3
    s_waitcnt vmcnt(0)
    s_branch L_FINR
L_P:
    s_cmp_lg_u32 s77, 1
    s_cbranch_scc1 L_ZW
    s_cmp_ge_u32 s2, 248
    s_cbranch_scc1 L_ZW
    v_lshlrev_b32 v8, 4, v1
    v_mov_b32 v16, 0
    v_mov_b32 v17, 0
    v_mov_b32 v18, 0
    v_mov_b32 v19, 0
    s_and_b32 s54, s2, 63
    s_lshl_b32 s54, s54, 11
    s_mov_b32 s79, 1
    s_mov_b32 s78, 1
    s_waitcnt lgkmcnt(0)
    s_mov_b32 s48, s26
    s_and_b32 s49, s27, 0xffff
    s_mov_b32 s50, 10485760
    s_mov_b32 s51, 0x20000
    s_mov_b32 s44, s24
    s_and_b32 s45, s25, 0xffff
    s_mov_b32 s46, 256
    s_mov_b32 s47, 0x20000
    buffer_store_dwordx4 v[16:19], v8, s[48:51], s54 offen sc1
    buffer_store_dwordx4 v[16:19], v8, s[48:51], s54 offen offset:1024 sc1
    s_waitcnt vmcnt(0)
    s_atomic_add s79, s[24:25], 0 glc
    s_waitcnt lgkmcnt(0)
    s_cmp_lg_u32 s79, 55
    s_cbranch_scc1 L_ZW
    s_atomic_add s78, s[24:25], 128
    s_waitcnt lgkmcnt(0)
L_ZW:
    s_and_b32 s52, s2, 7
    s_lshl_b32 s52, s52, 2
    s_bfe_u32 s53, s2, 0x20004
    s_add_u32 s52, s52, s53
    s_lshl_b32 s52, s52, 6
    s_bfe_u32 s65, s2, 0x10003
    s_mul_i32 s53, s65, 320
    s_sub_u32 s54, s77, 3
    s_lshl_b32 s55, s77, 1
    s_cmp_ge_u32 s77, 3
    s_cselect_b32 s54, s54, s55
    s_lshl_b32 s54, s54, 6
    s_add_u32 s53, s53, s54
    v_lshrrev_b32 v240, 3, v1
    v_lshl_add_u32 v241, v240, 3, s52
    v_and_b32 v242, 7, v1
    v_lshl_add_u32 v243, v242, 3, s53
    v_mul_u32_u24 v241, 1280, v241
    v_lshl_add_u32 v224, v243, 1, v241
    s_movk_i32 s55, 5120
    s_cmp_lt_u32 s77, 3
    s_cbranch_scc1 L_PQ
    v_subrev_u32 v225, 3840, v224
    v_lshlrev_b32 v226, 3, v243
    s_waitcnt lgkmcnt(0)
    s_mov_b32 s28, s6
    s_and_b32 s29, s7, 0xffff
    s_mov_b32 s30, 2621440
    s_mov_b32 s31, 0x20000
    buffer_load_dwordx4 v[16:19], v225, s[28:31], 0 offen offset:0
    buffer_load_dwordx4 v[20:23], v225, s[28:31], 0 offen offset:1280
    buffer_load_dwordx4 v[24:27], v225, s[28:31], 0 offen offset:2560
    buffer_load_dwordx4 v[28:31], v224, s[28:31], 0 offen offset:0
    buffer_load_dwordx4 v[32:35], v224, s[28:31], 0 offen offset:1280
    buffer_load_dwordx4 v[36:39], v224, s[28:31], 0 offen offset:2560
    buffer_load_dwordx4 v[40:43], v224, s[28:31], 0 offen offset:3840
    buffer_load_dwordx4 v[44:47], v224, s[28:31], s55 offen offset:0
    buffer_load_dwordx4 v[48:51], v224, s[28:31], s55 offen offset:1280
    buffer_load_dwordx4 v[52:55], v224, s[28:31], s55 offen offset:2560
    buffer_load_dwordx4 v[56:59], v224, s[28:31], s55 offen offset:3840
    s_mov_b32 s32, s8
    s_and_b32 s33, s9, 0xffff
    s_mov_b32 s34, 2621440
    s_mov_b32 s35, 0x20000
    s_mov_b32 s40, s10
    s_and_b32 s41, s11, 0xffff
    s_mov_b32 s42, 5120
    s_mov_b32 s43, 0x20000
    buffer_load_dwordx4 v[92:95], v226, s[40:43], 0 offen offset:0
    buffer_load_dwordx4 v[96:99], v226, s[40:43], 0 offen offset:16
    buffer_load_dwordx4 v[100:103], v226, s[40:43], 0 offen offset:32
    buffer_load_dwordx4 v[104:107], v226, s[40:43], 0 offen offset:48
    buffer_load_dwordx4 v[60:63], v224, s[32:35], 0 offen offset:0
    buffer_load_dwordx4 v[64:67], v224, s[32:35], 0 offen offset:1280
    buffer_load_dwordx4 v[68:71], v224, s[32:35], 0 offen offset:2560
    buffer_load_dwordx4 v[72:75], v224, s[32:35], 0 offen offset:3840
    buffer_load_dwordx4 v[76:79], v224, s[32:35], s55 offen offset:0
    buffer_load_dwordx4 v[80:83], v224, s[32:35], s55 offen offset:1280
    buffer_load_dwordx4 v[84:87], v224, s[32:35], s55 offen offset:2560
    buffer_load_dwordx4 v[88:91], v224, s[32:35], s55 offen offset:3840
    s_waitcnt lgkmcnt(0)
    s_mov_b32 s48, s26
    s_and_b32 s49, s27, 0xffff
    s_mov_b32 s50, 10485760
    s_mov_b32 s51, 0x20000
    s_mov_b32 s44, s24
    s_and_b32 s45, s25, 0xffff
    s_mov_b32 s46, 256
    s_mov_b32 s47, 0x20000
    v_add_u32 v241, s53, v240
    v_mul_u32_u24 v241, 4224, v241
    v_lshl_add_u32 v227, v242, 4, v241
    s_mul_i32 s54, s3, 20480
    s_mul_i32 s63, s74, 10240
    s_add_u32 s54, s54, s63
    v_mul_u32_u24 v241, 1040, v242
    v_add_u32 v241, s54, v241
    v_sub_u32 v240, 7, v240
    v_lshl_add_u32 v228, v240, 4, v241
    v_lshl_add_u32 v229, v1, 4, s54
    s_lshl_b32 s64, s52, 1
    s_mov_b32 s70, 0x05040100
    s_mov_b32 s71, 0x07060302
    s_sub_u32 s64, 1052544, s64
    s_mov_b32 s62, 0xffff0000
    s_waitcnt vmcnt(21)
    v_perm_b32 v108, v16, v20, s70
    s_waitcnt vmcnt(20)
    v_perm_b32 v109, v20, v24, s70
    s_waitcnt vmcnt(19)
    v_perm_b32 v110, v24, v28, s70
    s_waitcnt vmcnt(18)
    v_perm_b32 v111, v28, v32, s70
    s_waitcnt vmcnt(17)
    v_perm_b32 v112, v32, v36, s70
    s_waitcnt vmcnt(16)
    v_perm_b32 v113, v36, v40, s70
    s_waitcnt vmcnt(15)
    v_perm_b32 v114, v40, v44, s70
    s_waitcnt vmcnt(14)
    v_perm_b32 v115, v44, v48, s70
    s_waitcnt vmcnt(13)
    v_perm_b32 v116, v48, v52, s70
    s_waitcnt vmcnt(12)
    v_perm_b32 v117, v52, v56, s70
    s_waitcnt vmcnt(11)
    v_dot2_f32_bf16 v120, v108, v93, 0
    v_dot2_f32_bf16 v121, v109, v93, 0
    v_dot2_f32_bf16 v122, v110, v93, 0
    v_dot2_f32_bf16 v123, v111, v93, 0
    v_dot2_f32_bf16 v124, v112, v93, 0
    v_dot2_f32_bf16 v125, v113, v93, 0
    v_dot2_f32_bf16 v126, v114, v93, 0
    v_dot2_f32_bf16 v127, v115, v93, 0
    v_dot2_f32_bf16 v120, v110, v92, v120
    v_dot2_f32_bf16 v121, v111, v92, v121
    v_dot2_f32_bf16 v122, v112, v92, v122
    v_dot2_f32_bf16 v123, v113, v92, v123
    v_dot2_f32_bf16 v124, v114, v92, v124
    v_dot2_f32_bf16 v125, v115, v92, v125
    v_dot2_f32_bf16 v126, v116, v92, v126
    v_dot2_f32_bf16 v127, v117, v92, v127
    v_perm_b32 v108, v16, v20, s71
    v_perm_b32 v109, v20, v24, s71
    v_perm_b32 v110, v24, v28, s71
    v_perm_b32 v111, v28, v32, s71
    v_perm_b32 v112, v32, v36, s71
    v_perm_b32 v113, v36, v40, s71
    v_perm_b32 v114, v40, v44, s71
    v_perm_b32 v115, v44, v48, s71
    v_perm_b32 v116, v48, v52, s71
    v_perm_b32 v117, v52, v56, s71
    v_dot2_f32_bf16 v128, v108, v95, 0
    v_dot2_f32_bf16 v129, v109, v95, 0
    v_dot2_f32_bf16 v130, v110, v95, 0
    v_dot2_f32_bf16 v131, v111, v95, 0
    v_dot2_f32_bf16 v132, v112, v95, 0
    v_dot2_f32_bf16 v133, v113, v95, 0
    v_dot2_f32_bf16 v134, v114, v95, 0
    v_dot2_f32_bf16 v135, v115, v95, 0
    v_dot2_f32_bf16 v128, v110, v94, v128
    v_dot2_f32_bf16 v129, v111, v94, v129
    v_dot2_f32_bf16 v130, v112, v94, v130
    v_dot2_f32_bf16 v131, v113, v94, v131
    v_dot2_f32_bf16 v132, v114, v94, v132
    v_dot2_f32_bf16 v133, v115, v94, v133
    v_dot2_f32_bf16 v134, v116, v94, v134
    v_dot2_f32_bf16 v135, v117, v94, v135
    v_perm_b32 v108, v17, v21, s70
    v_perm_b32 v109, v21, v25, s70
    v_perm_b32 v110, v25, v29, s70
    v_perm_b32 v111, v29, v33, s70
    v_perm_b32 v112, v33, v37, s70
    v_perm_b32 v113, v37, v41, s70
    v_perm_b32 v114, v41, v45, s70
    v_perm_b32 v115, v45, v49, s70
    v_perm_b32 v116, v49, v53, s70
    v_perm_b32 v117, v53, v57, s70
    s_waitcnt vmcnt(10)
    v_dot2_f32_bf16 v136, v108, v97, 0
    v_dot2_f32_bf16 v137, v109, v97, 0
    v_dot2_f32_bf16 v138, v110, v97, 0
    v_dot2_f32_bf16 v139, v111, v97, 0
    v_dot2_f32_bf16 v140, v112, v97, 0
    v_dot2_f32_bf16 v141, v113, v97, 0
    v_dot2_f32_bf16 v142, v114, v97, 0
    v_dot2_f32_bf16 v143, v115, v97, 0
    v_dot2_f32_bf16 v136, v110, v96, v136
    v_dot2_f32_bf16 v137, v111, v96, v137
    v_dot2_f32_bf16 v138, v112, v96, v138
    v_dot2_f32_bf16 v139, v113, v96, v139
    v_dot2_f32_bf16 v140, v114, v96, v140
    v_dot2_f32_bf16 v141, v115, v96, v141
    v_dot2_f32_bf16 v142, v116, v96, v142
    v_dot2_f32_bf16 v143, v117, v96, v143
    v_perm_b32 v108, v17, v21, s71
    v_perm_b32 v109, v21, v25, s71
    v_perm_b32 v110, v25, v29, s71
    v_perm_b32 v111, v29, v33, s71
    v_perm_b32 v112, v33, v37, s71
    v_perm_b32 v113, v37, v41, s71
    v_perm_b32 v114, v41, v45, s71
    v_perm_b32 v115, v45, v49, s71
    v_perm_b32 v116, v49, v53, s71
    v_perm_b32 v117, v53, v57, s71
    v_dot2_f32_bf16 v144, v108, v99, 0
    v_dot2_f32_bf16 v145, v109, v99, 0
    v_dot2_f32_bf16 v146, v110, v99, 0
    v_dot2_f32_bf16 v147, v111, v99, 0
    v_dot2_f32_bf16 v148, v112, v99, 0
    v_dot2_f32_bf16 v149, v113, v99, 0
    v_dot2_f32_bf16 v150, v114, v99, 0
    v_dot2_f32_bf16 v151, v115, v99, 0
    v_dot2_f32_bf16 v144, v110, v98, v144
    v_dot2_f32_bf16 v145, v111, v98, v145
    v_dot2_f32_bf16 v146, v112, v98, v146
    v_dot2_f32_bf16 v147, v113, v98, v147
    v_dot2_f32_bf16 v148, v114, v98, v148
    v_dot2_f32_bf16 v149, v115, v98, v149
    v_dot2_f32_bf16 v150, v116, v98, v150
    v_dot2_f32_bf16 v151, v117, v98, v151
    v_perm_b32 v108, v18, v22, s70
    v_perm_b32 v109, v22, v26, s70
    v_perm_b32 v110, v26, v30, s70
    v_perm_b32 v111, v30, v34, s70
    v_perm_b32 v112, v34, v38, s70
    v_perm_b32 v113, v38, v42, s70
    v_perm_b32 v114, v42, v46, s70
    v_perm_b32 v115, v46, v50, s70
    v_perm_b32 v116, v50, v54, s70
    v_perm_b32 v117, v54, v58, s70
    s_waitcnt vmcnt(9)
    v_dot2_f32_bf16 v152, v108, v101, 0
    v_dot2_f32_bf16 v153, v109, v101, 0
    v_dot2_f32_bf16 v154, v110, v101, 0
    v_dot2_f32_bf16 v155, v111, v101, 0
    v_dot2_f32_bf16 v156, v112, v101, 0
    v_dot2_f32_bf16 v157, v113, v101, 0
    v_dot2_f32_bf16 v158, v114, v101, 0
    v_dot2_f32_bf16 v159, v115, v101, 0
    v_dot2_f32_bf16 v152, v110, v100, v152
    v_dot2_f32_bf16 v153, v111, v100, v153
    v_dot2_f32_bf16 v154, v112, v100, v154
    v_dot2_f32_bf16 v155, v113, v100, v155
    v_dot2_f32_bf16 v156, v114, v100, v156
    v_dot2_f32_bf16 v157, v115, v100, v157
    v_dot2_f32_bf16 v158, v116, v100, v158
    v_dot2_f32_bf16 v159, v117, v100, v159
    v_perm_b32 v108, v18, v22, s71
    v_perm_b32 v109, v22, v26, s71
    v_perm_b32 v110, v26, v30, s71
    v_perm_b32 v111, v30, v34, s71
    v_perm_b32 v112, v34, v38, s71
    v_perm_b32 v113, v38, v42, s71
    v_perm_b32 v114, v42, v46, s71
    v_perm_b32 v115, v46, v50, s71
    v_perm_b32 v116, v50, v54, s71
    v_perm_b32 v117, v54, v58, s71
    v_dot2_f32_bf16 v160, v108, v103, 0
    v_dot2_f32_bf16 v161, v109, v103, 0
    v_dot2_f32_bf16 v162, v110, v103, 0
    v_dot2_f32_bf16 v163, v111, v103, 0
    v_dot2_f32_bf16 v164, v112, v103, 0
    v_dot2_f32_bf16 v165, v113, v103, 0
    v_dot2_f32_bf16 v166, v114, v103, 0
    v_dot2_f32_bf16 v167, v115, v103, 0
    v_dot2_f32_bf16 v160, v110, v102, v160
    v_dot2_f32_bf16 v161, v111, v102, v161
    v_dot2_f32_bf16 v162, v112, v102, v162
    v_dot2_f32_bf16 v163, v113, v102, v163
    v_dot2_f32_bf16 v164, v114, v102, v164
    v_dot2_f32_bf16 v165, v115, v102, v165
    v_dot2_f32_bf16 v166, v116, v102, v166
    v_dot2_f32_bf16 v167, v117, v102, v167
    v_perm_b32 v108, v19, v23, s70
    v_perm_b32 v109, v23, v27, s70
    v_perm_b32 v110, v27, v31, s70
    v_perm_b32 v111, v31, v35, s70
    v_perm_b32 v112, v35, v39, s70
    v_perm_b32 v113, v39, v43, s70
    v_perm_b32 v114, v43, v47, s70
    v_perm_b32 v115, v47, v51, s70
    v_perm_b32 v116, v51, v55, s70
    v_perm_b32 v117, v55, v59, s70
    s_waitcnt vmcnt(8)
    v_dot2_f32_bf16 v168, v108, v105, 0
    v_dot2_f32_bf16 v169, v109, v105, 0
    v_dot2_f32_bf16 v170, v110, v105, 0
    v_dot2_f32_bf16 v171, v111, v105, 0
    v_dot2_f32_bf16 v172, v112, v105, 0
    v_dot2_f32_bf16 v173, v113, v105, 0
    v_dot2_f32_bf16 v174, v114, v105, 0
    v_dot2_f32_bf16 v175, v115, v105, 0
    v_dot2_f32_bf16 v168, v110, v104, v168
    v_dot2_f32_bf16 v169, v111, v104, v169
    v_dot2_f32_bf16 v170, v112, v104, v170
    v_dot2_f32_bf16 v171, v113, v104, v171
    v_dot2_f32_bf16 v172, v114, v104, v172
    v_dot2_f32_bf16 v173, v115, v104, v173
    v_dot2_f32_bf16 v174, v116, v104, v174
    v_dot2_f32_bf16 v175, v117, v104, v175
    v_perm_b32 v108, v19, v23, s71
    v_perm_b32 v109, v23, v27, s71
    v_perm_b32 v110, v27, v31, s71
    v_perm_b32 v111, v31, v35, s71
    v_perm_b32 v112, v35, v39, s71
    v_perm_b32 v113, v39, v43, s71
    v_perm_b32 v114, v43, v47, s71
    v_perm_b32 v115, v47, v51, s71
    v_perm_b32 v116, v51, v55, s71
    v_perm_b32 v117, v55, v59, s71
    v_dot2_f32_bf16 v176, v108, v107, 0
    v_dot2_f32_bf16 v177, v109, v107, 0
    v_dot2_f32_bf16 v178, v110, v107, 0
    v_dot2_f32_bf16 v179, v111, v107, 0
    v_dot2_f32_bf16 v180, v112, v107, 0
    v_dot2_f32_bf16 v181, v113, v107, 0
    v_dot2_f32_bf16 v182, v114, v107, 0
    v_dot2_f32_bf16 v183, v115, v107, 0
    v_dot2_f32_bf16 v176, v110, v106, v176
    v_dot2_f32_bf16 v177, v111, v106, v177
    v_dot2_f32_bf16 v178, v112, v106, v178
    v_dot2_f32_bf16 v179, v113, v106, v179
    v_dot2_f32_bf16 v180, v114, v106, v180
    v_dot2_f32_bf16 v181, v115, v106, v181
    v_dot2_f32_bf16 v182, v116, v106, v182
    v_dot2_f32_bf16 v183, v117, v106, v183
    s_waitcnt vmcnt(7)
    v_lshlrev_b32 v184, 16, v60
    s_waitcnt vmcnt(6)
    v_lshlrev_b32 v185, 16, v64
    s_waitcnt vmcnt(5)
    v_lshlrev_b32 v186, 16, v68
    s_waitcnt vmcnt(4)
    v_lshlrev_b32 v187, 16, v72
    s_waitcnt vmcnt(3)
    v_lshlrev_b32 v188, 16, v76
    s_waitcnt vmcnt(2)
    v_lshlrev_b32 v189, 16, v80
    s_waitcnt vmcnt(1)
    v_lshlrev_b32 v190, 16, v84
    s_waitcnt vmcnt(0)
    v_lshlrev_b32 v191, 16, v88
    v_mul_f32 v120, v120, v184
    v_mul_f32 v121, v121, v185
    v_mul_f32 v122, v122, v186
    v_mul_f32 v123, v123, v187
    v_mul_f32 v124, v124, v188
    v_mul_f32 v125, v125, v189
    v_mul_f32 v126, v126, v190
    v_mul_f32 v127, v127, v191
    v_cvt_pk_bf16_f32 v192, v127, v126
    v_cvt_pk_bf16_f32 v193, v125, v124
    v_cvt_pk_bf16_f32 v194, v123, v122
    v_cvt_pk_bf16_f32 v195, v121, v120
    ds_write_b128 v228, v[192:195] offset:0
    v_and_b32 v184, s62, v60
    v_and_b32 v185, s62, v64
    v_and_b32 v186, s62, v68
    v_and_b32 v187, s62, v72
    v_and_b32 v188, s62, v76
    v_and_b32 v189, s62, v80
    v_and_b32 v190, s62, v84
    v_and_b32 v191, s62, v88
    v_mul_f32 v128, v128, v184
    v_mul_f32 v129, v129, v185
    v_mul_f32 v130, v130, v186
    v_mul_f32 v131, v131, v187
    v_mul_f32 v132, v132, v188
    v_mul_f32 v133, v133, v189
    v_mul_f32 v134, v134, v190
    v_mul_f32 v135, v135, v191
    v_cvt_pk_bf16_f32 v196, v135, v134
    v_cvt_pk_bf16_f32 v197, v133, v132
    v_cvt_pk_bf16_f32 v198, v131, v130
    v_cvt_pk_bf16_f32 v199, v129, v128
    ds_write_b128 v228, v[196:199] offset:128
    v_lshlrev_b32 v184, 16, v61
    v_lshlrev_b32 v185, 16, v65
    v_lshlrev_b32 v186, 16, v69
    v_lshlrev_b32 v187, 16, v73
    v_lshlrev_b32 v188, 16, v77
    v_lshlrev_b32 v189, 16, v81
    v_lshlrev_b32 v190, 16, v85
    v_lshlrev_b32 v191, 16, v89
    v_mul_f32 v136, v136, v184
    v_mul_f32 v137, v137, v185
    v_mul_f32 v138, v138, v186
    v_mul_f32 v139, v139, v187
    v_mul_f32 v140, v140, v188
    v_mul_f32 v141, v141, v189
    v_mul_f32 v142, v142, v190
    v_mul_f32 v143, v143, v191
    v_cvt_pk_bf16_f32 v200, v143, v142
    v_cvt_pk_bf16_f32 v201, v141, v140
    v_cvt_pk_bf16_f32 v202, v139, v138
    v_cvt_pk_bf16_f32 v203, v137, v136
    ds_write_b128 v228, v[200:203] offset:256
    v_and_b32 v184, s62, v61
    v_and_b32 v185, s62, v65
    v_and_b32 v186, s62, v69
    v_and_b32 v187, s62, v73
    v_and_b32 v188, s62, v77
    v_and_b32 v189, s62, v81
    v_and_b32 v190, s62, v85
    v_and_b32 v191, s62, v89
    v_mul_f32 v144, v144, v184
    v_mul_f32 v145, v145, v185
    v_mul_f32 v146, v146, v186
    v_mul_f32 v147, v147, v187
    v_mul_f32 v148, v148, v188
    v_mul_f32 v149, v149, v189
    v_mul_f32 v150, v150, v190
    v_mul_f32 v151, v151, v191
    v_cvt_pk_bf16_f32 v204, v151, v150
    v_cvt_pk_bf16_f32 v205, v149, v148
    v_cvt_pk_bf16_f32 v206, v147, v146
    v_cvt_pk_bf16_f32 v207, v145, v144
    ds_write_b128 v228, v[204:207] offset:384
    v_lshlrev_b32 v184, 16, v62
    v_lshlrev_b32 v185, 16, v66
    v_lshlrev_b32 v186, 16, v70
    v_lshlrev_b32 v187, 16, v74
    v_lshlrev_b32 v188, 16, v78
    v_lshlrev_b32 v189, 16, v82
    v_lshlrev_b32 v190, 16, v86
    v_lshlrev_b32 v191, 16, v90
    v_mul_f32 v152, v152, v184
    v_mul_f32 v153, v153, v185
    v_mul_f32 v154, v154, v186
    v_mul_f32 v155, v155, v187
    v_mul_f32 v156, v156, v188
    v_mul_f32 v157, v157, v189
    v_mul_f32 v158, v158, v190
    v_mul_f32 v159, v159, v191
    v_cvt_pk_bf16_f32 v208, v159, v158
    v_cvt_pk_bf16_f32 v209, v157, v156
    v_cvt_pk_bf16_f32 v210, v155, v154
    v_cvt_pk_bf16_f32 v211, v153, v152
    ds_write_b128 v228, v[208:211] offset:512
    v_and_b32 v184, s62, v62
    v_and_b32 v185, s62, v66
    v_and_b32 v186, s62, v70
    v_and_b32 v187, s62, v74
    v_and_b32 v188, s62, v78
    v_and_b32 v189, s62, v82
    v_and_b32 v190, s62, v86
    v_and_b32 v191, s62, v90
    v_mul_f32 v160, v160, v184
    v_mul_f32 v161, v161, v185
    v_mul_f32 v162, v162, v186
    v_mul_f32 v163, v163, v187
    v_mul_f32 v164, v164, v188
    v_mul_f32 v165, v165, v189
    v_mul_f32 v166, v166, v190
    v_mul_f32 v167, v167, v191
    v_cvt_pk_bf16_f32 v212, v167, v166
    v_cvt_pk_bf16_f32 v213, v165, v164
    v_cvt_pk_bf16_f32 v214, v163, v162
    v_cvt_pk_bf16_f32 v215, v161, v160
    ds_write_b128 v228, v[212:215] offset:640
    v_lshlrev_b32 v184, 16, v63
    v_lshlrev_b32 v185, 16, v67
    v_lshlrev_b32 v186, 16, v71
    v_lshlrev_b32 v187, 16, v75
    v_lshlrev_b32 v188, 16, v79
    v_lshlrev_b32 v189, 16, v83
    v_lshlrev_b32 v190, 16, v87
    v_lshlrev_b32 v191, 16, v91
    v_mul_f32 v168, v168, v184
    v_mul_f32 v169, v169, v185
    v_mul_f32 v170, v170, v186
    v_mul_f32 v171, v171, v187
    v_mul_f32 v172, v172, v188
    v_mul_f32 v173, v173, v189
    v_mul_f32 v174, v174, v190
    v_mul_f32 v175, v175, v191
    v_cvt_pk_bf16_f32 v216, v175, v174
    v_cvt_pk_bf16_f32 v217, v173, v172
    v_cvt_pk_bf16_f32 v218, v171, v170
    v_cvt_pk_bf16_f32 v219, v169, v168
    ds_write_b128 v228, v[216:219] offset:768
    v_and_b32 v184, s62, v63
    v_and_b32 v185, s62, v67
    v_and_b32 v186, s62, v71
    v_and_b32 v187, s62, v75
    v_and_b32 v188, s62, v79
    v_and_b32 v189, s62, v83
    v_and_b32 v190, s62, v87
    v_and_b32 v191, s62, v91
    v_mul_f32 v176, v176, v184
    v_mul_f32 v177, v177, v185
    v_mul_f32 v178, v178, v186
    v_mul_f32 v179, v179, v187
    v_mul_f32 v180, v180, v188
    v_mul_f32 v181, v181, v189
    v_mul_f32 v182, v182, v190
    v_mul_f32 v183, v183, v191
    v_cvt_pk_bf16_f32 v220, v183, v182
    v_cvt_pk_bf16_f32 v221, v181, v180
    v_cvt_pk_bf16_f32 v222, v179, v178
    v_cvt_pk_bf16_f32 v223, v177, v176
    ds_write_b128 v228, v[220:223] offset:896
    ds_read_b128 v[16:19], v229 offset:0
    ds_read_b128 v[20:23], v229 offset:1040
    ds_read_b128 v[24:27], v229 offset:2080
    ds_read_b128 v[28:31], v229 offset:3120
    ds_read_b128 v[32:35], v229 offset:4160
    ds_read_b128 v[36:39], v229 offset:5200
    ds_read_b128 v[40:43], v229 offset:6240
    ds_read_b128 v[44:47], v229 offset:7280
    s_add_u32 s54, s64, 0
    s_waitcnt lgkmcnt(7)
    buffer_store_dwordx4 v[16:19], v227, s[48:51], s54 offen sc1
    s_add_u32 s54, s64, 33792
    s_waitcnt lgkmcnt(6)
    buffer_store_dwordx4 v[20:23], v227, s[48:51], s54 offen sc1
    s_add_u32 s54, s64, 67584
    s_waitcnt lgkmcnt(5)
    buffer_store_dwordx4 v[24:27], v227, s[48:51], s54 offen sc1
    s_add_u32 s54, s64, 101376
    s_waitcnt lgkmcnt(4)
    buffer_store_dwordx4 v[28:31], v227, s[48:51], s54 offen sc1
    s_add_u32 s54, s64, 135168
    s_waitcnt lgkmcnt(3)
    buffer_store_dwordx4 v[32:35], v227, s[48:51], s54 offen sc1
    s_add_u32 s54, s64, 168960
    s_waitcnt lgkmcnt(2)
    buffer_store_dwordx4 v[36:39], v227, s[48:51], s54 offen sc1
    s_add_u32 s54, s64, 202752
    s_waitcnt lgkmcnt(1)
    buffer_store_dwordx4 v[40:43], v227, s[48:51], s54 offen sc1
    s_add_u32 s54, s64, 236544
    s_waitcnt lgkmcnt(0)
    buffer_store_dwordx4 v[44:47], v227, s[48:51], s54 offen sc1
    v_mov_b32 v4, 128
    buffer_load_dword v3, v4, s[44:47], 0 offen sc1
    s_waitcnt vmcnt(0)
    v_cmp_gt_u32 vcc, 1, v3
    s_mov_b32 s78, 0
    s_nop 0
    s_cbranch_vccz L_OK_zpu
L_POLL_zpu:
    s_sleep 2
    buffer_load_dword v3, v4, s[44:47], 0 offen sc1
    s_add_u32 s78, s78, 1
    s_waitcnt vmcnt(0)
    v_cmp_gt_u32 vcc, 1, v3
    s_cmp_ge_u32 s78, 0x20000
    s_cbranch_scc1 L_OK_zpu
    s_cbranch_vccnz L_POLL_zpu
L_OK_zpu:
    s_waitcnt vmcnt(0)
    s_barrier
    s_cmp_eq_u32 s74, 1
    s_cbranch_scc1 L_CONV
    s_branch L_PW
L_PQ:
    s_cmp_lg_u32 s77, 2
    s_cbranch_scc1 L_PQ0
    s_getpc_b64 s[52:53]
L_PCp:
    s_lshr_b32 s54, s2, 3
    s_and_b32 s54, s54, 7
    s_lshl_b32 s54, s54, 13
    v_lshlrev_b32 v3, 7, v1
    v_add_u32 v3, s54, v3
    s_sub_u32 s52, s52, L_PCp-L_CODE_BEGIN
    s_subb_u32 s53, s53, 0
    v_min_u32 v3, L_CODE_END-L_CODE_BEGIN-4, v3
    global_load_dword v15, v3, s[52:53]
    v_and_b32 v4, 15, v1
    v_lshlrev_b32 v4, 2, v4
    v_bfe_u32 v5, v1, 4, 1
    v_mul_u32_u24 v5, 81920, v5
    v_add_u32 v4, v4, v5
    v_add_u32 v4, 81856, v4
    v_mov_b32 v5, 0
    ds_write_b32 v4, v5
L_PQ0:
    s_waitcnt lgkmcnt(0)
    s_mov_b32 s48, s26
    s_and_b32 s49, s27, 0xffff
    s_mov_b32 s50, 10485760
    s_mov_b32 s51, 0x20000
    s_mov_b32 s44, s24
    s_and_b32 s45, s25, 0xffff
    s_mov_b32 s46, 256
    s_mov_b32 s47, 0x20000
    s_lshl_b32 s65, s65, 10
    s_add_u32 s65, s65, 18432
    s_add_u32 s68, s26, s65
    s_addc_u32 s69, s27, 0
    s_mov_b32 s78, 1
    s_mov_b32 s79, 1
    s_waitcnt vmcnt(0)
    s_barrier
    s_cmp_lg_u32 s77, 0
    s_cbranch_scc1 L_PW
    s_atomic_add s79, s[68:69], 32768 glc
    s_waitcnt lgkmcnt(0)
    s_cmp_lg_u32 s79, 31
    s_cbranch_scc1 L_PW
    s_atomic_add s78, s[68:69], 0
    s_waitcnt lgkmcnt(0)
L_PW:
    v_mov_b32 v13, 163784
L_PWW:
    s_sleep 4
    ds_read_b32 v14, v13
    s_waitcnt lgkmcnt(0)
    v_cmp_gt_u32 vcc, 4, v14
    s_nop 1
    s_cbranch_vccnz L_PWW
    s_branch L_B2
L_CONV:
    s_and_b32 s52, s2, 7
    s_lshl_b32 s52, s52, 4
    s_lshr_b32 s53, s2, 3
    s_and_b32 s61, s2, 0
    s_sub_u32 s53, s53, 16
    s_add_u32 s57, s52, s53
    s_lshl_b32 s58, s57, 2
    s_add_u32 s58, s58, s3
    s_lshl_b32 s59, s58, 12
    s_mul_i32 s60, s3, 13056
    s_add_u32 s60, s60, s75
    s_add_u32 s52, s12, s59
    s_addc_u32 s53, s13, 0
    s_load_dword s66, s[52:53], 0
    s_lshr_b32 s54, s58, 1
    s_lshl_b32 s54, s54, 2
    s_load_dword s67, s[14:15], s54
    s_lshl_b32 s61, s61, 7
    s_cmp_ge_u32 s57, 80
    s_cselect_b32 s54, 1024, 0
    s_add_u32 s61, s61, s54
    s_add_u32 s61, s61, 18432
    s_lshr_b32 s63, s57, 4
    s_mul_i32 s63, s63, 1024
    s_add_u32 s63, s63, 8192
    v_lshlrev_b32 v2, 4, v1
    v_add_u32 v3, 4, v2
    v_mov_b32 v12, 0
    buffer_load_dword v15, v12, s[48:51], s61 offen sc1
    s_mov_b32 s28, s12
    s_and_b32 s29, s13, 0xffff
    s_mov_b32 s30, 2621440
    s_mov_b32 s31, 0x20000
    s_add_u32 m0, s60, 32
    s_nop 0
    buffer_load_dwordx4 v2, s[28:31], s59 offen offset:0 lds
    buffer_load_dwordx4 v2, s[28:31], s59 offen offset:1024 lds
    buffer_load_dwordx4 v2, s[28:31], s59 offen offset:2048 lds
    buffer_load_dwordx4 v2, s[28:31], s59 offen offset:3072 lds
    s_add_u32 m0, s60, 4256
    s_nop 0
    buffer_load_dwordx4 v3, s[28:31], s59 offen offset:0 lds
    buffer_load_dwordx4 v3, s[28:31], s59 offen offset:1024 lds
    buffer_load_dwordx4 v3, s[28:31], s59 offen offset:2048 lds
    buffer_load_dwordx4 v3, s[28:31], s59 offen offset:3072 lds
    s_cmp_eq_u32 s72, 0
    s_cbranch_scc1 L_LB_conv
    s_waitcnt vmcnt(9)
    s_barrier
    s_setprio 0
L_LB_conv:
L_CONV2:
    s_mul_i32 s55, s58, 4224
    s_add_u32 s65, s55, 1048576
    s_add_u32 s55, s55, 4194304
    s_lshr_b32 s53, s2, 3
    s_mul_i32 s54, s74, 5
    s_add_u32 s56, s53, s54
    s_sub_u32 s56, s56, 16
    s_cmp_lt_u32 s53, 21
    s_cselect_b32 s56, s56, 15
    s_and_b32 s52, s2, 7
    s_lshl_b32 s52, s52, 2
    s_add_u32 s52, s52, s3
    s_lshl_b32 s52, s52, 6
    s_lshl_b32 s53, s56, 6
    v_lshrrev_b32 v244, 3, v1
    v_lshl_add_u32 v245, v244, 3, s52
    v_and_b32 v246, 7, v1
    v_lshl_add_u32 v247, v246, 3, s53
    v_mul_u32_u24 v245, 1280, v245
    v_lshl_add_u32 v247, v247, 1, v245
    v_add_u32 v240, v247, v245
    v_add_u32 v245, s53, v244
    v_mul_u32_u24 v245, 4224, v245
    v_lshl_add_u32 v241, v246, 4, v245
    v_mul_u32_u24 v245, 1040, v246
    v_lshl_add_u32 v245, v244, 4, v245
    v_add_u32 v242, s60, v245
    s_lshl_b32 s64, s52, 1
    s_add_u32 s64, s64, 4194304
    s_movk_i32 s53, 5120
    s_mov_b32 s36, s4
    s_and_b32 s37, s5, 0xffff
    s_mov_b32 s38, 2621440
    s_mov_b32 s39, 0x20000
    s_mov_b32 s32, s22
    s_and_b32 s33, s23, 0xffff
    s_mov_b32 s34, 5242880
    s_mov_b32 s35, 0x20000
    s_cmp_ge_u32 s56, 10
    s_cselect_b32 s70, 0x40000000, 0
    s_add_u32 s71, s70, 5120
    v_and_b32 v8, 15, v1
    v_lshrrev_b32 v9, 4, v1
    v_add_u32 v10, 1, v8
    v_bfe_u32 v11, v10, 1, 1
    v_mul_u32_u24 v11, 4224, v11
    v_lshrrev_b32 v13, 2, v10
    v_lshl_add_u32 v13, v9, 3, v13
    v_lshl_add_u32 v11, v13, 3, v11
    v_add_u32 v4, s60, v11
    v_and_b32 v10, 1, v10
    v_lshlrev_b32 v5, 4, v10
    v_lshlrev_b32 v10, 1, v9
    v_sub_u32 v10, v10, v8
    v_add_u32 v10, 15, v10
    v_lshlrev_b32 v10, 4, v10
    v_add_u32 v6, s60, v10
    v_lshrrev_b32 v10, 1, v1
    v_and_b32 v11, 1, v1
    v_mul_u32_u24 v11, 144, v11
    v_add_u32 v10, v10, v11
    v_lshlrev_b32 v10, 4, v10
    v_add_u32 v7, s60, v10
    v_mov_b32 v16, 0
    v_mov_b32 v17, 0
    v_mov_b32 v18, 0
    v_mov_b32 v19, 0
    v_and_b32 v10, 1, v9
    v_mul_u32_u24 v10, 144, v10
    v_add_u32 v10, v10, v8
    v_lshl_add_u32 v20, v10, 4, s60
    v_and_b32 v10, 1, v1
    v_lshlrev_b32 v10, 4, v10
    v_bfe_u32 v11, v1, 1, 1
    v_mul_u32_u24 v11, 4224, v11
    v_add3_u32 v21, v10, v11, s60
    v_lshlrev_b32 v10, 5, v8
    v_lshl_add_u32 v8, v9, 3, v10
    s_waitcnt lgkmcnt(0)
    s_lshl_b32 s52, s66, 16
    s_lshl_b32 s53, s67, 16
    s_and_b32 s54, s67, 0xffff0000
    s_bitcmp1_b32 s58, 0
    s_cselect_b32 s53, s54, s53
    s_and_b32 s54, s66, 0xffff0000
    v_mov_b32 v10, s52
    v_add_f32 v10, s53, v10
    v_mov_b32 v11, s54
    v_cvt_pk_bf16_f32 v10, v10, v11
    v_mov_b32 v11, s60
    s_waitcnt vmcnt(0)
    v_cmp_gt_u32 vcc, 1, v15
    s_mov_b32 s62, 0
    s_nop 0
    s_cbranch_vccnz L_CU0
    buffer_load_dwordx4 v[224:227], v2, s[48:51], s65 offen offset:0 sc1
    buffer_load_dwordx4 v[228:231], v2, s[48:51], s65 offen offset:1024 sc1
    buffer_load_dwordx4 v[232:235], v2, s[48:51], s65 offen offset:2048 sc1
    buffer_load_dwordx4 v[236:239], v2, s[48:51], s65 offen offset:3072 sc1
    s_mov_b32 s62, 1
    s_branch L_CU1
L_CU0:
    buffer_load_dword v15, v12, s[48:51], s61 offen sc1
L_CU1:
    ds_write_b128 v21, v[16:19]
    ds_write_b32 v11, v10 offset:32
    ds_write_b32 v11, v10 offset:4252
    ds_write_b128 v20, v[16:19] offset:10496
    ds_read_b64 v[80:81], v4 offset:0
    ds_read_b64 v[82:83], v4 offset:8
    ds_read_b64 v[84:85], v4 offset:16
    ds_read_b64 v[86:87], v4 offset:512
    ds_read_b64 v[88:89], v4 offset:520
    ds_read_b64 v[90:91], v4 offset:528
    ds_read_b64 v[92:93], v4 offset:1024
    ds_read_b64 v[94:95], v4 offset:1032
    ds_read_b64 v[96:97], v4 offset:1040
    ds_read_b64 v[98:99], v4 offset:1536
    ds_read_b64 v[100:101], v4 offset:1544
    ds_read_b64 v[102:103], v4 offset:1552
    ds_read_b64 v[104:105], v4 offset:2048
    ds_read_b64 v[106:107], v4 offset:2056
    ds_read_b64 v[108:109], v4 offset:2064
    ds_read_b64 v[110:111], v4 offset:2560
    ds_read_b64 v[112:113], v4 offset:2568
    ds_read_b64 v[114:115], v4 offset:2576
    ds_read_b64 v[116:117], v4 offset:3072
    ds_read_b64 v[118:119], v4 offset:3080
    ds_read_b64 v[120:121], v4 offset:3088
    ds_read_b64 v[122:123], v4 offset:3584
    ds_read_b64 v[124:125], v4 offset:3592
    ds_read_b64 v[126:127], v4 offset:3600
    s_waitcnt lgkmcnt(15)
    v_alignbit_b32 v48, v81, v80, v5
    v_alignbit_b32 v49, v82, v81, v5
    v_alignbit_b32 v50, v83, v82, v5
    v_alignbit_b32 v51, v84, v83, v5
    ds_read_b64 v[80:81], v4 offset:24
    ds_read_b64 v[82:83], v4 offset:32
    v_alignbit_b32 v52, v87, v86, v5
    v_alignbit_b32 v53, v88, v87, v5
    v_alignbit_b32 v54, v89, v88, v5
    v_alignbit_b32 v55, v90, v89, v5
    ds_read_b64 v[86:87], v4 offset:536
    ds_read_b64 v[88:89], v4 offset:544
    v_alignbit_b32 v56, v93, v92, v5
    v_alignbit_b32 v57, v94, v93, v5
    v_alignbit_b32 v58, v95, v94, v5
    v_alignbit_b32 v59, v96, v95, v5
    ds_read_b64 v[92:93], v4 offset:1048
    ds_read_b64 v[94:95], v4 offset:1056
    s_waitcnt lgkmcnt(7)
    v_alignbit_b32 v60, v99, v98, v5
    v_alignbit_b32 v61, v100, v99, v5
    v_alignbit_b32 v62, v101, v100, v5
    v_alignbit_b32 v63, v102, v101, v5
    ds_read_b64 v[98:99], v4 offset:1560
    ds_read_b64 v[100:101], v4 offset:1568
    v_alignbit_b32 v64, v105, v104, v5
    v_alignbit_b32 v65, v106, v105, v5
    v_alignbit_b32 v66, v107, v106, v5
    v_alignbit_b32 v67, v108, v107, v5
    ds_read_b64 v[104:105], v4 offset:2072
    ds_read_b64 v[106:107], v4 offset:2080
    v_alignbit_b32 v68, v111, v110, v5
    v_alignbit_b32 v69, v112, v111, v5
    v_alignbit_b32 v70, v113, v112, v5
    v_alignbit_b32 v71, v114, v113, v5
    ds_read_b64 v[110:111], v4 offset:2584
    ds_read_b64 v[112:113], v4 offset:2592
    v_alignbit_b32 v72, v117, v116, v5
    v_alignbit_b32 v73, v118, v117, v5
    v_alignbit_b32 v74, v119, v118, v5
    v_alignbit_b32 v75, v120, v119, v5
    ds_read_b64 v[116:117], v4 offset:3096
    ds_read_b64 v[118:119], v4 offset:3104
    v_alignbit_b32 v76, v123, v122, v5
    v_alignbit_b32 v77, v124, v123, v5
    v_alignbit_b32 v78, v125, v124, v5
    s_waitcnt lgkmcnt(6)
    v_alignbit_b32 v79, v126, v125, v5
    ds_read_b64 v[122:123], v4 offset:3608
    ds_read_b64 v[124:125], v4 offset:3616
    s_cmp_eq_u32 s62, 1
    s_cbranch_scc1 L_CU2
    s_waitcnt vmcnt(0)
    v_cmp_gt_u32 vcc, 1, v15
    s_mov_b32 s78, 0
    s_nop 0
    s_cbranch_vccz L_OK_convu
L_POLL_convu:
    s_sleep 2
    buffer_load_dword v15, v12, s[48:51], s61 offen sc1
    s_add_u32 s78, s78, 1
    s_waitcnt vmcnt(0)
    v_cmp_gt_u32 vcc, 1, v15
    s_cmp_ge_u32 s78, 0x20000
    s_cbranch_scc1 L_OK_convu
    s_cbranch_vccnz L_POLL_convu
L_OK_convu:
    buffer_load_dwordx4 v[224:227], v2, s[48:51], s65 offen offset:0 sc1
    buffer_load_dwordx4 v[228:231], v2, s[48:51], s65 offen offset:1024 sc1
    buffer_load_dwordx4 v[232:235], v2, s[48:51], s65 offen offset:2048 sc1
    buffer_load_dwordx4 v[236:239], v2, s[48:51], s65 offen offset:3072 sc1
L_CU2:
    s_waitcnt vmcnt(0)
    ds_write_b128 v7, v[224:227] offset:8448
    ds_write_b128 v7, v[228:231] offset:8960
    ds_write_b128 v7, v[232:235] offset:9472
    ds_write_b128 v7, v[236:239] offset:9984
    ds_read_b128 v[128:131], v6 offset:10240
    ds_read_b128 v[132:135], v6 offset:9984
    ds_read_b128 v[136:139], v6 offset:9728
    ds_read_b128 v[140:143], v6 offset:9472
    ds_read_b128 v[144:147], v6 offset:9216
    ds_read_b128 v[148:151], v6 offset:8960
    ds_read_b128 v[152:155], v6 offset:8704
    ds_read_b128 v[156:159], v6 offset:8448
    v_mov_b32 v13, s75
    v_mov_b32 v14, 1
    v_add_u32 v13, 81856, v13
    s_mov_b64 exec, 1
    ds_add_u32 v13, v14 offset:8
    s_mov_b64 exec, -1
    s_setprio 0
    v_add_u32 v9, s60, v8
    v_add_u32 v10, s60, v2
    s_waitcnt lgkmcnt(8)
    v_mfma_f32_16x16x32_bf16 v[16:19], v[48:51], v[128:131], 0
    ds_read_b128 v[160:163], v6 offset:12544
    ds_read_b128 v[164:167], v6 offset:12288
    s_waitcnt lgkmcnt(9)
    v_mfma_f32_16x16x32_bf16 v[20:23], v[48:51], v[132:135], 0
    ds_read_b128 v[168:171], v6 offset:12032
    ds_read_b128 v[172:175], v6 offset:11776
    s_waitcnt lgkmcnt(9)
    v_mfma_f32_16x16x32_bf16 v[24:27], v[48:51], v[136:139], 0
    ds_read_b128 v[176:179], v6 offset:11520
    ds_read_b128 v[180:183], v6 offset:11264
    v_mfma_f32_16x16x32_bf16 v[28:31], v[48:51], v[140:143], 0
    ds_read_b128 v[184:187], v6 offset:11008
    ds_read_b128 v[188:191], v6 offset:10752
    s_waitcnt lgkmcnt(9)
    v_mfma_f32_16x16x32_bf16 v[32:35], v[48:51], v[144:147], 0
    v_mfma_f32_16x16x32_bf16 v[36:39], v[48:51], v[148:151], 0
    v_mfma_f32_16x16x32_bf16 v[40:43], v[48:51], v[152:155], 0
    v_mfma_f32_16x16x32_bf16 v[44:47], v[48:51], v[156:159], 0
    v_mfma_f32_16x16x32_bf16 v[20:23], v[52:55], v[128:131], v[20:23]
    v_alignbit_b32 v48, v85, v84, v5
    v_alignbit_b32 v49, v80, v85, v5
    v_mfma_f32_16x16x32_bf16 v[24:27], v[52:55], v[132:135], v[24:27]
    v_alignbit_b32 v50, v81, v80, v5
    v_alignbit_b32 v51, v82, v81, v5
    v_mfma_f32_16x16x32_bf16 v[28:31], v[52:55], v[136:139], v[28:31]
    ds_read_b64 v[84:85], v4 offset:40
    ds_read_b64 v[80:81], v4 offset:48
    v_mfma_f32_16x16x32_bf16 v[32:35], v[52:55], v[140:143], v[32:35]
    v_mfma_f32_16x16x32_bf16 v[36:39], v[52:55], v[144:147], v[36:39]
    v_mfma_f32_16x16x32_bf16 v[40:43], v[52:55], v[148:151], v[40:43]
    v_mfma_f32_16x16x32_bf16 v[44:47], v[52:55], v[152:155], v[44:47]
    v_mfma_f32_16x16x32_bf16 v[24:27], v[56:59], v[128:131], v[24:27]
    v_alignbit_b32 v52, v91, v90, v5
    v_alignbit_b32 v53, v86, v91, v5
    v_mfma_f32_16x16x32_bf16 v[28:31], v[56:59], v[132:135], v[28:31]
    v_alignbit_b32 v54, v87, v86, v5
    v_alignbit_b32 v55, v88, v87, v5
    v_mfma_f32_16x16x32_bf16 v[32:35], v[56:59], v[136:139], v[32:35]
    ds_read_b64 v[90:91], v4 offset:552
    ds_read_b64 v[86:87], v4 offset:560
    v_mfma_f32_16x16x32_bf16 v[36:39], v[56:59], v[140:143], v[36:39]
    v_mfma_f32_16x16x32_bf16 v[40:43], v[56:59], v[144:147], v[40:43]
    v_mfma_f32_16x16x32_bf16 v[44:47], v[56:59], v[148:151], v[44:47]
    v_mfma_f32_16x16x32_bf16 v[28:31], v[60:63], v[128:131], v[28:31]
    v_alignbit_b32 v56, v97, v96, v5
    v_alignbit_b32 v57, v92, v97, v5
    v_mfma_f32_16x16x32_bf16 v[32:35], v[60:63], v[132:135], v[32:35]
    v_alignbit_b32 v58, v93, v92, v5
    v_alignbit_b32 v59, v94, v93, v5
    v_mfma_f32_16x16x32_bf16 v[36:39], v[60:63], v[136:139], v[36:39]
    ds_read_b64 v[96:97], v4 offset:1064
    ds_read_b64 v[92:93], v4 offset:1072
    v_mfma_f32_16x16x32_bf16 v[40:43], v[60:63], v[140:143], v[40:43]
    v_mfma_f32_16x16x32_bf16 v[44:47], v[60:63], v[144:147], v[44:47]
    v_mfma_f32_16x16x32_bf16 v[32:35], v[64:67], v[128:131], v[32:35]
    v_alignbit_b32 v60, v103, v102, v5
    v_alignbit_b32 v61, v98, v103, v5
    v_mfma_f32_16x16x32_bf16 v[36:39], v[64:67], v[132:135], v[36:39]
    v_alignbit_b32 v62, v99, v98, v5
    v_alignbit_b32 v63, v100, v99, v5
    v_mfma_f32_16x16x32_bf16 v[40:43], v[64:67], v[136:139], v[40:43]
    ds_read_b64 v[102:103], v4 offset:1576
    ds_read_b64 v[98:99], v4 offset:1584
    v_mfma_f32_16x16x32_bf16 v[44:47], v[64:67], v[140:143], v[44:47]
    v_mfma_f32_16x16x32_bf16 v[36:39], v[68:71], v[128:131], v[36:39]
    v_alignbit_b32 v64, v109, v108, v5
    v_alignbit_b32 v65, v104, v109, v5
    v_mfma_f32_16x16x32_bf16 v[40:43], v[68:71], v[132:135], v[40:43]
    v_alignbit_b32 v66, v105, v104, v5
    v_alignbit_b32 v67, v106, v105, v5
    v_mfma_f32_16x16x32_bf16 v[44:47], v[68:71], v[136:139], v[44:47]
    ds_read_b64 v[108:109], v4 offset:2088
    ds_read_b64 v[104:105], v4 offset:2096
    v_mfma_f32_16x16x32_bf16 v[40:43], v[72:75], v[128:131], v[40:43]
    v_alignbit_b32 v68, v115, v114, v5
    v_alignbit_b32 v69, v110, v115, v5
    v_mfma_f32_16x16x32_bf16 v[44:47], v[72:75], v[132:135], v[44:47]
    v_alignbit_b32 v70, v111, v110, v5
    v_alignbit_b32 v71, v112, v111, v5
    v_mfma_f32_16x16x32_bf16 v[44:47], v[76:79], v[128:131], v[44:47]
    ds_read_b64 v[114:115], v4 offset:2600
    ds_read_b64 v[110:111], v4 offset:2608
    s_waitcnt lgkmcnt(4)
    v_mfma_f32_16x16x32_bf16 v[16:19], v[48:51], v[160:163], v[16:19]
    v_alignbit_b32 v72, v121, v120, v5
    v_alignbit_b32 v73, v116, v121, v5
    v_mfma_f32_16x16x32_bf16 v[20:23], v[48:51], v[164:167], v[20:23]
    v_alignbit_b32 v74, v117, v116, v5
    v_alignbit_b32 v75, v118, v117, v5
    v_mfma_f32_16x16x32_bf16 v[24:27], v[48:51], v[168:171], v[24:27]
    ds_read_b64 v[120:121], v4 offset:3112
    ds_read_b64 v[116:117], v4 offset:3120
    v_mfma_f32_16x16x32_bf16 v[28:31], v[48:51], v[172:175], v[28:31]
    v_alignbit_b32 v76, v127, v126, v5
    v_alignbit_b32 v77, v122, v127, v5
    v_mfma_f32_16x16x32_bf16 v[32:35], v[48:51], v[176:179], v[32:35]
    v_alignbit_b32 v78, v123, v122, v5
    v_alignbit_b32 v79, v124, v123, v5
    v_mfma_f32_16x16x32_bf16 v[36:39], v[48:51], v[180:183], v[36:39]
    ds_read_b64 v[126:127], v4 offset:3624
    ds_read_b64 v[122:123], v4 offset:3632
    v_mfma_f32_16x16x32_bf16 v[40:43], v[48:51], v[184:187], v[40:43]
    ds_read_b128 v[128:131], v6 offset:10256
    ds_read_b128 v[132:135], v6 offset:10000
    v_mfma_f32_16x16x32_bf16 v[44:47], v[48:51], v[188:191], v[44:47]
    ds_read_b128 v[136:139], v6 offset:9744
    ds_read_b128 v[140:143], v6 offset:9488
    v_mfma_f32_16x16x32_bf16 v[20:23], v[52:55], v[160:163], v[20:23]
    ds_read_b128 v[144:147], v6 offset:9232
    ds_read_b128 v[148:151], v6 offset:8976
    v_mfma_f32_16x16x32_bf16 v[24:27], v[52:55], v[164:167], v[24:27]
    ds_read_b128 v[152:155], v6 offset:8720
    ds_read_b128 v[156:159], v6 offset:8464
    v_mfma_f32_16x16x32_bf16 v[28:31], v[52:55], v[168:171], v[28:31]
    v_alignbit_b32 v48, v83, v82, v5
    v_alignbit_b32 v49, v84, v83, v5
    v_mfma_f32_16x16x32_bf16 v[32:35], v[52:55], v[172:175], v[32:35]
    v_alignbit_b32 v50, v85, v84, v5
    v_alignbit_b32 v51, v80, v85, v5
    v_mfma_f32_16x16x32_bf16 v[36:39], v[52:55], v[176:179], v[36:39]
    ds_read_b64 v[82:83], v4 offset:56
    ds_read_b64 v[84:85], v4 offset:64
    v_mfma_f32_16x16x32_bf16 v[40:43], v[52:55], v[180:183], v[40:43]
    v_mfma_f32_16x16x32_bf16 v[44:47], v[52:55], v[184:187], v[44:47]
    v_mfma_f32_16x16x32_bf16 v[24:27], v[56:59], v[160:163], v[24:27]
    v_alignbit_b32 v52, v89, v88, v5
    v_alignbit_b32 v53, v90, v89, v5
    v_mfma_f32_16x16x32_bf16 v[28:31], v[56:59], v[164:167], v[28:31]
    v_alignbit_b32 v54, v91, v90, v5
    v_alignbit_b32 v55, v86, v91, v5
    v_mfma_f32_16x16x32_bf16 v[32:35], v[56:59], v[168:171], v[32:35]
    ds_read_b64 v[88:89], v4 offset:568
    ds_read_b64 v[90:91], v4 offset:576
    v_mfma_f32_16x16x32_bf16 v[36:39], v[56:59], v[172:175], v[36:39]
    v_mfma_f32_16x16x32_bf16 v[40:43], v[56:59], v[176:179], v[40:43]
    v_mfma_f32_16x16x32_bf16 v[44:47], v[56:59], v[180:183], v[44:47]
    v_mfma_f32_16x16x32_bf16 v[28:31], v[60:63], v[160:163], v[28:31]
    v_alignbit_b32 v56, v95, v94, v5
    v_alignbit_b32 v57, v96, v95, v5
    v_mfma_f32_16x16x32_bf16 v[32:35], v[60:63], v[164:167], v[32:35]
    v_alignbit_b32 v58, v97, v96, v5
    v_alignbit_b32 v59, v92, v97, v5
    v_mfma_f32_16x16x32_bf16 v[36:39], v[60:63], v[168:171], v[36:39]
    ds_read_b64 v[94:95], v4 offset:1080
    ds_read_b64 v[96:97], v4 offset:1088
    v_mfma_f32_16x16x32_bf16 v[40:43], v[60:63], v[172:175], v[40:43]
    v_mfma_f32_16x16x32_bf16 v[44:47], v[60:63], v[176:179], v[44:47]
    v_mfma_f32_16x16x32_bf16 v[32:35], v[64:67], v[160:163], v[32:35]
    v_alignbit_b32 v60, v101, v100, v5
    v_alignbit_b32 v61, v102, v101, v5
    v_mfma_f32_16x16x32_bf16 v[36:39], v[64:67], v[164:167], v[36:39]
    v_alignbit_b32 v62, v103, v102, v5
    v_alignbit_b32 v63, v98, v103, v5
    v_mfma_f32_16x16x32_bf16 v[40:43], v[64:67], v[168:171], v[40:43]
    ds_read_b64 v[100:101], v4 offset:1592
    ds_read_b64 v[102:103], v4 offset:1600
    v_mfma_f32_16x16x32_bf16 v[44:47], v[64:67], v[172:175], v[44:47]
    v_mfma_f32_16x16x32_bf16 v[36:39], v[68:71], v[160:163], v[36:39]
    v_alignbit_b32 v64, v107, v106, v5
    s_waitcnt lgkmcnt(4)
    v_alignbit_b32 v65, v108, v107, v5
    v_mfma_f32_16x16x32_bf16 v[40:43], v[68:71], v[164:167], v[40:43]
    v_alignbit_b32 v66, v109, v108, v5
    v_alignbit_b32 v67, v104, v109, v5
    v_mfma_f32_16x16x32_bf16 v[44:47], v[68:71], v[168:171], v[44:47]
    ds_read_b64 v[106:107], v4 offset:2104
    ds_read_b64 v[108:109], v4 offset:2112
    v_mfma_f32_16x16x32_bf16 v[40:43], v[72:75], v[160:163], v[40:43]
    v_alignbit_b32 v68, v113, v112, v5
    v_alignbit_b32 v69, v114, v113, v5
    v_mfma_f32_16x16x32_bf16 v[44:47], v[72:75], v[164:167], v[44:47]
    v_alignbit_b32 v70, v115, v114, v5
    v_alignbit_b32 v71, v110, v115, v5
    v_mfma_f32_16x16x32_bf16 v[44:47], v[76:79], v[160:163], v[44:47]
    ds_read_b64 v[112:113], v4 offset:2616
    ds_read_b64 v[114:115], v4 offset:2624
    v_mfma_f32_16x16x32_bf16 v[16:19], v[48:51], v[128:131], v[16:19]
    v_alignbit_b32 v72, v119, v118, v5
    v_alignbit_b32 v73, v120, v119, v5
    v_mfma_f32_16x16x32_bf16 v[20:23], v[48:51], v[132:135], v[20:23]
    v_alignbit_b32 v74, v121, v120, v5
    v_alignbit_b32 v75, v116, v121, v5
    v_mfma_f32_16x16x32_bf16 v[24:27], v[48:51], v[136:139], v[24:27]
    ds_read_b64 v[118:119], v4 offset:3128
    ds_read_b64 v[120:121], v4 offset:3136
    v_mfma_f32_16x16x32_bf16 v[28:31], v[48:51], v[140:143], v[28:31]
    v_alignbit_b32 v76, v125, v124, v5
    v_alignbit_b32 v77, v126, v125, v5
    v_mfma_f32_16x16x32_bf16 v[32:35], v[48:51], v[144:147], v[32:35]
    v_alignbit_b32 v78, v127, v126, v5
    v_alignbit_b32 v79, v122, v127, v5
    v_mfma_f32_16x16x32_bf16 v[36:39], v[48:51], v[148:151], v[36:39]
    ds_read_b64 v[124:125], v4 offset:3640
    ds_read_b64 v[126:127], v4 offset:3648
    v_mfma_f32_16x16x32_bf16 v[40:43], v[48:51], v[152:155], v[40:43]
    ds_read_b128 v[160:163], v6 offset:12560
    ds_read_b128 v[164:167], v6 offset:12304
    v_mfma_f32_16x16x32_bf16 v[44:47], v[48:51], v[156:159], v[44:47]
    ds_read_b128 v[168:171], v6 offset:12048
    ds_read_b128 v[172:175], v6 offset:11792
    v_mfma_f32_16x16x32_bf16 v[20:23], v[52:55], v[128:131], v[20:23]
    ds_read_b128 v[176:179], v6 offset:11536
    ds_read_b128 v[180:183], v6 offset:11280
    v_mfma_f32_16x16x32_bf16 v[24:27], v[52:55], v[132:135], v[24:27]
    ds_read_b128 v[184:187], v6 offset:11024
    ds_read_b128 v[188:191], v6 offset:10768
    v_mfma_f32_16x16x32_bf16 v[28:31], v[52:55], v[136:139], v[28:31]
    v_alignbit_b32 v48, v81, v80, v5
    v_alignbit_b32 v49, v82, v81, v5
    v_mfma_f32_16x16x32_bf16 v[32:35], v[52:55], v[140:143], v[32:35]
    v_alignbit_b32 v50, v83, v82, v5
    v_alignbit_b32 v51, v84, v83, v5
    v_mfma_f32_16x16x32_bf16 v[36:39], v[52:55], v[144:147], v[36:39]
    ds_read_b64 v[80:81], v4 offset:256
    ds_read_b64 v[82:83], v4 offset:264
    v_mfma_f32_16x16x32_bf16 v[40:43], v[52:55], v[148:151], v[40:43]
    ds_read_b64 v[84:85], v4 offset:272
    v_mfma_f32_16x16x32_bf16 v[44:47], v[52:55], v[152:155], v[44:47]
    v_mfma_f32_16x16x32_bf16 v[24:27], v[56:59], v[128:131], v[24:27]
    v_alignbit_b32 v52, v87, v86, v5
    v_alignbit_b32 v53, v88, v87, v5
    v_mfma_f32_16x16x32_bf16 v[28:31], v[56:59], v[132:135], v[28:31]
    v_alignbit_b32 v54, v89, v88, v5
    v_alignbit_b32 v55, v90, v89, v5
    v_mfma_f32_16x16x32_bf16 v[32:35], v[56:59], v[136:139], v[32:35]
    ds_read_b64 v[86:87], v4 offset:768
    ds_read_b64 v[88:89], v4 offset:776
    v_mfma_f32_16x16x32_bf16 v[36:39], v[56:59], v[140:143], v[36:39]
    ds_read_b64 v[90:91], v4 offset:784
    v_mfma_f32_16x16x32_bf16 v[40:43], v[56:59], v[144:147], v[40:43]
    v_mfma_f32_16x16x32_bf16 v[44:47], v[56:59], v[148:151], v[44:47]
    v_mfma_f32_16x16x32_bf16 v[28:31], v[60:63], v[128:131], v[28:31]
    v_alignbit_b32 v56, v93, v92, v5
    s_waitcnt lgkmcnt(5)
    v_alignbit_b32 v57, v94, v93, v5
    v_mfma_f32_16x16x32_bf16 v[32:35], v[60:63], v[132:135], v[32:35]
    v_alignbit_b32 v58, v95, v94, v5
    v_alignbit_b32 v59, v96, v95, v5
    v_mfma_f32_16x16x32_bf16 v[36:39], v[60:63], v[136:139], v[36:39]
    ds_read_b64 v[92:93], v4 offset:1280
    ds_read_b64 v[94:95], v4 offset:1288
    v_mfma_f32_16x16x32_bf16 v[40:43], v[60:63], v[140:143], v[40:43]
    ds_read_b64 v[96:97], v4 offset:1296
    v_mfma_f32_16x16x32_bf16 v[44:47], v[60:63], v[144:147], v[44:47]
    v_mfma_f32_16x16x32_bf16 v[32:35], v[64:67], v[128:131], v[32:35]
    v_alignbit_b32 v60, v99, v98, v5
    v_alignbit_b32 v61, v100, v99, v5
    v_mfma_f32_16x16x32_bf16 v[36:39], v[64:67], v[132:135], v[36:39]
    v_alignbit_b32 v62, v101, v100, v5
    v_alignbit_b32 v63, v102, v101, v5
    v_mfma_f32_16x16x32_bf16 v[40:43], v[64:67], v[136:139], v[40:43]
    ds_read_b64 v[98:99], v4 offset:1792
    ds_read_b64 v[100:101], v4 offset:1800
    v_mfma_f32_16x16x32_bf16 v[44:47], v[64:67], v[140:143], v[44:47]
    ds_read_b64 v[102:103], v4 offset:1808
    v_mfma_f32_16x16x32_bf16 v[36:39], v[68:71], v[128:131], v[36:39]
    v_alignbit_b32 v64, v105, v104, v5
    v_alignbit_b32 v65, v106, v105, v5
    v_mfma_f32_16x16x32_bf16 v[40:43], v[68:71], v[132:135], v[40:43]
    v_alignbit_b32 v66, v107, v106, v5
    v_alignbit_b32 v67, v108, v107, v5
    v_mfma_f32_16x16x32_bf16 v[44:47], v[68:71], v[136:139], v[44:47]
    ds_read_b64 v[104:105], v4 offset:2304
    ds_read_b64 v[106:107], v4 offset:2312
    v_mfma_f32_16x16x32_bf16 v[40:43], v[72:75], v[128:131], v[40:43]
    ds_read_b64 v[108:109], v4 offset:2320
    v_alignbit_b32 v68, v111, v110, v5
    v_mfma_f32_16x16x32_bf16 v[44:47], v[72:75], v[132:135], v[44:47]
    v_alignbit_b32 v69, v112, v111, v5
    v_alignbit_b32 v70, v113, v112, v5
    v_mfma_f32_16x16x32_bf16 v[44:47], v[76:79], v[128:131], v[44:47]
    v_alignbit_b32 v71, v114, v113, v5
    ds_read_b64 v[110:111], v4 offset:2816
    v_mfma_f32_16x16x32_bf16 v[16:19], v[48:51], v[160:163], v[16:19]
    ds_read_b64 v[112:113], v4 offset:2824
    ds_read_b64 v[114:115], v4 offset:2832
    v_mfma_f32_16x16x32_bf16 v[20:23], v[48:51], v[164:167], v[20:23]
    v_alignbit_b32 v72, v117, v116, v5
    v_alignbit_b32 v73, v118, v117, v5
    v_mfma_f32_16x16x32_bf16 v[24:27], v[48:51], v[168:171], v[24:27]
    v_alignbit_b32 v74, v119, v118, v5
    v_alignbit_b32 v75, v120, v119, v5
    v_mfma_f32_16x16x32_bf16 v[28:31], v[48:51], v[172:175], v[28:31]
    ds_read_b64 v[116:117], v4 offset:3328
    ds_read_b64 v[118:119], v4 offset:3336
    v_mfma_f32_16x16x32_bf16 v[32:35], v[48:51], v[176:179], v[32:35]
    ds_read_b64 v[120:121], v4 offset:3344
    v_alignbit_b32 v76, v123, v122, v5
    v_mfma_f32_16x16x32_bf16 v[36:39], v[48:51], v[180:183], v[36:39]
    v_alignbit_b32 v77, v124, v123, v5
    v_alignbit_b32 v78, v125, v124, v5
    v_mfma_f32_16x16x32_bf16 v[40:43], v[48:51], v[184:187], v[40:43]
    v_alignbit_b32 v79, v126, v125, v5
    ds_read_b64 v[122:123], v4 offset:3840
    v_mfma_f32_16x16x32_bf16 v[44:47], v[48:51], v[188:191], v[44:47]
    ds_read_b64 v[124:125], v4 offset:3848
    ds_read_b64 v[126:127], v4 offset:3856
    v_mfma_f32_16x16x32_bf16 v[20:23], v[52:55], v[160:163], v[20:23]
    ds_read_b128 v[128:131], v6 offset:10368
    ds_read_b128 v[132:135], v6 offset:10112
    v_mfma_f32_16x16x32_bf16 v[24:27], v[52:55], v[164:167], v[24:27]
    ds_read_b128 v[136:139], v6 offset:9856
    ds_read_b128 v[140:143], v6 offset:9600
    v_mfma_f32_16x16x32_bf16 v[28:31], v[52:55], v[168:171], v[28:31]
    ds_read_b128 v[144:147], v6 offset:9344
    ds_read_b128 v[148:151], v6 offset:9088
    v_mfma_f32_16x16x32_bf16 v[32:35], v[52:55], v[172:175], v[32:35]
    ds_read_b128 v[152:155], v6 offset:8832
    ds_read_b128 v[156:159], v6 offset:8576
    v_mfma_f32_16x16x32_bf16 v[36:39], v[52:55], v[176:179], v[36:39]
    v_alignbit_b32 v48, v81, v80, v5
    s_waitcnt lgkmcnt(11)
    v_alignbit_b32 v49, v82, v81, v5
    v_mfma_f32_16x16x32_bf16 v[40:43], v[52:55], v[180:183], v[40:43]
    v_alignbit_b32 v50, v83, v82, v5
    v_alignbit_b32 v51, v84, v83, v5
    v_mfma_f32_16x16x32_bf16 v[44:47], v[52:55], v[184:187], v[44:47]
    ds_read_b64 v[80:81], v4 offset:280
    ds_read_b64 v[82:83], v4 offset:288
    v_mfma_f32_16x16x32_bf16 v[24:27], v[56:59], v[160:163], v[24:27]
    v_alignbit_b32 v52, v87, v86, v5
    v_alignbit_b32 v53, v88, v87, v5
    v_mfma_f32_16x16x32_bf16 v[28:31], v[56:59], v[164:167], v[28:31]
    v_alignbit_b32 v54, v89, v88, v5
    v_alignbit_b32 v55, v90, v89, v5
    v_mfma_f32_16x16x32_bf16 v[32:35], v[56:59], v[168:171], v[32:35]
    ds_read_b64 v[86:87], v4 offset:792
    ds_read_b64 v[88:89], v4 offset:800
    v_mfma_f32_16x16x32_bf16 v[36:39], v[56:59], v[172:175], v[36:39]
    v_mfma_f32_16x16x32_bf16 v[40:43], v[56:59], v[176:179], v[40:43]
    v_mfma_f32_16x16x32_bf16 v[44:47], v[56:59], v[180:183], v[44:47]
    v_mfma_f32_16x16x32_bf16 v[28:31], v[60:63], v[160:163], v[28:31]
    v_alignbit_b32 v56, v93, v92, v5
    v_alignbit_b32 v57, v94, v93, v5
    v_mfma_f32_16x16x32_bf16 v[32:35], v[60:63], v[164:167], v[32:35]
    v_alignbit_b32 v58, v95, v94, v5
    v_alignbit_b32 v59, v96, v95, v5
    v_mfma_f32_16x16x32_bf16 v[36:39], v[60:63], v[168:171], v[36:39]
    ds_read_b64 v[92:93], v4 offset:1304
    ds_read_b64 v[94:95], v4 offset:1312
    v_mfma_f32_16x16x32_bf16 v[40:43], v[60:63], v[172:175], v[40:43]
    v_mfma_f32_16x16x32_bf16 v[44:47], v[60:63], v[176:179], v[44:47]
    v_mfma_f32_16x16x32_bf16 v[32:35], v[64:67], v[160:163], v[32:35]
    v_alignbit_b32 v60, v99, v98, v5
    v_alignbit_b32 v61, v100, v99, v5
    v_mfma_f32_16x16x32_bf16 v[36:39], v[64:67], v[164:167], v[36:39]
    v_alignbit_b32 v62, v101, v100, v5
    v_alignbit_b32 v63, v102, v101, v5
    v_mfma_f32_16x16x32_bf16 v[40:43], v[64:67], v[168:171], v[40:43]
    ds_read_b64 v[98:99], v4 offset:1816
    ds_read_b64 v[100:101], v4 offset:1824
    v_mfma_f32_16x16x32_bf16 v[44:47], v[64:67], v[172:175], v[44:47]
    v_mfma_f32_16x16x32_bf16 v[36:39], v[68:71], v[160:163], v[36:39]
    v_alignbit_b32 v64, v105, v104, v5
    v_alignbit_b32 v65, v106, v105, v5
    v_mfma_f32_16x16x32_bf16 v[40:43], v[68:71], v[164:167], v[40:43]
    v_alignbit_b32 v66, v107, v106, v5
    v_alignbit_b32 v67, v108, v107, v5
    v_mfma_f32_16x16x32_bf16 v[44:47], v[68:71], v[168:171], v[44:47]
    ds_read_b64 v[104:105], v4 offset:2328
    ds_read_b64 v[106:107], v4 offset:2336
    v_mfma_f32_16x16x32_bf16 v[40:43], v[72:75], v[160:163], v[40:43]
    v_alignbit_b32 v68, v111, v110, v5
    v_alignbit_b32 v69, v112, v111, v5
    v_mfma_f32_16x16x32_bf16 v[44:47], v[72:75], v[164:167], v[44:47]
    v_alignbit_b32 v70, v113, v112, v5
    v_alignbit_b32 v71, v114, v113, v5
    v_mfma_f32_16x16x32_bf16 v[44:47], v[76:79], v[160:163], v[44:47]
    ds_read_b64 v[110:111], v4 offset:2840
    ds_read_b64 v[112:113], v4 offset:2848
    s_cmp_ge_u32 s56, 10
    s_cbranch_scc1 L_NQ
    buffer_load_dwordx4 v[192:195], v247, s[36:39], s70 offen offset:0
    buffer_load_dwordx4 v[196:199], v247, s[36:39], s70 offen offset:1280
    buffer_load_dwordx4 v[200:203], v247, s[36:39], s70 offen offset:2560
    buffer_load_dwordx4 v[204:207], v247, s[36:39], s70 offen offset:3840
    buffer_load_dwordx4 v[208:211], v247, s[36:39], s71 offen offset:0
    buffer_load_dwordx4 v[212:215], v247, s[36:39], s71 offen offset:1280
    buffer_load_dwordx4 v[216:219], v247, s[36:39], s71 offen offset:2560
    buffer_load_dwordx4 v[220:223], v247, s[36:39], s71 offen offset:3840
L_NQ:
    s_waitcnt lgkmcnt(2)
    v_mfma_f32_16x16x32_bf16 v[16:19], v[48:51], v[128:131], v[16:19]
    v_alignbit_b32 v72, v117, v116, v5
    v_alignbit_b32 v73, v118, v117, v5
    v_mfma_f32_16x16x32_bf16 v[20:23], v[48:51], v[132:135], v[20:23]
    v_alignbit_b32 v74, v119, v118, v5
    v_alignbit_b32 v75, v120, v119, v5
    v_mfma_f32_16x16x32_bf16 v[24:27], v[48:51], v[136:139], v[24:27]
    ds_read_b64 v[116:117], v4 offset:3352
    ds_read_b64 v[118:119], v4 offset:3360
    v_mfma_f32_16x16x32_bf16 v[28:31], v[48:51], v[140:143], v[28:31]
    v_alignbit_b32 v76, v123, v122, v5
    v_alignbit_b32 v77, v124, v123, v5
    v_mfma_f32_16x16x32_bf16 v[32:35], v[48:51], v[144:147], v[32:35]
    v_alignbit_b32 v78, v125, v124, v5
    v_alignbit_b32 v79, v126, v125, v5
    v_mfma_f32_16x16x32_bf16 v[36:39], v[48:51], v[148:151], v[36:39]
    ds_read_b64 v[122:123], v4 offset:3864
    ds_read_b64 v[124:125], v4 offset:3872
    v_mfma_f32_16x16x32_bf16 v[40:43], v[48:51], v[152:155], v[40:43]
    ds_read_b128 v[160:163], v6 offset:12672
    ds_read_b128 v[164:167], v6 offset:12416
    v_mfma_f32_16x16x32_bf16 v[44:47], v[48:51], v[156:159], v[44:47]
    ds_read_b128 v[168:171], v6 offset:12160
    ds_read_b128 v[172:175], v6 offset:11904
    v_mfma_f32_16x16x32_bf16 v[20:23], v[52:55], v[128:131], v[20:23]
    ds_read_b128 v[176:179], v6 offset:11648
    ds_read_b128 v[180:183], v6 offset:11392
    v_mfma_f32_16x16x32_bf16 v[24:27], v[52:55], v[132:135], v[24:27]
    ds_read_b128 v[184:187], v6 offset:11136
    ds_read_b128 v[188:191], v6 offset:10880
    v_mfma_f32_16x16x32_bf16 v[28:31], v[52:55], v[136:139], v[28:31]
    v_alignbit_b32 v48, v85, v84, v5
    v_alignbit_b32 v49, v80, v85, v5
    v_mfma_f32_16x16x32_bf16 v[32:35], v[52:55], v[140:143], v[32:35]
    v_alignbit_b32 v50, v81, v80, v5
    v_alignbit_b32 v51, v82, v81, v5
    v_mfma_f32_16x16x32_bf16 v[36:39], v[52:55], v[144:147], v[36:39]
    ds_read_b64 v[84:85], v4 offset:296
    ds_read_b64 v[80:81], v4 offset:304
    v_mfma_f32_16x16x32_bf16 v[40:43], v[52:55], v[148:151], v[40:43]
    v_mfma_f32_16x16x32_bf16 v[44:47], v[52:55], v[152:155], v[44:47]
    v_mfma_f32_16x16x32_bf16 v[24:27], v[56:59], v[128:131], v[24:27]
    v_alignbit_b32 v52, v91, v90, v5
    v_alignbit_b32 v53, v86, v91, v5
    v_mfma_f32_16x16x32_bf16 v[28:31], v[56:59], v[132:135], v[28:31]
    v_alignbit_b32 v54, v87, v86, v5
    v_alignbit_b32 v55, v88, v87, v5
    v_mfma_f32_16x16x32_bf16 v[32:35], v[56:59], v[136:139], v[32:35]
    ds_read_b64 v[90:91], v4 offset:808
    ds_read_b64 v[86:87], v4 offset:816
    v_mfma_f32_16x16x32_bf16 v[36:39], v[56:59], v[140:143], v[36:39]
    v_mfma_f32_16x16x32_bf16 v[40:43], v[56:59], v[144:147], v[40:43]
    v_mfma_f32_16x16x32_bf16 v[44:47], v[56:59], v[148:151], v[44:47]
    v_mfma_f32_16x16x32_bf16 v[28:31], v[60:63], v[128:131], v[28:31]
    v_alignbit_b32 v56, v97, v96, v5
    v_alignbit_b32 v57, v92, v97, v5
    v_mfma_f32_16x16x32_bf16 v[32:35], v[60:63], v[132:135], v[32:35]
    v_alignbit_b32 v58, v93, v92, v5
    v_alignbit_b32 v59, v94, v93, v5
    v_mfma_f32_16x16x32_bf16 v[36:39], v[60:63], v[136:139], v[36:39]
    ds_read_b64 v[96:97], v4 offset:1320
    ds_read_b64 v[92:93], v4 offset:1328
    v_mfma_f32_16x16x32_bf16 v[40:43], v[60:63], v[140:143], v[40:43]
    v_mfma_f32_16x16x32_bf16 v[44:47], v[60:63], v[144:147], v[44:47]
    v_mfma_f32_16x16x32_bf16 v[32:35], v[64:67], v[128:131], v[32:35]
    v_alignbit_b32 v60, v103, v102, v5
    v_alignbit_b32 v61, v98, v103, v5
    v_mfma_f32_16x16x32_bf16 v[36:39], v[64:67], v[132:135], v[36:39]
    v_alignbit_b32 v62, v99, v98, v5
    v_alignbit_b32 v63, v100, v99, v5
    v_mfma_f32_16x16x32_bf16 v[40:43], v[64:67], v[136:139], v[40:43]
    ds_read_b64 v[102:103], v4 offset:1832
    ds_read_b64 v[98:99], v4 offset:1840
    v_mfma_f32_16x16x32_bf16 v[44:47], v[64:67], v[140:143], v[44:47]
    v_mfma_f32_16x16x32_bf16 v[36:39], v[68:71], v[128:131], v[36:39]
    v_alignbit_b32 v64, v109, v108, v5
    v_alignbit_b32 v65, v104, v109, v5
    v_mfma_f32_16x16x32_bf16 v[40:43], v[68:71], v[132:135], v[40:43]
    v_alignbit_b32 v66, v105, v104, v5
    v_alignbit_b32 v67, v106, v105, v5
    v_mfma_f32_16x16x32_bf16 v[44:47], v[68:71], v[136:139], v[44:47]
    ds_read_b64 v[108:109], v4 offset:2344
    ds_read_b64 v[104:105], v4 offset:2352
    v_mfma_f32_16x16x32_bf16 v[40:43], v[72:75], v[128:131], v[40:43]
    v_alignbit_b32 v68, v115, v114, v5
    s_waitcnt lgkmcnt(4)
    v_alignbit_b32 v69, v110, v115, v5
    v_mfma_f32_16x16x32_bf16 v[44:47], v[72:75], v[132:135], v[44:47]
    v_alignbit_b32 v70, v111, v110, v5
    v_alignbit_b32 v71, v112, v111, v5
    v_mfma_f32_16x16x32_bf16 v[44:47], v[76:79], v[128:131], v[44:47]
    ds_read_b64 v[114:115], v4 offset:2856
    ds_read_b64 v[110:111], v4 offset:2864
    v_mfma_f32_16x16x32_bf16 v[16:19], v[48:51], v[160:163], v[16:19]
    v_alignbit_b32 v72, v121, v120, v5
    v_alignbit_b32 v73, v116, v121, v5
    v_mfma_f32_16x16x32_bf16 v[20:23], v[48:51], v[164:167], v[20:23]
    v_alignbit_b32 v74, v117, v116, v5
    v_alignbit_b32 v75, v118, v117, v5
    v_mfma_f32_16x16x32_bf16 v[24:27], v[48:51], v[168:171], v[24:27]
    ds_read_b64 v[120:121], v4 offset:3368
    ds_read_b64 v[116:117], v4 offset:3376
    v_mfma_f32_16x16x32_bf16 v[28:31], v[48:51], v[172:175], v[28:31]
    v_alignbit_b32 v76, v127, v126, v5
    v_alignbit_b32 v77, v122, v127, v5
    v_mfma_f32_16x16x32_bf16 v[32:35], v[48:51], v[176:179], v[32:35]
    v_alignbit_b32 v78, v123, v122, v5
    v_alignbit_b32 v79, v124, v123, v5
    v_mfma_f32_16x16x32_bf16 v[36:39], v[48:51], v[180:183], v[36:39]
    ds_read_b64 v[126:127], v4 offset:3880
    ds_read_b64 v[122:123], v4 offset:3888
    v_mfma_f32_16x16x32_bf16 v[40:43], v[48:51], v[184:187], v[40:43]
    ds_read_b128 v[128:131], v6 offset:10384
    ds_read_b128 v[132:135], v6 offset:10128
    v_mfma_f32_16x16x32_bf16 v[44:47], v[48:51], v[188:191], v[44:47]
    ds_read_b128 v[136:139], v6 offset:9872
    ds_read_b128 v[140:143], v6 offset:9616
    v_mfma_f32_16x16x32_bf16 v[20:23], v[52:55], v[160:163], v[20:23]
    ds_read_b128 v[144:147], v6 offset:9360
    ds_read_b128 v[148:151], v6 offset:9104
    v_mfma_f32_16x16x32_bf16 v[24:27], v[52:55], v[164:167], v[24:27]
    ds_read_b128 v[152:155], v6 offset:8848
    ds_read_b128 v[156:159], v6 offset:8592
    v_mfma_f32_16x16x32_bf16 v[28:31], v[52:55], v[168:171], v[28:31]
    v_alignbit_b32 v48, v83, v82, v5
    v_alignbit_b32 v49, v84, v83, v5
    v_mfma_f32_16x16x32_bf16 v[32:35], v[52:55], v[172:175], v[32:35]
    v_alignbit_b32 v50, v85, v84, v5
    v_alignbit_b32 v51, v80, v85, v5
    v_mfma_f32_16x16x32_bf16 v[36:39], v[52:55], v[176:179], v[36:39]
    ds_read_b64 v[82:83], v4 offset:312
    ds_read_b64 v[84:85], v4 offset:320
    v_mfma_f32_16x16x32_bf16 v[40:43], v[52:55], v[180:183], v[40:43]
    v_mfma_f32_16x16x32_bf16 v[44:47], v[52:55], v[184:187], v[44:47]
    v_mfma_f32_16x16x32_bf16 v[24:27], v[56:59], v[160:163], v[24:27]
    v_alignbit_b32 v52, v89, v88, v5
    v_alignbit_b32 v53, v90, v89, v5
    v_mfma_f32_16x16x32_bf16 v[28:31], v[56:59], v[164:167], v[28:31]
    v_alignbit_b32 v54, v91, v90, v5
    v_alignbit_b32 v55, v86, v91, v5
    v_mfma_f32_16x16x32_bf16 v[32:35], v[56:59], v[168:171], v[32:35]
    ds_read_b64 v[88:89], v4 offset:824
    ds_read_b64 v[90:91], v4 offset:832
    v_mfma_f32_16x16x32_bf16 v[36:39], v[56:59], v[172:175], v[36:39]
    v_mfma_f32_16x16x32_bf16 v[40:43], v[56:59], v[176:179], v[40:43]
    v_mfma_f32_16x16x32_bf16 v[44:47], v[56:59], v[180:183], v[44:47]
    v_mfma_f32_16x16x32_bf16 v[28:31], v[60:63], v[160:163], v[28:31]
    v_alignbit_b32 v56, v95, v94, v5
    v_alignbit_b32 v57, v96, v95, v5
    v_mfma_f32_16x16x32_bf16 v[32:35], v[60:63], v[164:167], v[32:35]
    v_alignbit_b32 v58, v97, v96, v5
    v_alignbit_b32 v59, v92, v97, v5
    v_mfma_f32_16x16x32_bf16 v[36:39], v[60:63], v[168:171], v[36:39]
    ds_read_b64 v[94:95], v4 offset:1336
    ds_read_b64 v[96:97], v4 offset:1344
    v_mfma_f32_16x16x32_bf16 v[40:43], v[60:63], v[172:175], v[40:43]
    v_mfma_f32_16x16x32_bf16 v[44:47], v[60:63], v[176:179], v[44:47]
    v_mfma_f32_16x16x32_bf16 v[32:35], v[64:67], v[160:163], v[32:35]
    v_alignbit_b32 v60, v101, v100, v5
    s_waitcnt lgkmcnt(4)
    v_alignbit_b32 v61, v102, v101, v5
    v_mfma_f32_16x16x32_bf16 v[36:39], v[64:67], v[164:167], v[36:39]
    v_alignbit_b32 v62, v103, v102, v5
    v_alignbit_b32 v63, v98, v103, v5
    v_mfma_f32_16x16x32_bf16 v[40:43], v[64:67], v[168:171], v[40:43]
    ds_read_b64 v[100:101], v4 offset:1848
    ds_read_b64 v[102:103], v4 offset:1856
    v_mfma_f32_16x16x32_bf16 v[44:47], v[64:67], v[172:175], v[44:47]
    v_mfma_f32_16x16x32_bf16 v[36:39], v[68:71], v[160:163], v[36:39]
    v_alignbit_b32 v64, v107, v106, v5
    v_alignbit_b32 v65, v108, v107, v5
    v_mfma_f32_16x16x32_bf16 v[40:43], v[68:71], v[164:167], v[40:43]
    v_alignbit_b32 v66, v109, v108, v5
    v_alignbit_b32 v67, v104, v109, v5
    v_mfma_f32_16x16x32_bf16 v[44:47], v[68:71], v[168:171], v[44:47]
    ds_read_b64 v[106:107], v4 offset:2360
    ds_read_b64 v[108:109], v4 offset:2368
    v_mfma_f32_16x16x32_bf16 v[40:43], v[72:75], v[160:163], v[40:43]
    v_alignbit_b32 v68, v113, v112, v5
    v_alignbit_b32 v69, v114, v113, v5
    v_mfma_f32_16x16x32_bf16 v[44:47], v[72:75], v[164:167], v[44:47]
    v_alignbit_b32 v70, v115, v114, v5
    v_alignbit_b32 v71, v110, v115, v5
    v_mfma_f32_16x16x32_bf16 v[44:47], v[76:79], v[160:163], v[44:47]
    ds_read_b64 v[112:113], v4 offset:2872
    ds_read_b64 v[114:115], v4 offset:2880
    v_mfma_f32_16x16x32_bf16 v[16:19], v[48:51], v[128:131], v[16:19]
    v_alignbit_b32 v72, v119, v118, v5
    v_alignbit_b32 v73, v120, v119, v5
    v_mfma_f32_16x16x32_bf16 v[20:23], v[48:51], v[132:135], v[20:23]
    v_alignbit_b32 v74, v121, v120, v5
    v_alignbit_b32 v75, v116, v121, v5
    v_mfma_f32_16x16x32_bf16 v[24:27], v[48:51], v[136:139], v[24:27]
    ds_read_b64 v[118:119], v4 offset:3384
    ds_read_b64 v[120:121], v4 offset:3392
    v_mfma_f32_16x16x32_bf16 v[28:31], v[48:51], v[140:143], v[28:31]
    v_alignbit_b32 v76, v125, v124, v5
    v_alignbit_b32 v77, v126, v125, v5
    v_mfma_f32_16x16x32_bf16 v[32:35], v[48:51], v[144:147], v[32:35]
    v_alignbit_b32 v78, v127, v126, v5
    v_alignbit_b32 v79, v122, v127, v5
    v_mfma_f32_16x16x32_bf16 v[36:39], v[48:51], v[148:151], v[36:39]
    ds_read_b64 v[124:125], v4 offset:3896
    ds_read_b64 v[126:127], v4 offset:3904
    v_mfma_f32_16x16x32_bf16 v[40:43], v[48:51], v[152:155], v[40:43]
    ds_read_b128 v[160:163], v6 offset:12688
    ds_read_b128 v[164:167], v6 offset:12432
    v_mfma_f32_16x16x32_bf16 v[44:47], v[48:51], v[156:159], v[44:47]
    ds_read_b128 v[168:171], v6 offset:12176
    ds_read_b128 v[172:175], v6 offset:11920
    v_mfma_f32_16x16x32_bf16 v[20:23], v[52:55], v[128:131], v[20:23]
    ds_read_b128 v[176:179], v6 offset:11664
    ds_read_b128 v[180:183], v6 offset:11408
    v_mfma_f32_16x16x32_bf16 v[24:27], v[52:55], v[132:135], v[24:27]
    ds_read_b128 v[184:187], v6 offset:11152
    ds_read_b128 v[188:191], v6 offset:10896
    v_mfma_f32_16x16x32_bf16 v[28:31], v[52:55], v[136:139], v[28:31]
    v_alignbit_b32 v48, v81, v80, v5
    v_alignbit_b32 v49, v82, v81, v5
    v_mfma_f32_16x16x32_bf16 v[32:35], v[52:55], v[140:143], v[32:35]
    v_alignbit_b32 v50, v83, v82, v5
    v_alignbit_b32 v51, v84, v83, v5
    v_mfma_f32_16x16x32_bf16 v[36:39], v[52:55], v[144:147], v[36:39]
    v_mfma_f32_16x16x32_bf16 v[40:43], v[52:55], v[148:151], v[40:43]
    v_mfma_f32_16x16x32_bf16 v[44:47], v[52:55], v[152:155], v[44:47]
    v_mfma_f32_16x16x32_bf16 v[24:27], v[56:59], v[128:131], v[24:27]
    v_alignbit_b32 v52, v87, v86, v5
    s_waitcnt lgkmcnt(6)
    v_alignbit_b32 v53, v88, v87, v5
    v_mfma_f32_16x16x32_bf16 v[28:31], v[56:59], v[132:135], v[28:31]
    v_alignbit_b32 v54, v89, v88, v5
    v_alignbit_b32 v55, v90, v89, v5
    v_mfma_f32_16x16x32_bf16 v[32:35], v[56:59], v[136:139], v[32:35]
    v_mfma_f32_16x16x32_bf16 v[36:39], v[56:59], v[140:143], v[36:39]
    v_mfma_f32_16x16x32_bf16 v[40:43], v[56:59], v[144:147], v[40:43]
    v_mfma_f32_16x16x32_bf16 v[44:47], v[56:59], v[148:151], v[44:47]
    v_mfma_f32_16x16x32_bf16 v[28:31], v[60:63], v[128:131], v[28:31]
    v_alignbit_b32 v56, v93, v92, v5
    v_alignbit_b32 v57, v94, v93, v5
    v_mfma_f32_16x16x32_bf16 v[32:35], v[60:63], v[132:135], v[32:35]
    v_alignbit_b32 v58, v95, v94, v5
    v_alignbit_b32 v59, v96, v95, v5
    v_mfma_f32_16x16x32_bf16 v[36:39], v[60:63], v[136:139], v[36:39]
    v_mfma_f32_16x16x32_bf16 v[40:43], v[60:63], v[140:143], v[40:43]
    v_mfma_f32_16x16x32_bf16 v[44:47], v[60:63], v[144:147], v[44:47]
    v_mfma_f32_16x16x32_bf16 v[32:35], v[64:67], v[128:131], v[32:35]
    v_alignbit_b32 v60, v99, v98, v5
    v_alignbit_b32 v61, v100, v99, v5
    v_mfma_f32_16x16x32_bf16 v[36:39], v[64:67], v[132:135], v[36:39]
    v_alignbit_b32 v62, v101, v100, v5
    v_alignbit_b32 v63, v102, v101, v5
    v_mfma_f32_16x16x32_bf16 v[40:43], v[64:67], v[136:139], v[40:43]
    v_mfma_f32_16x16x32_bf16 v[44:47], v[64:67], v[140:143], v[44:47]
    v_mfma_f32_16x16x32_bf16 v[36:39], v[68:71], v[128:131], v[36:39]
    v_alignbit_b32 v64, v105, v104, v5
    v_alignbit_b32 v65, v106, v105, v5
    v_mfma_f32_16x16x32_bf16 v[40:43], v[68:71], v[132:135], v[40:43]
    v_alignbit_b32 v66, v107, v106, v5
    v_alignbit_b32 v67, v108, v107, v5
    v_mfma_f32_16x16x32_bf16 v[44:47], v[68:71], v[136:139], v[44:47]
    v_mfma_f32_16x16x32_bf16 v[40:43], v[72:75], v[128:131], v[40:43]
    v_alignbit_b32 v68, v111, v110, v5
    v_alignbit_b32 v69, v112, v111, v5
    v_mfma_f32_16x16x32_bf16 v[44:47], v[72:75], v[132:135], v[44:47]
    v_alignbit_b32 v70, v113, v112, v5
    v_alignbit_b32 v71, v114, v113, v5
    v_mfma_f32_16x16x32_bf16 v[44:47], v[76:79], v[128:131], v[44:47]
    v_alignbit_b32 v72, v117, v116, v5
    v_alignbit_b32 v73, v118, v117, v5
    s_setprio 3
    v_mfma_f32_16x16x32_bf16 v[16:19], v[48:51], v[160:163], v[16:19]
    v_alignbit_b32 v74, v119, v118, v5
    v_alignbit_b32 v75, v120, v119, v5
    v_mfma_f32_16x16x32_bf16 v[20:23], v[48:51], v[164:167], v[20:23]
    v_alignbit_b32 v76, v123, v122, v5
    v_alignbit_b32 v77, v124, v123, v5
    s_waitcnt lgkmcnt(0)
    v_mfma_f32_16x16x32_bf16 v[24:27], v[48:51], v[168:171], v[24:27]
    v_alignbit_b32 v78, v125, v124, v5
    v_alignbit_b32 v79, v126, v125, v5
    v_mfma_f32_16x16x32_bf16 v[28:31], v[48:51], v[172:175], v[28:31]
    v_mfma_f32_16x16x32_bf16 v[32:35], v[48:51], v[176:179], v[32:35]
    v_mfma_f32_16x16x32_bf16 v[36:39], v[48:51], v[180:183], v[36:39]
    v_mfma_f32_16x16x32_bf16 v[40:43], v[48:51], v[184:187], v[40:43]
    v_mfma_f32_16x16x32_bf16 v[44:47], v[48:51], v[188:191], v[44:47]
    v_mfma_f32_16x16x32_bf16 v[20:23], v[52:55], v[160:163], v[20:23]
    v_mfma_f32_16x16x32_bf16 v[24:27], v[52:55], v[164:167], v[24:27]
    v_mfma_f32_16x16x32_bf16 v[28:31], v[52:55], v[168:171], v[28:31]
    v_mfma_f32_16x16x32_bf16 v[32:35], v[52:55], v[172:175], v[32:35]
    v_mfma_f32_16x16x32_bf16 v[36:39], v[52:55], v[176:179], v[36:39]
    v_mfma_f32_16x16x32_bf16 v[40:43], v[52:55], v[180:183], v[40:43]
    v_mfma_f32_16x16x32_bf16 v[44:47], v[52:55], v[184:187], v[44:47]
    v_mfma_f32_16x16x32_bf16 v[24:27], v[56:59], v[160:163], v[24:27]
    v_mfma_f32_16x16x32_bf16 v[28:31], v[56:59], v[164:167], v[28:31]
    v_mfma_f32_16x16x32_bf16 v[32:35], v[56:59], v[168:171], v[32:35]
    v_mfma_f32_16x16x32_bf16 v[36:39], v[56:59], v[172:175], v[36:39]
    v_mfma_f32_16x16x32_bf16 v[40:43], v[56:59], v[176:179], v[40:43]
    v_mfma_f32_16x16x32_bf16 v[44:47], v[56:59], v[180:183], v[44:47]
    v_mfma_f32_16x16x32_bf16 v[28:31], v[60:63], v[160:163], v[28:31]
    v_cvt_pk_bf16_f32 v80, v16, v17
    v_cvt_pk_bf16_f32 v81, v18, v19
    v_mfma_f32_16x16x32_bf16 v[32:35], v[60:63], v[164:167], v[32:35]
    ds_write_b64 v9, v[80:81] offset:0
    v_mfma_f32_16x16x32_bf16 v[36:39], v[60:63], v[168:171], v[36:39]
    v_mfma_f32_16x16x32_bf16 v[40:43], v[60:63], v[172:175], v[40:43]
    v_mfma_f32_16x16x32_bf16 v[44:47], v[60:63], v[176:179], v[44:47]
    v_mfma_f32_16x16x32_bf16 v[32:35], v[64:67], v[160:163], v[32:35]
    v_cvt_pk_bf16_f32 v82, v20, v21
    v_cvt_pk_bf16_f32 v83, v22, v23
    v_mfma_f32_16x16x32_bf16 v[36:39], v[64:67], v[164:167], v[36:39]
    ds_write_b64 v9, v[82:83] offset:512
    ds_read_b128 v[96:99], v10 offset:0
    v_mfma_f32_16x16x32_bf16 v[40:43], v[64:67], v[168:171], v[40:43]
    v_mfma_f32_16x16x32_bf16 v[44:47], v[64:67], v[172:175], v[44:47]
    v_mfma_f32_16x16x32_bf16 v[36:39], v[68:71], v[160:163], v[36:39]
    v_cvt_pk_bf16_f32 v84, v24, v25
    v_cvt_pk_bf16_f32 v85, v26, v27
    v_mfma_f32_16x16x32_bf16 v[40:43], v[68:71], v[164:167], v[40:43]
    ds_write_b64 v9, v[84:85] offset:1024
    v_mfma_f32_16x16x32_bf16 v[44:47], v[68:71], v[168:171], v[44:47]
    v_mfma_f32_16x16x32_bf16 v[40:43], v[72:75], v[160:163], v[40:43]
    v_cvt_pk_bf16_f32 v86, v28, v29
    v_cvt_pk_bf16_f32 v87, v30, v31
    v_mfma_f32_16x16x32_bf16 v[44:47], v[72:75], v[164:167], v[44:47]
    ds_write_b64 v9, v[86:87] offset:1536
    ds_read_b128 v[100:103], v10 offset:1024
    v_mfma_f32_16x16x32_bf16 v[44:47], v[76:79], v[160:163], v[44:47]
    s_waitcnt lgkmcnt(3)
    buffer_store_dwordx4 v[96:99], v2, s[48:51], s55 offen offset:0 sc1
    v_cvt_pk_bf16_f32 v88, v32, v33
    v_cvt_pk_bf16_f32 v89, v34, v35
    ds_write_b64 v9, v[88:89] offset:2048
    v_cvt_pk_bf16_f32 v90, v36, v37
    v_cvt_pk_bf16_f32 v91, v38, v39
    ds_write_b64 v9, v[90:91] offset:2560
    ds_read_b128 v[104:107], v10 offset:2048
    s_waitcnt lgkmcnt(3)
    buffer_store_dwordx4 v[100:103], v2, s[48:51], s55 offen offset:1024 sc1
    v_cvt_pk_bf16_f32 v92, v40, v41
    v_cvt_pk_bf16_f32 v93, v42, v43
    ds_write_b64 v9, v[92:93] offset:3072
    v_cvt_pk_bf16_f32 v94, v44, v45
    v_cvt_pk_bf16_f32 v95, v46, v47
    ds_write_b64 v9, v[94:95] offset:3584
    ds_read_b128 v[108:111], v10 offset:3072
    s_waitcnt lgkmcnt(3)
    buffer_store_dwordx4 v[104:107], v2, s[48:51], s55 offen offset:2048 sc1
    s_waitcnt lgkmcnt(0)
    buffer_store_dwordx4 v[108:111], v2, s[48:51], s55 offen offset:3072 sc1
    v_mov_b32 v13, 81868
    v_mov_b32 v14, 1
    s_add_u32 s68, s26, s63
    s_addc_u32 s69, s27, 0
    s_mov_b32 s78, 1
    s_waitcnt vmcnt(0)
    s_mov_b64 exec, 1
    ds_add_rtn_u32 v12, v13, v14
    s_mov_b64 exec, -1
    s_waitcnt lgkmcnt(0)
    v_readfirstlane_b32 s79, v12
    s_nop 0
    s_cmp_lg_u32 s79, 3
    s_cbranch_scc1 L_SIG_2
    s_mov_b32 s79, 1
    s_atomic_add s79, s[68:69], 32768 glc
    s_waitcnt lgkmcnt(0)
    s_cmp_lg_u32 s79, 15
    s_cbranch_scc1 L_SIG_2
    s_atomic_add s78, s[68:69], 0
    s_waitcnt lgkmcnt(0)
L_SIG_2:
    s_cmp_ge_u32 s56, 10
    s_cbranch_scc1 L_FIN
L_FINR:
    s_setprio 3
    s_and_b32 s61, s2, 0
    s_lshl_b32 s61, s61, 7
    s_mul_i32 s54, s56, 1024
    s_add_u32 s61, s61, s54
    s_add_u32 s61, s61, 8192
    s_mov_b32 s62, 0xffff0000
    v_mov_b32 v12, 0
    buffer_load_dword v15, v12, s[48:51], s61 offen sc1
    v_lshlrev_b32 v48, 16, v192
    v_and_b32 v49, s62, v192
    v_lshlrev_b32 v50, 16, v193
    v_and_b32 v51, s62, v193
    v_lshlrev_b32 v52, 16, v194
    v_and_b32 v53, s62, v194
    v_lshlrev_b32 v54, 16, v195
    v_and_b32 v55, s62, v195
    v_lshlrev_b32 v56, 16, v196
    v_and_b32 v57, s62, v196
    v_lshlrev_b32 v58, 16, v197
    v_and_b32 v59, s62, v197
    v_lshlrev_b32 v60, 16, v198
    v_and_b32 v61, s62, v198
    v_lshlrev_b32 v62, 16, v199
    v_and_b32 v63, s62, v199
    v_lshlrev_b32 v64, 16, v200
    v_and_b32 v65, s62, v200
    v_lshlrev_b32 v66, 16, v201
    v_and_b32 v67, s62, v201
    v_lshlrev_b32 v68, 16, v202
    v_and_b32 v69, s62, v202
    v_lshlrev_b32 v70, 16, v203
    v_and_b32 v71, s62, v203
    v_lshlrev_b32 v72, 16, v204
    v_and_b32 v73, s62, v204
    v_lshlrev_b32 v74, 16, v205
    v_and_b32 v75, s62, v205
    v_lshlrev_b32 v76, 16, v206
    v_and_b32 v77, s62, v206
    v_lshlrev_b32 v78, 16, v207
    v_and_b32 v79, s62, v207
    v_lshlrev_b32 v80, 16, v208
    v_and_b32 v81, s62, v208
    v_lshlrev_b32 v82, 16, v209
    v_and_b32 v83, s62, v209
    v_lshlrev_b32 v84, 16, v210
    v_and_b32 v85, s62, v210
    v_lshlrev_b32 v86, 16, v211
    v_and_b32 v87, s62, v211
    v_lshlrev_b32 v88, 16, v212
    v_and_b32 v89, s62, v212
    v_lshlrev_b32 v90, 16, v213
    v_and_b32 v91, s62, v213
    v_lshlrev_b32 v92, 16, v214
    v_and_b32 v93, s62, v214
    v_lshlrev_b32 v94, 16, v215
    v_and_b32 v95, s62, v215
    v_lshlrev_b32 v96, 16, v216
    v_and_b32 v97, s62, v216
    v_lshlrev_b32 v98, 16, v217
    v_and_b32 v99, s62, v217
    v_lshlrev_b32 v100, 16, v218
    v_and_b32 v101, s62, v218
    v_lshlrev_b32 v102, 16, v219
    v_and_b32 v103, s62, v219
    v_lshlrev_b32 v104, 16, v220
    v_and_b32 v105, s62, v220
    v_lshlrev_b32 v106, 16, v221
    v_and_b32 v107, s62, v221
    v_lshlrev_b32 v108, 16, v222
    v_and_b32 v109, s62, v222
    v_lshlrev_b32 v110, 16, v223
    v_and_b32 v111, s62, v223
    s_waitcnt vmcnt(0)
    v_cmp_gt_u32 vcc, 1, v15
    s_mov_b32 s78, 0
    s_nop 0
    s_cbranch_vccz L_OK_fin
L_POLL_fin:
    s_sleep 2
    buffer_load_dword v15, v12, s[48:51], s61 offen sc1
    s_add_u32 s78, s78, 1
    s_waitcnt vmcnt(0)
    v_cmp_gt_u32 vcc, 1, v15
    s_cmp_ge_u32 s78, 0x20000
    s_cbranch_scc1 L_OK_fin
    s_cbranch_vccnz L_POLL_fin
L_OK_fin:
    s_add_u32 s54, s64, 0
    buffer_load_dwordx4 v[16:19], v241, s[48:51], s54 offen sc1
    s_add_u32 s54, s64, 33792
    buffer_load_dwordx4 v[20:23], v241, s[48:51], s54 offen sc1
    s_add_u32 s54, s64, 67584
    buffer_load_dwordx4 v[24:27], v241, s[48:51], s54 offen sc1
    s_add_u32 s54, s64, 101376
    buffer_load_dwordx4 v[28:31], v241, s[48:51], s54 offen sc1
    s_add_u32 s54, s64, 135168
    buffer_load_dwordx4 v[32:35], v241, s[48:51], s54 offen sc1
    s_add_u32 s54, s64, 168960
    buffer_load_dwordx4 v[36:39], v241, s[48:51], s54 offen sc1
    s_add_u32 s54, s64, 202752
    buffer_load_dwordx4 v[40:43], v241, s[48:51], s54 offen sc1
    s_add_u32 s54, s64, 236544
    buffer_load_dwordx4 v[44:47], v241, s[48:51], s54 offen sc1
    s_waitcnt vmcnt(7)
    ds_write_b128 v10, v[16:19] offset:0
    s_waitcnt vmcnt(6)
    ds_write_b128 v10, v[20:23] offset:1040
    s_waitcnt vmcnt(5)
    ds_write_b128 v10, v[24:27] offset:2080
    s_waitcnt vmcnt(4)
    ds_write_b128 v10, v[28:31] offset:3120
    s_waitcnt vmcnt(3)
    ds_write_b128 v10, v[32:35] offset:4160
    s_waitcnt vmcnt(2)
    ds_write_b128 v10, v[36:39] offset:5200
    s_waitcnt vmcnt(1)
    ds_write_b128 v10, v[40:43] offset:6240
    s_waitcnt vmcnt(0)
    ds_write_b128 v10, v[44:47] offset:7280
    ds_read_b128 v[112:115], v242 offset:0
    ds_read_b128 v[116:119], v242 offset:128
    ds_read_b128 v[120:123], v242 offset:256
    ds_read_b128 v[124:127], v242 offset:384
    ds_read_b128 v[128:131], v242 offset:512
    ds_read_b128 v[132:135], v242 offset:640
    ds_read_b128 v[136:139], v242 offset:768
    ds_read_b128 v[140:143], v242 offset:896
    s_mov_b32 s54, 0
    s_waitcnt lgkmcnt(7)
    v_lshlrev_b32 v144, 16, v112
    s_waitcnt lgkmcnt(6)
    v_lshlrev_b32 v145, 16, v116
    s_waitcnt lgkmcnt(5)
    v_lshlrev_b32 v146, 16, v120
    s_waitcnt lgkmcnt(4)
    v_lshlrev_b32 v147, 16, v124
    s_waitcnt lgkmcnt(3)
    v_lshlrev_b32 v148, 16, v128
    s_waitcnt lgkmcnt(2)
    v_lshlrev_b32 v149, 16, v132
    s_waitcnt lgkmcnt(1)
    v_lshlrev_b32 v150, 16, v136
    s_waitcnt lgkmcnt(0)
    v_lshlrev_b32 v151, 16, v140
    v_mul_f32 v144, v144, v48
    v_mul_f32 v145, v145, v49
    v_mul_f32 v146, v146, v50
    v_mul_f32 v147, v147, v51
    v_mul_f32 v148, v148, v52
    v_mul_f32 v149, v149, v53
    v_mul_f32 v150, v150, v54
    v_mul_f32 v151, v151, v55
    v_cvt_pk_bf16_f32 v160, v144, v145
    v_cvt_pk_bf16_f32 v161, v146, v147
    v_cvt_pk_bf16_f32 v162, v148, v149
    v_cvt_pk_bf16_f32 v163, v150, v151
    buffer_store_dwordx4 v[160:163], v240, s[32:35], s54 offen sc1
    s_add_u32 s54, s54, 2560
    v_and_b32 v152, s62, v112
    v_and_b32 v153, s62, v116
    v_and_b32 v154, s62, v120
    v_and_b32 v155, s62, v124
    v_and_b32 v156, s62, v128
    v_and_b32 v157, s62, v132
    v_and_b32 v158, s62, v136
    v_and_b32 v159, s62, v140
    v_mul_f32 v152, v152, v56
    v_mul_f32 v153, v153, v57
    v_mul_f32 v154, v154, v58
    v_mul_f32 v155, v155, v59
    v_mul_f32 v156, v156, v60
    v_mul_f32 v157, v157, v61
    v_mul_f32 v158, v158, v62
    v_mul_f32 v159, v159, v63
    v_cvt_pk_bf16_f32 v164, v152, v153
    v_cvt_pk_bf16_f32 v165, v154, v155
    v_cvt_pk_bf16_f32 v166, v156, v157
    v_cvt_pk_bf16_f32 v167, v158, v159
    buffer_store_dwordx4 v[164:167], v240, s[32:35], s54 offen sc1
    s_add_u32 s54, s54, 2560
    v_lshlrev_b32 v144, 16, v113
    v_lshlrev_b32 v145, 16, v117
    v_lshlrev_b32 v146, 16, v121
    v_lshlrev_b32 v147, 16, v125
    v_lshlrev_b32 v148, 16, v129
    v_lshlrev_b32 v149, 16, v133
    v_lshlrev_b32 v150, 16, v137
    v_lshlrev_b32 v151, 16, v141
    v_mul_f32 v144, v144, v64
    v_mul_f32 v145, v145, v65
    v_mul_f32 v146, v146, v66
    v_mul_f32 v147, v147, v67
    v_mul_f32 v148, v148, v68
    v_mul_f32 v149, v149, v69
    v_mul_f32 v150, v150, v70
    v_mul_f32 v151, v151, v71
    v_cvt_pk_bf16_f32 v168, v144, v145
    v_cvt_pk_bf16_f32 v169, v146, v147
    v_cvt_pk_bf16_f32 v170, v148, v149
    v_cvt_pk_bf16_f32 v171, v150, v151
    buffer_store_dwordx4 v[168:171], v240, s[32:35], s54 offen sc1
    s_add_u32 s54, s54, 2560
    v_and_b32 v152, s62, v113
    v_and_b32 v153, s62, v117
    v_and_b32 v154, s62, v121
    v_and_b32 v155, s62, v125
    v_and_b32 v156, s62, v129
    v_and_b32 v157, s62, v133
    v_and_b32 v158, s62, v137
    v_and_b32 v159, s62, v141
    v_mul_f32 v152, v152, v72
    v_mul_f32 v153, v153, v73
    v_mul_f32 v154, v154, v74
    v_mul_f32 v155, v155, v75
    v_mul_f32 v156, v156, v76
    v_mul_f32 v157, v157, v77
    v_mul_f32 v158, v158, v78
    v_mul_f32 v159, v159, v79
    v_cvt_pk_bf16_f32 v172, v152, v153
    v_cvt_pk_bf16_f32 v173, v154, v155
    v_cvt_pk_bf16_f32 v174, v156, v157
    v_cvt_pk_bf16_f32 v175, v158, v159
    buffer_store_dwordx4 v[172:175], v240, s[32:35], s54 offen sc1
    s_add_u32 s54, s54, 2560
    v_lshlrev_b32 v144, 16, v114
    v_lshlrev_b32 v145, 16, v118
    v_lshlrev_b32 v146, 16, v122
    v_lshlrev_b32 v147, 16, v126
    v_lshlrev_b32 v148, 16, v130
    v_lshlrev_b32 v149, 16, v134
    v_lshlrev_b32 v150, 16, v138
    v_lshlrev_b32 v151, 16, v142
    v_mul_f32 v144, v144, v80
    v_mul_f32 v145, v145, v81
    v_mul_f32 v146, v146, v82
    v_mul_f32 v147, v147, v83
    v_mul_f32 v148, v148, v84
    v_mul_f32 v149, v149, v85
    v_mul_f32 v150, v150, v86
    v_mul_f32 v151, v151, v87
    v_cvt_pk_bf16_f32 v176, v144, v145
    v_cvt_pk_bf16_f32 v177, v146, v147
    v_cvt_pk_bf16_f32 v178, v148, v149
    v_cvt_pk_bf16_f32 v179, v150, v151
    buffer_store_dwordx4 v[176:179], v240, s[32:35], s54 offen sc1
    s_add_u32 s54, s54, 2560
    v_and_b32 v152, s62, v114
    v_and_b32 v153, s62, v118
    v_and_b32 v154, s62, v122
    v_and_b32 v155, s62, v126
    v_and_b32 v156, s62, v130
    v_and_b32 v157, s62, v134
    v_and_b32 v158, s62, v138
    v_and_b32 v159, s62, v142
    v_mul_f32 v152, v152, v88
    v_mul_f32 v153, v153, v89
    v_mul_f32 v154, v154, v90
    v_mul_f32 v155, v155, v91
    v_mul_f32 v156, v156, v92
    v_mul_f32 v157, v157, v93
    v_mul_f32 v158, v158, v94
    v_mul_f32 v159, v159, v95
    v_cvt_pk_bf16_f32 v180, v152, v153
    v_cvt_pk_bf16_f32 v181, v154, v155
    v_cvt_pk_bf16_f32 v182, v156, v157
    v_cvt_pk_bf16_f32 v183, v158, v159
    buffer_store_dwordx4 v[180:183], v240, s[32:35], s54 offen sc1
    s_add_u32 s54, s54, 2560
    v_lshlrev_b32 v144, 16, v115
    v_lshlrev_b32 v145, 16, v119
    v_lshlrev_b32 v146, 16, v123
    v_lshlrev_b32 v147, 16, v127
    v_lshlrev_b32 v148, 16, v131
    v_lshlrev_b32 v149, 16, v135
    v_lshlrev_b32 v150, 16, v139
    v_lshlrev_b32 v151, 16, v143
    v_mul_f32 v144, v144, v96
    v_mul_f32 v145, v145, v97
    v_mul_f32 v146, v146, v98
    v_mul_f32 v147, v147, v99
    v_mul_f32 v148, v148, v100
    v_mul_f32 v149, v149, v101
    v_mul_f32 v150, v150, v102
    v_mul_f32 v151, v151, v103
    v_cvt_pk_bf16_f32 v184, v144, v145
    v_cvt_pk_bf16_f32 v185, v146, v147
    v_cvt_pk_bf16_f32 v186, v148, v149
    v_cvt_pk_bf16_f32 v187, v150, v151
    buffer_store_dwordx4 v[184:187], v240, s[32:35], s54 offen sc1
    s_add_u32 s54, s54, 2560
    v_and_b32 v152, s62, v115
    v_and_b32 v153, s62, v119
    v_and_b32 v154, s62, v123
    v_and_b32 v155, s62, v127
    v_and_b32 v156, s62, v131
    v_and_b32 v157, s62, v135
    v_and_b32 v158, s62, v139
    v_and_b32 v159, s62, v143
    v_mul_f32 v152, v152, v104
    v_mul_f32 v153, v153, v105
    v_mul_f32 v154, v154, v106
    v_mul_f32 v155, v155, v107
    v_mul_f32 v156, v156, v108
    v_mul_f32 v157, v157, v109
    v_mul_f32 v158, v158, v110
    v_mul_f32 v159, v159, v111
    v_cvt_pk_bf16_f32 v188, v152, v153
    v_cvt_pk_bf16_f32 v189, v154, v155
    v_cvt_pk_bf16_f32 v190, v156, v157
    v_cvt_pk_bf16_f32 v191, v158, v159
    buffer_store_dwordx4 v[188:191], v240, s[32:35], s54 offen sc1
    s_branch L_FIN
L_B2:
    s_lshr_b32 s53, s2, 3
    s_sub_u32 s54, s53, 5
    s_cmp_lt_u32 s53, 16
    s_cselect_b32 s53, s53, s54
    s_and_b32 s56, s2, 7
    s_mul_i32 s56, s56, 27
    s_add_u32 s56, s56, s53
    s_cmp_ge_u32 s56, 215
    s_cbranch_scc1 L_FIN
    s_mul_i32 s57, s56, 205
    s_lshr_b32 s57, s57, 10
    s_mul_i32 s54, s57, 5
    s_sub_u32 s58, s56, s54
    s_mov_b32 s28, s20
    s_and_b32 s29, s21, 0xffff
    s_mov_b32 s30, 819200
    s_mov_b32 s31, 0x20000
    s_lshl_b32 s59, s58, 8
    s_mul_i32 s53, s3, 204800
    s_add_u32 s59, s59, s53
    s_lshl_b32 s53, s3, 6
    s_mul_i32 s65, s3, 20480
    s_add_u32 s65, s65, s75
    v_and_b32 v240, 15, v1
    v_lshrrev_b32 v241, 4, v1
    v_lshlrev_b32 v240, 4, v240
    v_xor_b32 v240, s53, v240
    v_mul_u32_u24 v241, 10240, v241
    v_add3_u32 v2, v240, v241, s59
    v_mov_b32 v13, s75
    v_add_u32 v13, 81856, v13
L_BW_4:
    ds_read_b32 v14, v13
    s_waitcnt lgkmcnt(0)
    v_cmp_gt_u32 vcc, s76, v14
    s_nop 1
    s_cbranch_vccnz L_BW_4
    s_add_u32 m0, s65, 0
    s_mov_b32 s63, 0
    buffer_load_dwordx4 v2, s[28:31], s63 offen lds
    s_add_u32 m0, s65, 1056
    s_mov_b32 s63, 1280
    buffer_load_dwordx4 v2, s[28:31], s63 offen lds
    s_add_u32 m0, s65, 2112
    s_mov_b32 s63, 2560
    buffer_load_dwordx4 v2, s[28:31], s63 offen lds
    s_add_u32 m0, s65, 3168
    s_mov_b32 s63, 3840
    buffer_load_dwordx4 v2, s[28:31], s63 offen lds
    s_add_u32 m0, s65, 4224
    s_mov_b32 s63, 5120
    buffer_load_dwordx4 v2, s[28:31], s63 offen lds
    s_add_u32 m0, s65, 5280
    s_mov_b32 s63, 6400
    buffer_load_dwordx4 v2, s[28:31], s63 offen lds
    s_add_u32 m0, s65, 6336
    s_mov_b32 s63, 7680
    buffer_load_dwordx4 v2, s[28:31], s63 offen lds
    s_add_u32 m0, s65, 7392
    s_mov_b32 s63, 8960
    buffer_load_dwordx4 v2, s[28:31], s63 offen lds
    s_cmp_eq_u32 s72, 0
    s_cbranch_scc1 L_LB_b2
    s_waitcnt vmcnt(8)
    s_barrier
    s_setprio 0
L_LB_b2:
    s_add_u32 m0, s65, 8416
    s_mov_b32 s63, 40960
    buffer_load_dwordx4 v2, s[28:31], s63 offen lds
    s_add_u32 m0, s65, 9472
    s_mov_b32 s63, 42240
    buffer_load_dwordx4 v2, s[28:31], s63 offen lds
    s_add_u32 m0, s65, 10528
    s_mov_b32 s63, 43520
    buffer_load_dwordx4 v2, s[28:31], s63 offen lds
    s_add_u32 m0, s65, 11584
    s_mov_b32 s63, 44800
    buffer_load_dwordx4 v2, s[28:31], s63 offen lds
    s_add_u32 m0, s65, 12640
    s_mov_b32 s63, 46080
    buffer_load_dwordx4 v2, s[28:31], s63 offen lds
    s_add_u32 m0, s65, 13696
    s_mov_b32 s63, 47360
    buffer_load_dwordx4 v2, s[28:31], s63 offen lds
    s_add_u32 m0, s65, 14752
    s_mov_b32 s63, 48640
    buffer_load_dwordx4 v2, s[28:31], s63 offen lds
    s_add_u32 m0, s65, 15808
    s_mov_b32 s63, 49920
    buffer_load_dwordx4 v2, s[28:31], s63 offen lds
L_B2Q:
    v_and_b32 v8, 15, v1
    v_lshrrev_b32 v9, 4, v1
    s_setprio 2
    s_mov_b32 s32, s22
    s_and_b32 s33, s23, 0xffff
    s_mov_b32 s34, 5242880
    s_mov_b32 s35, 0x20000
    v_bfe_u32 v10, v1, 2, 3
    v_mul_u32_u24 v10, 1056, v10
    v_lshrrev_b32 v11, 5, v1
    v_lshl_add_u32 v10, v11, 8, v10
    v_and_b32 v11, 3, v1
    v_lshl_add_u32 v10, v11, 3, v10
    v_add_u32 v0, s65, v10
    s_add_u32 s64, s65, 16832
    v_lshlrev_b32 v9, 3, v9
    v_mul_u32_u24 v3, 40, v8
    v_add3_u32 v3, v3, v9, s64
    v_mul_u32_u24 v4, 800, v11
    v_add3_u32 v4, v4, v9, s64
    v_lshlrev_b32 v5, 4, v1
    v_lshlrev_b32 v6, 3, v1
    v_add_u32 v6, s64, v6
    v_add_u32 v7, 4096, v5
    s_mul_i32 s52, s57, 3
    s_lshr_b32 s53, s52, 3
    s_add_u32 s54, s52, 2
    s_min_u32 s54, s54, 127
    s_lshr_b32 s54, s54, 3
    s_sub_u32 s54, s54, s53
    s_lshl_b32 s54, s54, 7
    v_and_b32 v12, 1, v1
    v_mul_u32_u24 v13, 128, v12
    v_mul_u32_u24 v12, s54, v12
    s_mul_i32 s60, s3, 17
    s_add_u32 s60, s60, s53
    s_lshl_b32 s60, s60, 7
    s_add_u32 s60, s60, 20480
    s_and_b32 s61, s2, 7
    s_lshl_b32 s61, s61, 10
    s_mul_i32 s53, s3, 256
    s_add_u32 s61, s61, s53
    s_mul_i32 s52, s52, 20480
    s_mul_i32 s53, s3, 5120
    s_add_u32 s52, s52, s53
    s_add_u32 s52, s52, 7340032
    s_mul_i32 s62, s3, 13440
    s_add_u32 s62, s62, 53248
    s_mov_b32 s73, 897988541
    s_mov_b32 s66, 0xffff0000
    s_mov_b32 s67, -1
    s_mov_b32 s68, 0
    s_mov_b32 s69, -1
    s_mov_b32 s70, 0
    s_mov_b32 s71, 0xffff0000
    v_mov_b32 v108, 0
    v_mov_b32 v109, 0
    v_mov_b32 v110, 0
    v_mov_b32 v111, 0
    v_mov_b32 v112, 0
    v_mov_b32 v113, 0
    v_mov_b32 v114, 0
    v_mov_b32 v115, 0
    v_mov_b32 v116, 0
    v_mov_b32 v117, 0
    v_mov_b32 v118, 0
    v_mov_b32 v119, 0
    v_mov_b32 v120, 0
    v_mov_b32 v121, 0
    v_mov_b32 v122, 0
    v_mov_b32 v123, 0
    v_mov_b32 v124, 0
    v_mov_b32 v125, 0
    v_mov_b32 v126, 0
    v_mov_b32 v127, 0
    v_mov_b32 v128, 0
    v_mov_b32 v129, 0
    v_mov_b32 v130, 0
    v_mov_b32 v131, 0
    v_mov_b32 v132, 0
    v_mov_b32 v133, 0
    v_mov_b32 v134, 0
    v_mov_b32 v135, 0
    v_mov_b32 v136, 0
    v_mov_b32 v137, 0
    v_mov_b32 v138, 0
    v_mov_b32 v139, 0
    v_mov_b32 v140, 0
    v_mov_b32 v141, 0
    v_mov_b32 v142, 0
    v_mov_b32 v143, 0
    v_mov_b32 v144, 0
    v_mov_b32 v145, 0
    v_mov_b32 v146, 0
    v_mov_b32 v147, 0
    v_mov_b32 v148, 0
    v_mov_b32 v149, 0
    v_mov_b32 v150, 0
    v_mov_b32 v151, 0
    v_mov_b32 v152, 0
    v_mov_b32 v153, 0
    v_mov_b32 v154, 0
    v_mov_b32 v155, 0
    v_mov_b32 v156, 0
    v_mov_b32 v157, 0
    v_mov_b32 v158, 0
    v_mov_b32 v159, 0
    v_mov_b32 v160, 0
    v_mov_b32 v161, 0
    v_mov_b32 v162, 0
    v_mov_b32 v163, 0
    v_mov_b32 v164, 0
    v_mov_b32 v165, 0
    v_mov_b32 v166, 0
    v_mov_b32 v167, 0
    v_mov_b32 v168, 0
    v_mov_b32 v169, 0
    v_mov_b32 v170, 0
    v_mov_b32 v171, 0
    v_mov_b32 v172, 0
    v_mov_b32 v173, 0
    v_mov_b32 v174, 0
    v_mov_b32 v175, 0
    v_mov_b32 v176, 0
    v_mov_b32 v177, 0
    v_mov_b32 v178, 0
    v_mov_b32 v179, 0
    s_mov_b32 s4, 0x11111111
    s_mov_b32 s5, 0x11111111
    s_mov_b32 s10, 0x22221111
    s_mov_b32 s11, 0x22222222
    s_mov_b32 s12, 0x22222222
    s_mov_b32 s13, 0x44444444
    s_mov_b32 s14, 0x44444444
    s_mov_b32 s15, 0x88884444
    s_mov_b32 s16, 0x88888888
    s_mov_b32 s17, 0x88888888
    s_mov_b32 s18, 0xffff
    s_mov_b32 s19, 0x0
    s_mov_b32 s36, 0xf000f
    s_mov_b32 s37, 0xf000f
    s_mov_b32 s38, 0xfff0000f
    s_mov_b32 s39, 0xfff0fff0
    s_mov_b32 s40, 0xfff0fff0
    s_mov_b32 s41, 0x0
    s_mov_b32 s42, 0xff0000
    s_mov_b32 s43, 0xff00ff
    s_mov_b32 s44, 0xff00ff
    s_mov_b32 s45, 0xff00ff00
    s_mov_b32 s46, 0xff00ff00
    s_mov_b32 s47, 0xff00
    s_mov_b32 s20, 0x0
    s_mov_b32 s21, 0xfff0fff
    s_mov_b32 s24, 0xfff0fff
    s_mov_b32 s25, 0xf0000fff
    s_waitcnt vmcnt(8)
    ds_read_b64_tr_b16 v[76:77], v0 offset:0
    ds_read_b64_tr_b16 v[78:79], v0 offset:512
    ds_read_b64_tr_b16 v[80:81], v0 offset:32
    ds_read_b64_tr_b16 v[82:83], v0 offset:544
    ds_read_b64_tr_b16 v[84:85], v0 offset:64
    ds_read_b64_tr_b16 v[86:87], v0 offset:576
    ds_read_b64_tr_b16 v[88:89], v0 offset:96
    ds_read_b64_tr_b16 v[90:91], v0 offset:608
    ds_read_b64_tr_b16 v[92:93], v0 offset:128
    ds_read_b64_tr_b16 v[94:95], v0 offset:640
    ds_read_b64_tr_b16 v[96:97], v0 offset:160
    ds_read_b64_tr_b16 v[98:99], v0 offset:672
    ds_read_b64_tr_b16 v[100:101], v0 offset:192
    ds_read_b64_tr_b16 v[102:103], v0 offset:704
    ds_read_b64_tr_b16 v[104:105], v0 offset:224
    ds_read_b64_tr_b16 v[106:107], v0 offset:736
    s_waitcnt vmcnt(0)
    ds_read_b64_tr_b16 v[228:229], v0 offset:8416
    ds_read_b64_tr_b16 v[230:231], v0 offset:8928
    ds_read_b64_tr_b16 v[232:233], v0 offset:8448
    ds_read_b64_tr_b16 v[234:235], v0 offset:8960
    ds_read_b64_tr_b16 v[236:237], v0 offset:8480
    ds_read_b64_tr_b16 v[238:239], v0 offset:8992
    ds_read_b64_tr_b16 v[240:241], v0 offset:8512
    ds_read_b64_tr_b16 v[242:243], v0 offset:9024
    ds_read_b64_tr_b16 v[244:245], v0 offset:8544
    ds_read_b64_tr_b16 v[246:247], v0 offset:9056
    ds_read_b64_tr_b16 v[248:249], v0 offset:8576
    ds_read_b64_tr_b16 v[250:251], v0 offset:9088
    ds_read_b64_tr_b16 v[252:253], v0 offset:8608
    ds_read_b64_tr_b16 v[254:255], v0 offset:9120
    ds_read_b64_tr_b16 v[8:9], v0 offset:8640
    ds_read_b64_tr_b16 v[10:11], v0 offset:9152
    s_waitcnt lgkmcnt(0)
    s_mov_b32 s79, 1
    s_mov_b32 s8, 0
    s_sub_u32 s54, 163784, s75
    v_mov_b32 v15, s54
    s_cmp_ge_u32 s2, 192
    s_cbranch_scc1 L_GTW
    s_cmp_eq_u32 s72, 0
    s_cbranch_scc1 L_GT
    s_branch L_GTW
L_GQ:
    buffer_load_dword v14, v12, s[48:51], s60 offen sc1
    s_waitcnt vmcnt(0)
    ds_read_b32 v16, v15
    v_cmp_gt_u32 vcc, 1, v14
    s_nop 1
    s_cbranch_vccz L_GQ1
    s_waitcnt lgkmcnt(0)
    v_cmp_gt_u32 vcc, 4, v16
    s_nop 1
    s_cbranch_vccz L_GO
    s_sleep 1
    s_branch L_GQ
L_GQ1:
    s_waitcnt lgkmcnt(0)
    s_mov_b32 s8, 1
    buffer_load_dwordx4 v[16:19], v5, s[48:51], s52 offen offset:0 sc1
    buffer_load_dwordx4 v[20:23], v5, s[48:51], s52 offen offset:1024 sc1
    buffer_load_dwordx4 v[24:27], v5, s[48:51], s52 offen offset:2048 sc1
    buffer_load_dwordx4 v[28:31], v5, s[48:51], s52 offen offset:3072 sc1
    buffer_load_dwordx4 v[32:35], v7, s[48:51], s52 offen offset:0 sc1
    s_add_u32 s52, s52, 20480
    buffer_load_dwordx4 v[36:39], v5, s[48:51], s52 offen offset:0 sc1
    buffer_load_dwordx4 v[40:43], v5, s[48:51], s52 offen offset:1024 sc1
    buffer_load_dwordx4 v[44:47], v5, s[48:51], s52 offen offset:2048 sc1
    buffer_load_dwordx4 v[48:51], v5, s[48:51], s52 offen offset:3072 sc1
    buffer_load_dwordx4 v[52:55], v7, s[48:51], s52 offen offset:0 sc1
    s_cmp_eq_u32 s57, 42
    s_cselect_b32 s53, 0, 20480
    s_add_u32 s52, s52, s53
    buffer_load_dwordx4 v[56:59], v5, s[48:51], s52 offen offset:0 sc1
    buffer_load_dwordx4 v[60:63], v5, s[48:51], s52 offen offset:1024 sc1
    buffer_load_dwordx4 v[64:67], v5, s[48:51], s52 offen offset:2048 sc1
    buffer_load_dwordx4 v[68:71], v5, s[48:51], s52 offen offset:3072 sc1
    buffer_load_dwordx4 v[72:75], v7, s[48:51], s52 offen offset:0 sc1
L_GTW:
    ds_read_b32 v14, v15
    s_waitcnt lgkmcnt(0)
    v_cmp_gt_u32 vcc, 4, v14
    s_nop 1
    s_cbranch_vccz L_GO
    s_sleep 1
    s_branch L_GTW
L_GO:
L_GT:
    s_add_u32 m0, s65, 0
    s_mov_b32 s63, 81920
    buffer_load_dwordx4 v2, s[28:31], s63 offen lds
    s_add_u32 m0, s65, 1056
    s_mov_b32 s63, 83200
    buffer_load_dwordx4 v2, s[28:31], s63 offen lds
    s_add_u32 m0, s65, 2112
    s_mov_b32 s63, 84480
    buffer_load_dwordx4 v2, s[28:31], s63 offen lds
    s_add_u32 m0, s65, 3168
    s_mov_b32 s63, 85760
    buffer_load_dwordx4 v2, s[28:31], s63 offen lds
    s_add_u32 m0, s65, 4224
    s_mov_b32 s63, 87040
    buffer_load_dwordx4 v2, s[28:31], s63 offen lds
    s_add_u32 m0, s65, 5280
    s_mov_b32 s63, 88320
    buffer_load_dwordx4 v2, s[28:31], s63 offen lds
    s_add_u32 m0, s65, 6336
    s_mov_b32 s63, 89600
    buffer_load_dwordx4 v2, s[28:31], s63 offen lds
    s_add_u32 m0, s65, 7392
    s_mov_b32 s63, 90880
    buffer_load_dwordx4 v2, s[28:31], s63 offen lds
    s_add_u32 m0, s65, 8416
    s_mov_b32 s63, 122880
    buffer_load_dwordx4 v2, s[28:31], s63 offen lds
    s_add_u32 m0, s65, 9472
    s_mov_b32 s63, 124160
    buffer_load_dwordx4 v2, s[28:31], s63 offen lds
L_GT2:
    s_add_u32 m0, s65, 10528
    s_mov_b32 s63, 125440
    buffer_load_dwordx4 v2, s[28:31], s63 offen lds
    s_add_u32 m0, s65, 11584
    s_mov_b32 s63, 126720
    buffer_load_dwordx4 v2, s[28:31], s63 offen lds
    s_add_u32 m0, s65, 12640
    s_mov_b32 s63, 128000
    buffer_load_dwordx4 v2, s[28:31], s63 offen lds
    s_add_u32 m0, s65, 13696
    s_mov_b32 s63, 129280
    buffer_load_dwordx4 v2, s[28:31], s63 offen lds
    s_add_u32 m0, s65, 14752
    s_mov_b32 s63, 130560
    buffer_load_dwordx4 v2, s[28:31], s63 offen lds
    s_add_u32 m0, s65, 15808
    s_mov_b32 s63, 131840
    buffer_load_dwordx4 v2, s[28:31], s63 offen lds
    s_sub_u32 s59, 134144, s75
    s_mul_i32 s53, s3, 7360
    s_add_u32 s59, s59, s53
    s_add_u32 s55, s59, 7392
    s_sub_u32 s55, s55, s64
    s_and_b32 s55, s55, 255
    s_add_u32 s55, s55, s64
    s_add_u32 m0, s59, 0
    s_mov_b32 s63, 163840
    buffer_load_dwordx4 v2, s[28:31], s63 offen lds
    s_add_u32 m0, s59, 1056
    s_mov_b32 s63, 165120
    buffer_load_dwordx4 v2, s[28:31], s63 offen lds
    s_add_u32 m0, s59, 2112
    s_mov_b32 s63, 166400
    buffer_load_dwordx4 v2, s[28:31], s63 offen lds
    s_add_u32 m0, s59, 3168
    s_mov_b32 s63, 167680
    buffer_load_dwordx4 v2, s[28:31], s63 offen lds
    s_add_u32 m0, s59, 4224
    s_mov_b32 s63, 168960
    buffer_load_dwordx4 v2, s[28:31], s63 offen lds
    s_add_u32 m0, s59, 5280
    s_mov_b32 s63, 170240
    buffer_load_dwordx4 v2, s[28:31], s63 offen lds
    s_add_u32 m0, s59, 6336
    s_mov_b32 s63, 171520
    buffer_load_dwordx4 v2, s[28:31], s63 offen lds
    s_waitcnt lgkmcnt(0)
    s_cmp_lg_u32 s8, 0
    s_cbranch_scc1 L_PQG
    buffer_load_dword v14, v12, s[48:51], s60 offen sc1
    s_waitcnt vmcnt(0)
    v_cmp_gt_u32 vcc, 1, v14
    s_mov_b32 s78, 0
    s_nop 0
    s_cbranch_vccz L_OK_b2qy
L_POLL_b2qy:
    s_sleep 2
    buffer_load_dword v14, v12, s[48:51], s60 offen sc1
    s_add_u32 s78, s78, 1
    s_waitcnt vmcnt(0)
    v_cmp_gt_u32 vcc, 1, v14
    s_cmp_ge_u32 s78, 0x20000
    s_cbranch_scc1 L_OK_b2qy
    s_cbranch_vccnz L_POLL_b2qy
L_OK_b2qy:
    buffer_load_dwordx4 v[16:19], v5, s[48:51], s52 offen offset:0 sc1
    buffer_load_dwordx4 v[20:23], v5, s[48:51], s52 offen offset:1024 sc1
    buffer_load_dwordx4 v[24:27], v5, s[48:51], s52 offen offset:2048 sc1
    buffer_load_dwordx4 v[28:31], v5, s[48:51], s52 offen offset:3072 sc1
    buffer_load_dwordx4 v[32:35], v7, s[48:51], s52 offen offset:0 sc1
    s_add_u32 s52, s52, 20480
    buffer_load_dwordx4 v[36:39], v5, s[48:51], s52 offen offset:0 sc1
    buffer_load_dwordx4 v[40:43], v5, s[48:51], s52 offen offset:1024 sc1
    buffer_load_dwordx4 v[44:47], v5, s[48:51], s52 offen offset:2048 sc1
    buffer_load_dwordx4 v[48:51], v5, s[48:51], s52 offen offset:3072 sc1
    buffer_load_dwordx4 v[52:55], v7, s[48:51], s52 offen offset:0 sc1
    s_cmp_eq_u32 s57, 42
    s_cselect_b32 s53, 0, 20480
    s_add_u32 s52, s52, s53
    buffer_load_dwordx4 v[56:59], v5, s[48:51], s52 offen offset:0 sc1
    buffer_load_dwordx4 v[60:63], v5, s[48:51], s52 offen offset:1024 sc1
    buffer_load_dwordx4 v[64:67], v5, s[48:51], s52 offen offset:2048 sc1
    buffer_load_dwordx4 v[68:71], v5, s[48:51], s52 offen offset:3072 sc1
    buffer_load_dwordx4 v[72:75], v7, s[48:51], s52 offen offset:0 sc1
L_PQG:
    buffer_load_dword v14, v13, s[48:51], s61 offen sc1
    s_waitcnt vmcnt(0)
    v_cmp_gt_u32 vcc, 1, v14
    s_mov_b32 s78, 0
    s_nop 0
    s_cbranch_vccz L_OK_b2kv
L_POLL_b2kv:
    s_sleep 2
    buffer_load_dword v14, v13, s[48:51], s61 offen sc1
    s_add_u32 s78, s78, 1
    s_waitcnt vmcnt(0)
    v_cmp_gt_u32 vcc, 1, v14
    s_cmp_ge_u32 s78, 0x20000
    s_cbranch_scc1 L_OK_b2kv
    s_cbranch_vccnz L_POLL_b2kv
L_OK_b2kv:
    buffer_load_dwordx4 v[180:183], v5, s[48:51], s62 offen offset:0 sc1
    buffer_load_dwordx4 v[184:187], v5, s[48:51], s62 offen offset:1024 sc1
    buffer_load_dwordx4 v[188:191], v5, s[48:51], s62 offen offset:2048 sc1
    buffer_load_dwordx4 v[192:195], v5, s[48:51], s62 offen offset:3072 sc1
    buffer_load_dwordx4 v[196:199], v7, s[48:51], s62 offen offset:0 sc1
    buffer_load_dwordx4 v[200:203], v7, s[48:51], s62 offen offset:1024 sc1
    buffer_load_dwordx4 v[204:207], v7, s[48:51], s62 offen offset:2048 sc1
    s_add_u32 s62, s62, 6720
    buffer_load_dwordx4 v[208:211], v5, s[48:51], s62 offen offset:0 sc1
    buffer_load_dwordx4 v[212:215], v5, s[48:51], s62 offen offset:1024 sc1
    buffer_load_dwordx4 v[216:219], v5, s[48:51], s62 offen offset:2048 sc1
    buffer_load_dwordx4 v[220:223], v5, s[48:51], s62 offen offset:3072 sc1
    buffer_load_dwordx4 v[224:227], v7, s[48:51], s62 offen offset:0 sc1
    buffer_load_dwordx4 v[172:175], v7, s[48:51], s62 offen offset:1024 sc1
    buffer_load_dwordx4 v[176:179], v7, s[48:51], s62 offen offset:2048 sc1
    v_mov_b32 v12, s73
    v_mov_b32 v13, s73
    v_mov_b32 v14, s73
    v_mov_b32 v15, s73
    s_waitcnt vmcnt(13)
    v_cvt_pk_bf16_f32 v180, v180, v181
    v_cvt_pk_bf16_f32 v181, v182, v183
    ds_write_b64 v6, v[180:181] offset:0
    s_waitcnt vmcnt(12)
    v_cvt_pk_bf16_f32 v184, v184, v185
    v_cvt_pk_bf16_f32 v185, v186, v187
    ds_write_b64 v6, v[184:185] offset:512
    s_waitcnt vmcnt(11)
    v_cvt_pk_bf16_f32 v188, v188, v189
    v_cvt_pk_bf16_f32 v189, v190, v191
    ds_write_b64 v6, v[188:189] offset:1024
    s_waitcnt vmcnt(10)
    v_cvt_pk_bf16_f32 v192, v192, v193
    v_cvt_pk_bf16_f32 v193, v194, v195
    ds_write_b64 v6, v[192:193] offset:1536
    s_waitcnt vmcnt(9)
    v_cvt_pk_bf16_f32 v196, v196, v197
    v_cvt_pk_bf16_f32 v197, v198, v199
    ds_write_b64 v6, v[196:197] offset:2048
    s_waitcnt vmcnt(8)
    v_cvt_pk_bf16_f32 v200, v200, v201
    v_cvt_pk_bf16_f32 v201, v202, v203
    ds_write_b64 v6, v[200:201] offset:2560
    s_waitcnt vmcnt(7)
    v_cvt_pk_bf16_f32 v204, v204, v205
    v_cvt_pk_bf16_f32 v205, v206, v207
    ds_write_b64 v6, v[204:205] offset:3072
    s_mov_b64 exec, s[4:5]
    ds_read_b64 v[108:109], v4 offset:800
    s_mov_b64 exec, s[10:11]
    ds_read_b64 v[110:111], v4 offset:832
    s_mov_b64 exec, s[12:13]
    ds_read_b64 v[112:113], v4 offset:864
    s_mov_b64 exec, s[14:15]
    ds_read_b64 v[114:115], v4 offset:896
    s_mov_b64 exec, s[16:17]
    ds_read_b64 v[116:117], v4 offset:928
    s_mov_b64 exec, -1
    ds_read_b64 v[118:119], v3 offset:0
    s_mov_b64 exec, s[18:19]
    ds_read_b64 v[120:121], v3 offset:32
    s_mov_b64 exec, s[36:37]
    ds_read_b64 v[122:123], v3 offset:640
    s_mov_b64 exec, s[38:39]
    ds_read_b64 v[124:125], v3 offset:672
    s_mov_b64 exec, s[40:41]
    ds_read_b64 v[126:127], v3 offset:704
    s_mov_b64 exec, s[42:43]
    ds_read_b64 v[128:129], v3 offset:1312
    s_mov_b64 exec, s[44:45]
    ds_read_b64 v[130:131], v3 offset:1344
    s_mov_b64 exec, s[46:47]
    ds_read_b64 v[132:133], v3 offset:1376
    s_mov_b64 exec, s[20:21]
    ds_read_b64 v[134:135], v3 offset:1984
    s_mov_b64 exec, s[24:25]
    ds_read_b64 v[136:137], v3 offset:2016
    s_mov_b32 exec_lo, 0xf000f000
    s_mov_b32 exec_hi, 0xf000f000
    ds_read_b64 v[138:139], v3 offset:2048
    s_mov_b32 exec_lo, 0x0
    s_mov_b32 exec_hi, 0xffff0000
    ds_read_b64 v[140:141], v3 offset:2656
    s_mov_b64 exec, -1
    ds_read_b64 v[142:143], v3 offset:2688
    s_mov_b64 exec, -1
    s_waitcnt vmcnt(6)
    v_cvt_pk_bf16_f32 v208, v208, v209
    v_cvt_pk_bf16_f32 v209, v210, v211
    ds_write_b64 v6, v[208:209] offset:0
    s_waitcnt vmcnt(5)
    v_cvt_pk_bf16_f32 v212, v212, v213
    v_cvt_pk_bf16_f32 v213, v214, v215
    ds_write_b64 v6, v[212:213] offset:512
    s_waitcnt vmcnt(4)
    v_cvt_pk_bf16_f32 v216, v216, v217
    v_cvt_pk_bf16_f32 v217, v218, v219
    ds_write_b64 v6, v[216:217] offset:1024
    s_waitcnt vmcnt(3)
    v_cvt_pk_bf16_f32 v220, v220, v221
    v_cvt_pk_bf16_f32 v221, v222, v223
    ds_write_b64 v6, v[220:221] offset:1536
    s_waitcnt vmcnt(2)
    v_cvt_pk_bf16_f32 v224, v224, v225
    v_cvt_pk_bf16_f32 v225, v226, v227
    ds_write_b64 v6, v[224:225] offset:2048
    s_waitcnt vmcnt(1)
    v_cvt_pk_bf16_f32 v172, v172, v173
    v_cvt_pk_bf16_f32 v173, v174, v175
    ds_write_b64 v6, v[172:173] offset:2560
    s_waitcnt vmcnt(0)
    v_cvt_pk_bf16_f32 v176, v176, v177
    v_cvt_pk_bf16_f32 v177, v178, v179
    ds_write_b64 v6, v[176:177] offset:3072
    v_mov_b32 v172, 0
    v_mov_b32 v173, 0
    v_mov_b32 v174, 0
    v_mov_b32 v175, 0
    v_mov_b32 v176, 0
    v_mov_b32 v177, 0
    v_mov_b32 v178, 0
    v_mov_b32 v179, 0
    s_waitcnt lgkmcnt(4)
    v_mfma_f32_16x16x16_bf16 v[180:183], v[116:117], v[24:25], v[12:15]
    v_mfma_f32_16x16x32_bf16 v[184:187], v[118:121], v[16:19], 0
    s_mov_b64 exec, s[4:5]
    ds_read_b64 v[144:145], v4 offset:800
    s_mov_b64 exec, s[10:11]
    ds_read_b64 v[146:147], v4 offset:832
    s_mov_b64 exec, -1
    v_mfma_f32_16x16x16_bf16 v[188:191], v[126:127], v[20:21], 0
    s_mov_b64 exec, s[12:13]
    ds_read_b64 v[148:149], v4 offset:864
    s_mov_b64 exec, s[14:15]
    ds_read_b64 v[150:151], v4 offset:896
    s_mov_b64 exec, -1
    v_mfma_f32_16x16x16_bf16 v[192:195], v[128:129], v[18:19], 0
    s_mov_b64 exec, s[16:17]
    ds_read_b64 v[152:153], v4 offset:928
    s_mov_b64 exec, -1
    ds_read_b64 v[154:155], v3 offset:0
    s_mov_b64 exec, -1
    v_mfma_f32_16x16x16_bf16 v[196:199], v[138:139], v[24:25], 0
    s_mov_b64 exec, s[18:19]
    ds_read_b64 v[156:157], v3 offset:32
    s_mov_b64 exec, s[36:37]
    ds_read_b64 v[158:159], v3 offset:640
    s_mov_b64 exec, -1
    v_mfma_f32_16x16x16_bf16 v[200:203], v[140:141], v[22:23], 0
    s_mov_b64 exec, s[38:39]
    ds_read_b64 v[160:161], v3 offset:672
    s_mov_b64 exec, s[40:41]
    ds_read_b64 v[162:163], v3 offset:704
    s_mov_b64 exec, -1
    v_mfma_f32_16x16x32_bf16 v[180:183], v[108:111], v[16:19], v[180:183]
    s_mov_b64 exec, s[42:43]
    ds_read_b64 v[164:165], v3 offset:1312
    s_mov_b64 exec, s[44:45]
    ds_read_b64 v[166:167], v3 offset:1344
    s_mov_b64 exec, -1
    v_mfma_f32_16x16x32_bf16 v[180:183], v[112:115], v[20:23], v[180:183]
    s_mov_b64 exec, s[46:47]
    ds_read_b64 v[168:169], v3 offset:1376
    s_mov_b64 exec, s[20:21]
    ds_read_b64 v[170:171], v3 offset:1984
    s_mov_b64 exec, -1
    v_mfma_f32_16x16x32_bf16 v[188:191], v[122:125], v[16:19], v[188:191]
    s_mov_b64 exec, s[24:25]
    ds_read_b64 v[172:173], v3 offset:2016
    s_mov_b32 exec_lo, 0xf000f000
    s_mov_b32 exec_hi, 0xf000f000
    ds_read_b64 v[174:175], v3 offset:2048
    s_mov_b64 exec, -1
    v_mfma_f32_16x16x32_bf16 v[192:195], v[130:133], v[20:23], v[192:195]
    s_mov_b32 exec_lo, 0x0
    s_mov_b32 exec_hi, 0xffff0000
    ds_read_b64 v[176:177], v3 offset:2656
    s_mov_b64 exec, -1
    ds_read_b64 v[178:179], v3 offset:2688
    s_mov_b64 exec, -1
    v_mfma_f32_16x16x32_bf16 v[196:199], v[134:137], v[20:23], v[196:199]
    v_mfma_f32_16x16x16_bf16 v[200:203], v[142:143], v[24:25], v[200:203]
    v_mfma_f32_16x16x16_bf16 v[204:207], v[116:117], v[44:45], v[12:15]
    v_mfma_f32_16x16x32_bf16 v[208:211], v[118:121], v[36:39], 0
    v_mfma_f32_16x16x16_bf16 v[212:215], v[126:127], v[40:41], 0
    v_rcp_f32 v180, v180
    v_rcp_f32 v181, v181
    v_rcp_f32 v182, v182
    v_rcp_f32 v183, v183
    v_mfma_f32_16x16x16_bf16 v[216:219], v[128:129], v[38:39], 0
    v_mul_f32 v184, v184, v180
    v_mul_f32 v185, v185, v180
    v_mul_f32 v186, v186, v180
    v_mul_f32 v187, v187, v180
    v_mfma_f32_16x16x16_bf16 v[220:223], v[138:139], v[44:45], 0
    v_cvt_pk_bf16_f32 v16, v184, v185
    v_cvt_pk_bf16_f32 v17, v186, v187
    v_cndmask_b32 v180, v180, v181, s[66:67]
    v_mul_f32 v188, v188, v180
    v_mfma_f32_16x16x16_bf16 v[224:227], v[140:141], v[42:43], 0
    v_mul_f32 v189, v189, v180
    v_mul_f32 v190, v190, v180
    v_mul_f32 v191, v191, v180
    v_mfma_f32_16x16x32_bf16 v[204:207], v[108:111], v[36:39], v[204:207]
    v_cvt_pk_bf16_f32 v18, v188, v189
    v_cvt_pk_bf16_f32 v19, v190, v191
    v_cndmask_b32 v181, v181, v182, s[68:69]
    v_mul_f32 v192, v192, v181
    v_mfma_f32_16x16x32_bf16 v[204:207], v[112:115], v[40:43], v[204:207]
    v_mul_f32 v193, v193, v181
    v_mul_f32 v194, v194, v181
    v_mul_f32 v195, v195, v181
    v_cvt_pk_bf16_f32 v20, v192, v193
    v_mfma_f32_16x16x32_bf16 v[212:215], v[122:125], v[36:39], v[212:215]
    v_cvt_pk_bf16_f32 v21, v194, v195
    v_cndmask_b32 v182, v182, v183, s[70:71]
    v_mul_f32 v196, v196, v182
    v_mfma_f32_16x16x32_bf16 v[216:219], v[130:133], v[40:43], v[216:219]
    v_mul_f32 v197, v197, v182
    v_mul_f32 v198, v198, v182
    v_mul_f32 v199, v199, v182
    v_cvt_pk_bf16_f32 v22, v196, v197
    v_mfma_f32_16x16x32_bf16 v[220:223], v[134:137], v[40:43], v[220:223]
    v_cvt_pk_bf16_f32 v23, v198, v199
    v_mul_f32 v200, v200, v183
    v_mul_f32 v201, v201, v183
    v_mul_f32 v202, v202, v183
    v_mfma_f32_16x16x16_bf16 v[224:227], v[142:143], v[44:45], v[224:227]
    v_mul_f32 v203, v203, v183
    v_cvt_pk_bf16_f32 v24, v200, v201
    v_cvt_pk_bf16_f32 v25, v202, v203
    s_waitcnt lgkmcnt(0)
    s_mov_b32 m0, s55
    s_mov_b32 s63, 172800
    buffer_load_dwordx4 v2, s[28:31], s63 offen lds
    v_mfma_f32_16x16x16_bf16 v[180:183], v[116:117], v[64:65], v[12:15]
    v_mfma_f32_16x16x32_bf16 v[184:187], v[118:121], v[56:59], 0
    v_mfma_f32_16x16x16_bf16 v[188:191], v[126:127], v[60:61], 0
    v_rcp_f32 v204, v204
    v_rcp_f32 v205, v205
    v_rcp_f32 v206, v206
    v_rcp_f32 v207, v207
    v_mfma_f32_16x16x16_bf16 v[192:195], v[128:129], v[58:59], 0
    v_mul_f32 v208, v208, v204
    v_mul_f32 v209, v209, v204
    v_mul_f32 v210, v210, v204
    v_mul_f32 v211, v211, v204
    v_mfma_f32_16x16x16_bf16 v[196:199], v[138:139], v[64:65], 0
    v_cvt_pk_bf16_f32 v36, v208, v209
    v_cvt_pk_bf16_f32 v37, v210, v211
    v_cndmask_b32 v204, v204, v205, s[66:67]
    v_mul_f32 v212, v212, v204
    v_mfma_f32_16x16x16_bf16 v[200:203], v[140:141], v[62:63], 0
    v_mul_f32 v213, v213, v204
    v_mul_f32 v214, v214, v204
    v_mul_f32 v215, v215, v204
    v_mfma_f32_16x16x32_bf16 v[180:183], v[108:111], v[56:59], v[180:183]
    v_cvt_pk_bf16_f32 v38, v212, v213
    v_cvt_pk_bf16_f32 v39, v214, v215
    v_cndmask_b32 v205, v205, v206, s[68:69]
    v_mul_f32 v216, v216, v205
    v_mfma_f32_16x16x32_bf16 v[180:183], v[112:115], v[60:63], v[180:183]
    v_mul_f32 v217, v217, v205
    v_mul_f32 v218, v218, v205
    v_mul_f32 v219, v219, v205
    v_cvt_pk_bf16_f32 v40, v216, v217
    v_mfma_f32_16x16x32_bf16 v[188:191], v[122:125], v[56:59], v[188:191]
    v_cvt_pk_bf16_f32 v41, v218, v219
    v_cndmask_b32 v206, v206, v207, s[70:71]
    v_mul_f32 v220, v220, v206
    v_mfma_f32_16x16x32_bf16 v[192:195], v[130:133], v[60:63], v[192:195]
    v_mul_f32 v221, v221, v206
    v_mul_f32 v222, v222, v206
    v_mul_f32 v223, v223, v206
    v_cvt_pk_bf16_f32 v42, v220, v221
    v_mfma_f32_16x16x32_bf16 v[196:199], v[134:137], v[60:63], v[196:199]
    v_cvt_pk_bf16_f32 v43, v222, v223
    v_mul_f32 v224, v224, v207
    v_mul_f32 v225, v225, v207
    v_mul_f32 v226, v226, v207
    v_mfma_f32_16x16x16_bf16 v[200:203], v[142:143], v[64:65], v[200:203]
    v_mul_f32 v227, v227, v207
    v_cvt_pk_bf16_f32 v44, v224, v225
    v_cvt_pk_bf16_f32 v45, v226, v227
    v_mfma_f32_16x16x16_bf16 v[204:207], v[144:145], v[26:27], v[12:15]
    v_mfma_f32_16x16x16_bf16 v[208:211], v[154:155], v[26:27], 0
    v_mfma_f32_16x16x16_bf16 v[212:215], v[158:159], v[26:27], 0
    v_rcp_f32 v180, v180
    v_rcp_f32 v181, v181
    v_rcp_f32 v182, v182
    v_rcp_f32 v183, v183
    v_mfma_f32_16x16x16_bf16 v[216:219], v[168:169], v[32:33], 0
    v_mul_f32 v184, v184, v180
    v_mul_f32 v185, v185, v180
    v_mul_f32 v186, v186, v180
    v_mul_f32 v187, v187, v180
    v_mfma_f32_16x16x16_bf16 v[220:223], v[170:171], v[30:31], 0
    v_cvt_pk_bf16_f32 v56, v184, v185
    v_cvt_pk_bf16_f32 v57, v186, v187
    v_cndmask_b32 v180, v180, v181, s[66:67]
    v_mul_f32 v188, v188, v180
    v_mfma_f32_16x16x32_bf16 v[224:227], v[176:179], v[32:35], 0
    v_mul_f32 v189, v189, v180
    v_mul_f32 v190, v190, v180
    v_mul_f32 v191, v191, v180
    v_mfma_f32_16x16x32_bf16 v[204:207], v[146:149], v[28:31], v[204:207]
    v_cvt_pk_bf16_f32 v58, v188, v189
    v_cvt_pk_bf16_f32 v59, v190, v191
    v_cndmask_b32 v181, v181, v182, s[68:69]
    v_mul_f32 v192, v192, v181
    v_mfma_f32_16x16x32_bf16 v[204:207], v[150:153], v[32:35], v[204:207]
    v_mul_f32 v193, v193, v181
    v_mul_f32 v194, v194, v181
    v_mul_f32 v195, v195, v181
    v_cvt_pk_bf16_f32 v60, v192, v193
    v_mfma_f32_16x16x16_bf16 v[208:211], v[156:157], v[28:29], v[208:211]
    v_cvt_pk_bf16_f32 v61, v194, v195
    v_cndmask_b32 v182, v182, v183, s[70:71]
    v_mul_f32 v196, v196, v182
    v_mfma_f32_16x16x32_bf16 v[212:215], v[160:163], v[28:31], v[212:215]
    v_mul_f32 v197, v197, v182
    v_mul_f32 v198, v198, v182
    v_mul_f32 v199, v199, v182
    v_cvt_pk_bf16_f32 v62, v196, v197
    v_mfma_f32_16x16x32_bf16 v[216:219], v[164:167], v[28:31], v[216:219]
    v_cvt_pk_bf16_f32 v63, v198, v199
    v_mul_f32 v200, v200, v183
    v_mul_f32 v201, v201, v183
    v_mul_f32 v202, v202, v183
    v_mfma_f32_16x16x32_bf16 v[220:223], v[172:175], v[32:35], v[220:223]
    v_mul_f32 v203, v203, v183
    v_cvt_pk_bf16_f32 v64, v200, v201
    v_cvt_pk_bf16_f32 v65, v202, v203
    v_mfma_f32_16x16x16_bf16 v[180:183], v[144:145], v[46:47], v[12:15]
    v_mfma_f32_16x16x16_bf16 v[184:187], v[154:155], v[46:47], 0
    v_mfma_f32_16x16x16_bf16 v[188:191], v[158:159], v[46:47], 0
    v_rcp_f32 v204, v204
    v_rcp_f32 v205, v205
    v_rcp_f32 v206, v206
    v_rcp_f32 v207, v207
    v_mfma_f32_16x16x16_bf16 v[192:195], v[168:169], v[52:53], 0
    v_mul_f32 v208, v208, v204
    v_mul_f32 v209, v209, v204
    v_mul_f32 v210, v210, v204
    v_mul_f32 v211, v211, v204
    v_mfma_f32_16x16x16_bf16 v[196:199], v[170:171], v[50:51], 0
    v_cvt_pk_bf16_f32 v26, v208, v209
    v_cvt_pk_bf16_f32 v27, v210, v211
    v_cndmask_b32 v204, v204, v205, s[66:67]
    v_mul_f32 v212, v212, v204
    v_mfma_f32_16x16x32_bf16 v[200:203], v[176:179], v[52:55], 0
    v_mul_f32 v213, v213, v204
    v_mul_f32 v214, v214, v204
    v_mul_f32 v215, v215, v204
    v_mfma_f32_16x16x32_bf16 v[180:183], v[146:149], v[48:51], v[180:183]
    v_cvt_pk_bf16_f32 v28, v212, v213
    v_cvt_pk_bf16_f32 v29, v214, v215
    v_cndmask_b32 v205, v205, v206, s[68:69]
    v_mul_f32 v216, v216, v205
    v_mfma_f32_16x16x32_bf16 v[180:183], v[150:153], v[52:55], v[180:183]
    v_mul_f32 v217, v217, v205
    v_mul_f32 v218, v218, v205
    v_mul_f32 v219, v219, v205
    v_cvt_pk_bf16_f32 v30, v216, v217
    v_mfma_f32_16x16x16_bf16 v[184:187], v[156:157], v[48:49], v[184:187]
    v_cvt_pk_bf16_f32 v31, v218, v219
    v_cndmask_b32 v206, v206, v207, s[70:71]
    v_mul_f32 v220, v220, v206
    v_mfma_f32_16x16x32_bf16 v[188:191], v[160:163], v[48:51], v[188:191]
    v_mul_f32 v221, v221, v206
    v_mul_f32 v222, v222, v206
    v_mul_f32 v223, v223, v206
    v_cvt_pk_bf16_f32 v32, v220, v221
    v_mfma_f32_16x16x32_bf16 v[192:195], v[164:167], v[48:51], v[192:195]
    v_cvt_pk_bf16_f32 v33, v222, v223
    v_mul_f32 v224, v224, v207
    v_mul_f32 v225, v225, v207
    v_mul_f32 v226, v226, v207
    v_mfma_f32_16x16x32_bf16 v[196:199], v[172:175], v[52:55], v[196:199]
    v_mul_f32 v227, v227, v207
    v_cvt_pk_bf16_f32 v34, v224, v225
    v_cvt_pk_bf16_f32 v35, v226, v227
    v_mfma_f32_16x16x16_bf16 v[204:207], v[144:145], v[66:67], v[12:15]
    v_mfma_f32_16x16x16_bf16 v[208:211], v[154:155], v[66:67], 0
    v_mfma_f32_16x16x16_bf16 v[212:215], v[158:159], v[66:67], 0
    v_rcp_f32 v180, v180
    v_rcp_f32 v181, v181
    v_rcp_f32 v182, v182
    v_rcp_f32 v183, v183
    v_mfma_f32_16x16x16_bf16 v[216:219], v[168:169], v[72:73], 0
    v_mul_f32 v184, v184, v180
    v_mul_f32 v185, v185, v180
    v_mul_f32 v186, v186, v180
    v_mul_f32 v187, v187, v180
    v_mfma_f32_16x16x16_bf16 v[220:223], v[170:171], v[70:71], 0
    v_cvt_pk_bf16_f32 v46, v184, v185
    v_cvt_pk_bf16_f32 v47, v186, v187
    v_cndmask_b32 v180, v180, v181, s[66:67]
    v_mul_f32 v188, v188, v180
    v_mfma_f32_16x16x32_bf16 v[224:227], v[176:179], v[72:75], 0
    v_mul_f32 v189, v189, v180
    v_mul_f32 v190, v190, v180
    v_mul_f32 v191, v191, v180
    v_mfma_f32_16x16x32_bf16 v[204:207], v[146:149], v[68:71], v[204:207]
    v_cvt_pk_bf16_f32 v48, v188, v189
    v_cvt_pk_bf16_f32 v49, v190, v191
    v_cndmask_b32 v181, v181, v182, s[68:69]
    v_mul_f32 v192, v192, v181
    v_mfma_f32_16x16x32_bf16 v[204:207], v[150:153], v[72:75], v[204:207]
    v_mul_f32 v193, v193, v181
    v_mul_f32 v194, v194, v181
    v_mul_f32 v195, v195, v181
    v_cvt_pk_bf16_f32 v50, v192, v193
    v_mfma_f32_16x16x16_bf16 v[208:211], v[156:157], v[68:69], v[208:211]
    v_cvt_pk_bf16_f32 v51, v194, v195
    v_cndmask_b32 v182, v182, v183, s[70:71]
    v_mul_f32 v196, v196, v182
    v_mfma_f32_16x16x32_bf16 v[212:215], v[160:163], v[68:71], v[212:215]
    v_mul_f32 v197, v197, v182
    v_mul_f32 v198, v198, v182
    v_mul_f32 v199, v199, v182
    v_cvt_pk_bf16_f32 v52, v196, v197
    v_mfma_f32_16x16x32_bf16 v[216:219], v[164:167], v[68:71], v[216:219]
    v_cvt_pk_bf16_f32 v53, v198, v199
    v_mul_f32 v200, v200, v183
    v_mul_f32 v201, v201, v183
    v_mul_f32 v202, v202, v183
    v_mfma_f32_16x16x32_bf16 v[220:223], v[172:175], v[72:75], v[220:223]
    v_mul_f32 v203, v203, v183
    v_cvt_pk_bf16_f32 v54, v200, v201
    v_cvt_pk_bf16_f32 v55, v202, v203
    v_mfma_f32_16x16x32_bf16 v[108:111], v[76:79], v[16:19], 0
    v_mfma_f32_16x16x32_bf16 v[112:115], v[76:79], v[36:39], 0
    v_mfma_f32_16x16x32_bf16 v[116:119], v[76:79], v[56:59], 0
    v_rcp_f32 v204, v204
    v_rcp_f32 v205, v205
    v_mfma_f32_16x16x32_bf16 v[120:123], v[80:83], v[16:19], 0
    v_rcp_f32 v206, v206
    v_rcp_f32 v207, v207
    v_mfma_f32_16x16x32_bf16 v[124:127], v[80:83], v[36:39], 0
    v_mul_f32 v208, v208, v204
    v_mul_f32 v209, v209, v204
    v_mfma_f32_16x16x32_bf16 v[128:131], v[80:83], v[56:59], 0
    v_mul_f32 v210, v210, v204
    v_mfma_f32_16x16x32_bf16 v[132:135], v[84:87], v[16:19], 0
    v_mul_f32 v211, v211, v204
    v_cvt_pk_bf16_f32 v66, v208, v209
    v_mfma_f32_16x16x32_bf16 v[136:139], v[84:87], v[36:39], 0
    v_cvt_pk_bf16_f32 v67, v210, v211
    v_cndmask_b32 v204, v204, v205, s[66:67]
    v_mfma_f32_16x16x32_bf16 v[140:143], v[84:87], v[56:59], 0
    v_mul_f32 v212, v212, v204
    v_mfma_f32_16x16x32_bf16 v[144:147], v[88:91], v[16:19], 0
    v_mul_f32 v213, v213, v204
    v_mul_f32 v214, v214, v204
    v_mfma_f32_16x16x32_bf16 v[148:151], v[88:91], v[36:39], 0
    v_mul_f32 v215, v215, v204
    v_cvt_pk_bf16_f32 v68, v212, v213
    v_mfma_f32_16x16x32_bf16 v[152:155], v[88:91], v[56:59], 0
    v_cvt_pk_bf16_f32 v69, v214, v215
    v_mfma_f32_16x16x32_bf16 v[156:159], v[92:95], v[16:19], 0
    v_cndmask_b32 v205, v205, v206, s[68:69]
    v_mul_f32 v216, v216, v205
    v_mfma_f32_16x16x32_bf16 v[160:163], v[92:95], v[36:39], 0
    v_mul_f32 v217, v217, v205
    v_mul_f32 v218, v218, v205
    v_mfma_f32_16x16x32_bf16 v[164:167], v[92:95], v[56:59], 0
    v_mul_f32 v219, v219, v205
    v_mfma_f32_16x16x32_bf16 v[168:171], v[96:99], v[16:19], 0
    v_cvt_pk_bf16_f32 v70, v216, v217
    v_cvt_pk_bf16_f32 v71, v218, v219
    v_mfma_f32_16x16x32_bf16 v[172:175], v[96:99], v[36:39], 0
    v_cndmask_b32 v206, v206, v207, s[70:71]
    v_mul_f32 v220, v220, v206
    v_mfma_f32_16x16x32_bf16 v[176:179], v[96:99], v[56:59], 0
    v_mul_f32 v221, v221, v206
    v_mfma_f32_16x16x32_bf16 v[180:183], v[100:103], v[16:19], 0
    v_mul_f32 v222, v222, v206
    v_mul_f32 v223, v223, v206
    v_mfma_f32_16x16x32_bf16 v[184:187], v[100:103], v[36:39], 0
    v_cvt_pk_bf16_f32 v72, v220, v221
    v_cvt_pk_bf16_f32 v73, v222, v223
    v_mfma_f32_16x16x32_bf16 v[188:191], v[100:103], v[56:59], 0
    v_mul_f32 v224, v224, v207
    v_mfma_f32_16x16x32_bf16 v[192:195], v[104:107], v[16:19], 0
    v_mul_f32 v225, v225, v207
    v_mul_f32 v226, v226, v207
    v_mfma_f32_16x16x32_bf16 v[196:199], v[104:107], v[36:39], 0
    v_mul_f32 v227, v227, v207
    v_cvt_pk_bf16_f32 v74, v224, v225
    v_mfma_f32_16x16x32_bf16 v[200:203], v[104:107], v[56:59], 0
    v_cvt_pk_bf16_f32 v75, v226, v227
    v_mfma_f32_16x16x32_bf16 v[108:111], v[228:231], v[20:23], v[108:111]
    ds_read_b64_tr_b16 v[76:77], v0 offset:0
    v_mfma_f32_16x16x32_bf16 v[112:115], v[228:231], v[40:43], v[112:115]
    ds_read_b64_tr_b16 v[78:79], v0 offset:512
    v_mfma_f32_16x16x32_bf16 v[116:119], v[228:231], v[60:63], v[116:119]
    ds_read_b64_tr_b16 v[80:81], v0 offset:32
    v_mfma_f32_16x16x32_bf16 v[120:123], v[232:235], v[20:23], v[120:123]
    ds_read_b64_tr_b16 v[82:83], v0 offset:544
    v_mfma_f32_16x16x32_bf16 v[124:127], v[232:235], v[40:43], v[124:127]
    ds_read_b64_tr_b16 v[84:85], v0 offset:64
    v_mfma_f32_16x16x32_bf16 v[128:131], v[232:235], v[60:63], v[128:131]
    ds_read_b64_tr_b16 v[86:87], v0 offset:576
    v_mfma_f32_16x16x32_bf16 v[132:135], v[236:239], v[20:23], v[132:135]
    ds_read_b64_tr_b16 v[88:89], v0 offset:96
    v_mfma_f32_16x16x32_bf16 v[136:139], v[236:239], v[40:43], v[136:139]
    ds_read_b64_tr_b16 v[90:91], v0 offset:608
    v_mfma_f32_16x16x32_bf16 v[140:143], v[236:239], v[60:63], v[140:143]
    v_mfma_f32_16x16x32_bf16 v[144:147], v[240:243], v[20:23], v[144:147]
    ds_read_b64_tr_b16 v[92:93], v0 offset:128
    v_mfma_f32_16x16x32_bf16 v[148:151], v[240:243], v[40:43], v[148:151]
    ds_read_b64_tr_b16 v[94:95], v0 offset:640
    v_mfma_f32_16x16x32_bf16 v[152:155], v[240:243], v[60:63], v[152:155]
    ds_read_b64_tr_b16 v[96:97], v0 offset:160
    v_mfma_f32_16x16x32_bf16 v[156:159], v[244:247], v[20:23], v[156:159]
    ds_read_b64_tr_b16 v[98:99], v0 offset:672
    v_mfma_f32_16x16x32_bf16 v[160:163], v[244:247], v[40:43], v[160:163]
    ds_read_b64_tr_b16 v[100:101], v0 offset:192
    v_mfma_f32_16x16x32_bf16 v[164:167], v[244:247], v[60:63], v[164:167]
    ds_read_b64_tr_b16 v[102:103], v0 offset:704
    v_mfma_f32_16x16x32_bf16 v[168:171], v[248:251], v[20:23], v[168:171]
    ds_read_b64_tr_b16 v[104:105], v0 offset:224
    v_mfma_f32_16x16x32_bf16 v[172:175], v[248:251], v[40:43], v[172:175]
    ds_read_b64_tr_b16 v[106:107], v0 offset:736
    v_mfma_f32_16x16x32_bf16 v[176:179], v[248:251], v[60:63], v[176:179]
    v_mfma_f32_16x16x32_bf16 v[180:183], v[252:255], v[20:23], v[180:183]
    v_mfma_f32_16x16x32_bf16 v[184:187], v[252:255], v[40:43], v[184:187]
    v_mfma_f32_16x16x32_bf16 v[188:191], v[252:255], v[60:63], v[188:191]
    v_mfma_f32_16x16x32_bf16 v[192:195], v[8:11], v[20:23], v[192:195]
    v_mfma_f32_16x16x32_bf16 v[196:199], v[8:11], v[40:43], v[196:199]
    v_mfma_f32_16x16x32_bf16 v[200:203], v[8:11], v[60:63], v[200:203]
    s_waitcnt lgkmcnt(6)
    v_mfma_f32_16x16x32_bf16 v[108:111], v[76:79], v[24:27], v[108:111]
    s_xor_b32 s52, s3, 1
    s_mul_i32 s52, s52, 20480
    ds_read_b64_tr_b16 v[228:229], v0 offset:8416
    s_add_u32 s52, s52, 0
    v_mfma_f32_16x16x32_bf16 v[112:115], v[76:79], v[44:47], v[112:115]
    s_add_u32 s52, s52, s75
    ds_read_b64_tr_b16 v[230:231], v0 offset:8928
    v_add_u32 v204, s52, v5
    v_mfma_f32_16x16x32_bf16 v[116:119], v[76:79], v[64:67], v[116:119]
    s_xor_b32 s52, s3, 2
    ds_read_b64_tr_b16 v[232:233], v0 offset:8448
    s_mul_i32 s52, s52, 20480
    v_mfma_f32_16x16x32_bf16 v[120:123], v[80:83], v[24:27], v[120:123]
    s_add_u32 s52, s52, 6144
    ds_read_b64_tr_b16 v[234:235], v0 offset:8960
    s_add_u32 s52, s52, s75
    v_mfma_f32_16x16x32_bf16 v[124:127], v[80:83], v[44:47], v[124:127]
    v_add_u32 v205, s52, v5
    s_xor_b32 s52, s3, 3
    ds_read_b64_tr_b16 v[236:237], v0 offset:8480
    s_mul_i32 s52, s52, 20480
    v_mfma_f32_16x16x32_bf16 v[128:131], v[80:83], v[64:67], v[128:131]
    s_add_u32 s52, s52, 12288
    ds_read_b64_tr_b16 v[238:239], v0 offset:8992
    s_add_u32 s52, s52, s75
    v_mfma_f32_16x16x32_bf16 v[132:135], v[84:87], v[24:27], v[132:135]
    v_add_u32 v206, s52, v5
    ds_read_b64_tr_b16 v[240:241], v0 offset:8512
    s_sub_u32 s59, s59, s65
    v_mfma_f32_16x16x32_bf16 v[136:139], v[84:87], v[44:47], v[136:139]
    s_sub_u32 s55, s55, s65
    ds_read_b64_tr_b16 v[242:243], v0 offset:9024
    s_sub_u32 s55, s55, 7392
    v_mfma_f32_16x16x32_bf16 v[140:143], v[84:87], v[64:67], v[140:143]
    v_add_u32 v208, s59, v0
    v_add_u32 v209, s55, v0
    ds_read_b64_tr_b16 v[244:245], v0 offset:8544
    v_bfe_u32 v210, v1, 2, 3
    v_mfma_f32_16x16x32_bf16 v[144:147], v[88:91], v[24:27], v[144:147]
    v_cmp_eq_u32 vcc, 7, v210
    ds_read_b64_tr_b16 v[246:247], v0 offset:9056
    v_mov_b32 v211, 0
    v_mfma_f32_16x16x32_bf16 v[148:151], v[88:91], v[44:47], v[148:151]
    v_mov_b32 v211, 0
    ds_read_b64_tr_b16 v[248:249], v0 offset:8576
    v_cndmask_b32 v208, v208, v209, vcc
    v_mfma_f32_16x16x32_bf16 v[152:155], v[88:91], v[64:67], v[152:155]
    v_add_u32 v207, s65, v5
    ds_read_b64_tr_b16 v[250:251], v0 offset:9088
    s_add_u32 s53, s65, 18432
    v_mfma_f32_16x16x32_bf16 v[156:159], v[92:95], v[24:27], v[156:159]
    v_and_b32 v12, 15, v1
    v_mul_u32_u24 v12, 80, v12
    ds_read_b64_tr_b16 v[252:253], v0 offset:8608
    v_lshrrev_b32 v3, 4, v1
    v_mfma_f32_16x16x32_bf16 v[160:163], v[92:95], v[44:47], v[160:163]
    v_lshl_add_u32 v12, v3, 3, v12
    ds_read_b64_tr_b16 v[254:255], v0 offset:9120
    v_add_u32 v12, s53, v12
    v_mfma_f32_16x16x32_bf16 v[164:167], v[92:95], v[64:67], v[164:167]
    v_lshrrev_b32 v3, 2, v1
    ds_read_b64_tr_b16 v[8:9], v0 offset:8640
    v_and_b32 v4, 3, v1
    s_waitcnt lgkmcnt(5)
    v_mfma_f32_16x16x32_bf16 v[168:171], v[96:99], v[24:27], v[168:171]
    v_lshlrev_b32 v4, 4, v4
    ds_read_b64_tr_b16 v[10:11], v0 offset:9152
    v_mul_u32_u24 v15, 80, v3
    v_mfma_f32_16x16x32_bf16 v[172:175], v[96:99], v[44:47], v[172:175]
    v_add3_u32 v15, v15, v4, s53
    s_mul_i32 s52, s57, 48
    v_mfma_f32_16x16x32_bf16 v[176:179], v[96:99], v[64:67], v[176:179]
    v_add_u32 v3, s52, v3
    v_mfma_f32_16x16x32_bf16 v[180:183], v[100:103], v[24:27], v[180:183]
    v_mul_u32_u24 v3, 2560, v3
    v_mfma_f32_16x16x32_bf16 v[184:187], v[100:103], v[44:47], v[184:187]
    v_add_u32 v3, v3, v4
    v_mfma_f32_16x16x32_bf16 v[188:191], v[100:103], v[64:67], v[188:191]
    s_lshl_b32 s52, s58, 8
    v_mfma_f32_16x16x32_bf16 v[192:195], v[104:107], v[24:27], v[192:195]
    s_lshl_b32 s54, s3, 6
    v_mfma_f32_16x16x32_bf16 v[196:199], v[104:107], v[44:47], v[196:199]
    s_add_u32 s52, s52, s54
    v_mfma_f32_16x16x32_bf16 v[200:203], v[104:107], v[64:67], v[200:203]
    s_add_u32 s52, s52, 1280
    s_waitcnt vmcnt(0)
    v_mfma_f32_16x16x32_bf16 v[108:111], v[228:231], v[28:31], v[108:111]
    ds_read_b64_tr_b16 v[84:85], v208 offset:64
    ds_read_b64_tr_b16 v[86:87], v208 offset:576
    v_mfma_f32_16x16x32_bf16 v[112:115], v[228:231], v[48:51], v[112:115]
    ds_read_b64_tr_b16 v[88:89], v208 offset:96
    v_mfma_f32_16x16x32_bf16 v[116:119], v[228:231], v[68:71], v[116:119]
    ds_read_b64_tr_b16 v[90:91], v208 offset:608
    v_mfma_f32_16x16x32_bf16 v[120:123], v[232:235], v[28:31], v[120:123]
    ds_read_b64_tr_b16 v[92:93], v208 offset:128
    ds_read_b64_tr_b16 v[94:95], v208 offset:640
    v_mfma_f32_16x16x32_bf16 v[124:127], v[232:235], v[48:51], v[124:127]
    ds_read_b64_tr_b16 v[96:97], v208 offset:160
    v_mfma_f32_16x16x32_bf16 v[128:131], v[232:235], v[68:71], v[128:131]
    ds_read_b64_tr_b16 v[98:99], v208 offset:672
    v_mfma_f32_16x16x32_bf16 v[132:135], v[236:239], v[28:31], v[132:135]
    ds_read_b64_tr_b16 v[100:101], v208 offset:192
    ds_read_b64_tr_b16 v[102:103], v208 offset:704
    v_mfma_f32_16x16x32_bf16 v[136:139], v[236:239], v[48:51], v[136:139]
    ds_read_b64_tr_b16 v[104:105], v208 offset:224
    v_mfma_f32_16x16x32_bf16 v[140:143], v[236:239], v[68:71], v[140:143]
    ds_read_b64_tr_b16 v[106:107], v208 offset:736
    v_mfma_f32_16x16x32_bf16 v[144:147], v[240:243], v[28:31], v[144:147]
    ds_read_b64_tr_b16 v[76:77], v208 offset:0
    ds_read_b64_tr_b16 v[78:79], v208 offset:512
    v_mfma_f32_16x16x32_bf16 v[148:151], v[240:243], v[48:51], v[148:151]
    ds_read_b64_tr_b16 v[80:81], v208 offset:32
    v_mfma_f32_16x16x32_bf16 v[152:155], v[240:243], v[68:71], v[152:155]
    ds_read_b64_tr_b16 v[82:83], v208 offset:544
    s_waitcnt lgkmcnt(11)
    v_mfma_f32_16x16x32_bf16 v[132:135], v[84:87], v[32:35], v[132:135]
    v_mfma_f32_16x16x32_bf16 v[136:139], v[84:87], v[52:55], v[136:139]
    v_mfma_f32_16x16x32_bf16 v[140:143], v[84:87], v[72:75], v[140:143]
    v_mfma_f32_16x16x32_bf16 v[144:147], v[88:91], v[32:35], v[144:147]
    v_mfma_f32_16x16x32_bf16 v[148:151], v[88:91], v[52:55], v[148:151]
    v_mfma_f32_16x16x32_bf16 v[152:155], v[88:91], v[72:75], v[152:155]
    v_mfma_f32_16x16x32_bf16 v[156:159], v[244:247], v[28:31], v[156:159]
    v_mfma_f32_16x16x32_bf16 v[160:163], v[244:247], v[48:51], v[160:163]
    v_mfma_f32_16x16x32_bf16 v[164:167], v[244:247], v[68:71], v[164:167]
    ds_write_b128 v207, v[132:135] offset:0
    v_mfma_f32_16x16x32_bf16 v[168:171], v[248:251], v[28:31], v[168:171]
    ds_write_b128 v207, v[136:139] offset:1024
    v_mfma_f32_16x16x32_bf16 v[172:175], v[248:251], v[48:51], v[172:175]
    v_mfma_f32_16x16x32_bf16 v[176:179], v[248:251], v[68:71], v[176:179]
    ds_write_b128 v207, v[140:143] offset:2048
    s_waitcnt lgkmcnt(5)
    v_mfma_f32_16x16x32_bf16 v[156:159], v[92:95], v[32:35], v[156:159]
    v_mfma_f32_16x16x32_bf16 v[160:163], v[92:95], v[52:55], v[160:163]
    ds_write_b128 v207, v[144:147] offset:3072
    v_mfma_f32_16x16x32_bf16 v[164:167], v[92:95], v[72:75], v[164:167]
    ds_write_b128 v207, v[148:151] offset:4096
    v_mfma_f32_16x16x32_bf16 v[168:171], v[96:99], v[32:35], v[168:171]
    v_mfma_f32_16x16x32_bf16 v[172:175], v[96:99], v[52:55], v[172:175]
    ds_write_b128 v207, v[152:155] offset:5120
    v_mfma_f32_16x16x32_bf16 v[176:179], v[96:99], v[72:75], v[176:179]
    v_mfma_f32_16x16x32_bf16 v[180:183], v[252:255], v[28:31], v[180:183]
    v_mfma_f32_16x16x32_bf16 v[184:187], v[252:255], v[48:51], v[184:187]
    v_mfma_f32_16x16x32_bf16 v[188:191], v[252:255], v[68:71], v[188:191]
    ds_write_b128 v207, v[156:159] offset:6144
    v_mfma_f32_16x16x32_bf16 v[192:195], v[8:11], v[28:31], v[192:195]
    ds_write_b128 v207, v[160:163] offset:7168
    v_mfma_f32_16x16x32_bf16 v[196:199], v[8:11], v[48:51], v[196:199]
    v_mfma_f32_16x16x32_bf16 v[200:203], v[8:11], v[68:71], v[200:203]
    ds_write_b128 v207, v[164:167] offset:8192
    v_mfma_f32_16x16x32_bf16 v[180:183], v[100:103], v[32:35], v[180:183]
    v_mfma_f32_16x16x32_bf16 v[184:187], v[100:103], v[52:55], v[184:187]
    ds_write_b128 v207, v[168:171] offset:9216
    v_mfma_f32_16x16x32_bf16 v[188:191], v[100:103], v[72:75], v[188:191]
    ds_write_b128 v207, v[172:175] offset:10240
    v_mfma_f32_16x16x32_bf16 v[192:195], v[104:107], v[32:35], v[192:195]
    v_mfma_f32_16x16x32_bf16 v[196:199], v[104:107], v[52:55], v[196:199]
    ds_write_b128 v207, v[176:179] offset:11264
    v_mfma_f32_16x16x32_bf16 v[200:203], v[104:107], v[72:75], v[200:203]
    v_mfma_f32_16x16x32_bf16 v[108:111], v[76:79], v[32:35], v[108:111]
    v_mfma_f32_16x16x32_bf16 v[112:115], v[76:79], v[52:55], v[112:115]
    v_mfma_f32_16x16x32_bf16 v[116:119], v[76:79], v[72:75], v[116:119]
    ds_write_b128 v207, v[180:183] offset:12288
    ds_write_b128 v207, v[184:187] offset:13312
    s_waitcnt lgkmcnt(7)
    v_mfma_f32_16x16x32_bf16 v[120:123], v[80:83], v[32:35], v[120:123]
    ds_write_b128 v207, v[188:191] offset:14336
    v_mfma_f32_16x16x32_bf16 v[124:127], v[80:83], v[52:55], v[124:127]
    ds_write_b128 v207, v[192:195] offset:15360
    ds_write_b128 v207, v[196:199] offset:16384
    v_mfma_f32_16x16x32_bf16 v[128:131], v[80:83], v[72:75], v[128:131]
    ds_write_b128 v207, v[200:203] offset:17408
    v_mov_b32 v13, s75
    v_mov_b32 v14, 1
    v_add_u32 v13, 81856, v13
    s_add_u32 s76, s76, 4
    s_mov_b64 exec, 1
    ds_add_u32 v13, v14
    s_mov_b64 exec, -1
L_BW_5:
    ds_read_b32 v14, v13
    s_waitcnt lgkmcnt(0)
    v_cmp_gt_u32 vcc, s76, v14
    s_nop 1
    s_cbranch_vccnz L_BW_5
    ds_read_b128 v[16:19], v204 offset:0
    ds_read_b128 v[20:23], v205 offset:0
    ds_read_b128 v[24:27], v206 offset:0
    ds_read_b128 v[52:55], v204 offset:3072
    ds_read_b128 v[56:59], v205 offset:3072
    ds_read_b128 v[60:63], v206 offset:3072
    ds_read_b128 v[28:31], v204 offset:1024
    ds_read_b128 v[32:35], v205 offset:1024
    ds_read_b128 v[36:39], v206 offset:1024
    ds_read_b128 v[64:67], v204 offset:4096
    ds_read_b128 v[68:71], v205 offset:4096
    ds_read_b128 v[72:75], v206 offset:4096
    ds_read_b128 v[40:43], v204 offset:2048
    ds_read_b128 v[44:47], v205 offset:2048
    ds_read_b128 v[48:51], v206 offset:2048
    ds_read_b128 v[76:79], v204 offset:5120
    ds_read_b128 v[80:83], v205 offset:5120
    ds_read_b128 v[84:87], v206 offset:5120
    s_waitcnt lgkmcnt(15)
    v_add_f32 v108, v108, v16
    v_add_f32 v109, v109, v17
    v_add_f32 v110, v110, v18
    v_add_f32 v111, v111, v19
    v_add_f32 v20, v20, v24
    v_add_f32 v21, v21, v25
    v_add_f32 v22, v22, v26
    v_add_f32 v23, v23, v27
    v_add_f32 v108, v108, v20
    v_add_f32 v109, v109, v21
    v_add_f32 v110, v110, v22
    v_add_f32 v111, v111, v23
    v_cvt_pk_bf16_f32 v140, v108, v109
    v_cvt_pk_bf16_f32 v141, v110, v111
    ds_write_b64 v12, v[140:141] offset:0
    s_waitcnt lgkmcnt(5)
    v_add_f32 v120, v120, v52
    v_add_f32 v121, v121, v53
    v_add_f32 v122, v122, v54
    v_add_f32 v123, v123, v55
    v_add_f32 v56, v56, v60
    v_add_f32 v57, v57, v61
    v_add_f32 v58, v58, v62
    v_add_f32 v59, v59, v63
    v_add_f32 v120, v120, v56
    v_add_f32 v121, v121, v57
    v_add_f32 v122, v122, v58
    v_add_f32 v123, v123, v59
    v_cvt_pk_bf16_f32 v146, v120, v121
    v_cvt_pk_bf16_f32 v147, v122, v123
    ds_write_b64 v12, v[146:147] offset:32
    ds_read_b128 v[160:163], v15
    v_add_f32 v112, v112, v28
    v_add_f32 v113, v113, v29
    v_add_f32 v114, v114, v30
    v_add_f32 v115, v115, v31
    v_add_f32 v32, v32, v36
    v_add_f32 v33, v33, v37
    v_add_f32 v34, v34, v38
    v_add_f32 v35, v35, v39
    v_add_f32 v112, v112, v32
    v_add_f32 v113, v113, v33
    v_add_f32 v114, v114, v34
    v_add_f32 v115, v115, v35
    v_cvt_pk_bf16_f32 v142, v112, v113
    v_cvt_pk_bf16_f32 v143, v114, v115
    ds_write_b64 v12, v[142:143] offset:0
    v_add_f32 v124, v124, v64
    v_add_f32 v125, v125, v65
    v_add_f32 v126, v126, v66
    v_add_f32 v127, v127, v67
    v_add_f32 v68, v68, v72
    v_add_f32 v69, v69, v73
    v_add_f32 v70, v70, v74
    v_add_f32 v71, v71, v75
    v_add_f32 v124, v124, v68
    v_add_f32 v125, v125, v69
    v_add_f32 v126, v126, v70
    v_add_f32 v127, v127, v71
    v_cvt_pk_bf16_f32 v148, v124, v125
    v_cvt_pk_bf16_f32 v149, v126, v127
    ds_write_b64 v12, v[148:149] offset:32
    ds_read_b128 v[164:167], v15
    s_waitcnt lgkmcnt(3)
    buffer_store_dwordx4 v[160:163], v3, s[32:35], s52 offen sc1
    s_add_u32 s52, s52, 40960
    v_add_f32 v116, v116, v40
    v_add_f32 v117, v117, v41
    v_add_f32 v118, v118, v42
    v_add_f32 v119, v119, v43
    v_add_f32 v44, v44, v48
    v_add_f32 v45, v45, v49
    v_add_f32 v46, v46, v50
    v_add_f32 v47, v47, v51
    v_add_f32 v116, v116, v44
    v_add_f32 v117, v117, v45
    v_add_f32 v118, v118, v46
    v_add_f32 v119, v119, v47
    v_cvt_pk_bf16_f32 v144, v116, v117
    v_cvt_pk_bf16_f32 v145, v118, v119
    ds_write_b64 v12, v[144:145] offset:0
    v_add_f32 v128, v128, v76
    v_add_f32 v129, v129, v77
    v_add_f32 v130, v130, v78
    v_add_f32 v131, v131, v79
    v_add_f32 v80, v80, v84
    v_add_f32 v81, v81, v85
    v_add_f32 v82, v82, v86
    v_add_f32 v83, v83, v87
    v_add_f32 v128, v128, v80
    v_add_f32 v129, v129, v81
    v_add_f32 v130, v130, v82
    v_add_f32 v131, v131, v83
    v_cvt_pk_bf16_f32 v150, v128, v129
    v_cvt_pk_bf16_f32 v151, v130, v131
    ds_write_b64 v12, v[150:151] offset:32
    ds_read_b128 v[168:171], v15
    s_waitcnt lgkmcnt(3)
    buffer_store_dwordx4 v[164:167], v3, s[32:35], s52 offen sc1
    s_add_u32 s52, s52, 40960
    s_waitcnt lgkmcnt(0)
    buffer_store_dwordx4 v[168:171], v3, s[32:35], s52 offen sc1
L_FIN:
L_END:
    s_endpgm
L_CODE_END:
    s_endpgm
.section .rodata,"a"
.p2align 6
.amdhsa_kernel concat_heads__ssm_conv_h3__linear_attn_block__prompt_kernel
  .amdhsa_next_free_vgpr 256
  .amdhsa_next_free_sgpr 102
  .amdhsa_accum_offset 256
  .amdhsa_group_segment_fixed_size 0
  .amdhsa_kernarg_size 96
  .amdhsa_user_sgpr_count 2
  .amdhsa_user_sgpr_kernarg_segment_ptr 1
  .amdhsa_system_sgpr_workgroup_id_x 1
  .amdhsa_float_denorm_mode_32 3
.end_amdhsa_kernel
```
